```python
import torch

def _softmax(x, axis=-1):
    return torch.softmax(x, dim=axis)
def _gelu(x):
    return torch.nn.functional.gelu(x, approximate="tanh")
def _silu(x):
    return torch.nn.functional.silu(x)
def _sigmoid(x):
    return torch.sigmoid(x)
def _layernorm(x, axis=-1, eps=1e-5):
    m = x.mean(dim=axis, keepdim=True)
    v = x.var(dim=axis, keepdim=True, unbiased=False)
    return (x - m) / torch.sqrt(v + eps)
def _scatter_add(tgt, idx, src, axis=0):
    return tgt.clone().index_add_(axis, idx, src)
def _segment_sum(src, seg, n):
    out = torch.zeros((n,) + src.shape[1:], dtype=src.dtype)
    return out.index_add_(0, seg, src)
def _pad(x, pw):
    flat = tuple(v for pair in reversed(pw) for v in pair)
    return torch.nn.functional.pad(x, flat)

kernel_name = 'gated_mix__sliding_block__swiglu_ffn__prompt'

def setup_inputs():

    _w = (lambda a: (lambda t: t.to(torch.bfloat16) if t.is_floating_point() else t)(torch.as_tensor(a)))
    def _A_setup():
        B, S, D = 1, 2048, 1024
        return {
            "x": _w((lambda *s: torch.randn(*s, dtype=torch.bfloat16) * 0.05)(B, S, D)),
            "wqkv": _w((lambda *s: torch.randn(*s, dtype=torch.bfloat16) * 1.6)(D, 3 * D)),
            "wo": _w((lambda *s: torch.randn(*s, dtype=torch.bfloat16) * 0.1)(D, D)),
        }
    _A_in = _A_setup()

    def _B_setup():
        B, S, D, F = 1, 2048, 1024, 3584
        return {
            "x": _w((lambda *s: torch.randn(*s, dtype=torch.bfloat16) * 0.05)(B, S, D)),
            "w_gate": _w((lambda *s: torch.randn(*s, dtype=torch.bfloat16) * 0.4)(D, F)),
            "w_up": _w((lambda *s: torch.randn(*s, dtype=torch.bfloat16) * 0.4)(D, F)),
            "w_down": _w((lambda *s: torch.randn(*s, dtype=torch.bfloat16) * 0.4)(F, D)),
        }
    _B_in = _B_setup()

    return {
        "A_x": _A_in["x"],
        "A_wqkv": _A_in["wqkv"],
        "A_wo": _A_in["wo"],
        "B_x": _B_in["x"],
        "B_w_gate": _B_in["w_gate"],
        "B_w_up": _B_in["w_up"],
        "B_w_down": _B_in["w_down"],
        "gate_w": _w((lambda *s: torch.randn(*s, dtype=torch.bfloat16) * 0.05)(1024) * 16.0),
    }

def reference(A_x, A_wqkv, A_wo, B_x, B_w_gate, B_w_up, B_w_down, gate_w):
    def _A_ref(x, wqkv, wo):
        B, S, D = x.shape
        H = 32; Dh = D // H; W = 256
        qkv = (lambda x, *d: x.permute(*d))((x @ wqkv).reshape(B, S, 3, H, Dh), 2, 0, 3, 1, 4)
        q, k, v = qkv[0], qkv[1], qkv[2]
        scores = torch.einsum("bhqd,bhkd->bhqk", q, k) * (Dh ** -0.5)
        idx = torch.arange(S)
        mask = (idx[:, None] - idx[None, :] >= 0) & (idx[:, None] - idx[None, :] < W)
        scores = torch.where(mask[None, None], scores, -1e9)
        p = _softmax(scores, axis=-1)
        o = torch.einsum("bhqk,bhkd->bhqd", p, v)
        return (lambda x, *d: x.permute(*d))(o, 0, 2, 1, 3).reshape(B, S, D) @ wo

    def _B_ref(x, w_gate, w_up, w_down):
        g = _silu(x @ w_gate)
        u = x @ w_up
        return (g * u) @ w_down

    x = A_x
    g = _sigmoid((x * gate_w).sum(-1, keepdims=True))
    a = _A_ref(x, A_wqkv, A_wo)
    b = _B_ref(x, B_w_gate, B_w_up, B_w_down)
    return g * a + (1 - g) * b
```

```asm
; @launch grid=(256,1,1) block=(512,1,1) lds=163840
.amdgcn_target "amdgcn-amd-amdhsa--gfx950"
.text
.globl gated_mix__sliding_block__swiglu_ffn__prompt_kernel
.p2align 8
.type gated_mix__sliding_block__swiglu_ffn__prompt_kernel,@function
gated_mix__sliding_block__swiglu_ffn__prompt_kernel:
    s_cmp_ge_u32 s2, 256
    s_cbranch_scc1 L_end
    s_load_dwordx16 s[64:79], s[0:1], 0
    s_load_dwordx4 s[80:83], s[0:1], 64
    s_load_dwordx2 s[84:85], s[0:1], 80
    s_getpc_b64 s[56:57]
LA_pc0:
    s_sub_u32 s56, s56, LA_pc0-gated_mix__sliding_block__swiglu_ffn__prompt_kernel
    s_subb_u32 s57, s57, 0
    s_lshr_b32 s58, s2, 3
    s_lshl_b32 s58, s58, 7
    v_lshlrev_b32 v26, 12, v0
    v_add_u32 v26, s58, v26
    v_cmp_gt_u32 vcc, LZ_end-gated_mix__sliding_block__swiglu_ffn__prompt_kernel-4, v26
    v_mov_b32 v27, s57
    s_and_saveexec_b64 s[58:59], vcc
    s_cbranch_execz LA_nopc
    v_add_co_u32 v26, vcc, s56, v26
    s_nop 1
    v_addc_co_u32 v27, vcc, 0, v27, vcc
    global_load_dword v18, v[26:27], off
LA_nopc:
    s_mov_b64 exec, -1
    v_lshrrev_b32 v26, 6, v0
    v_and_b32 v1, 63, v0
    v_readfirstlane_b32 s3, v26
    s_and_b32 s4, s2, 4
    s_lshr_b32 s56, s2, 6
    s_add_u32 s4, s4, s56
    s_and_b32 s5, s2, 3
    s_lshl_b32 s5, s5, 3
    s_bfe_u32 s56, s2, 0x30003
    s_add_u32 s5, s5, s56
    s_and_b32 s6, s3, 3
    s_lshr_b32 s7, s3, 2
    s_lshl_b32 s53, s4, 5
    s_add_u32 s53, s53, s5
    v_lshlrev_b32 v2, 4, v1
    v_lshrrev_b32 v26, 3, v1
    v_lshlrev_b32 v26, 11, v26
    v_lshrrev_b32 v27, 4, v1
    v_and_b32 v28, 7, v1
    v_xor_b32 v27, v27, v28
    v_lshl_add_u32 v4, v27, 4, v26
    v_xor_b32 v5, 64, v4
    v_add_u32 v6, 30720, v4
    v_add_u32 v7, 46080, v5
    v_add_u32 v5, 15360, v5
    v_lshrrev_b32 v26, 2, v1
    v_and_b32 v27, 0x13, v26
    v_and_b32 v28, 4, v26
    v_lshl_or_b32 v27, v28, 1, v27
    v_and_b32 v28, 8, v26
    v_lshrrev_b32 v28, 1, v28
    v_or_b32 v27, v27, v28
    v_mul_u32_u24 v27, 6144, v27
    v_lshrrev_b32 v26, 3, v1
    v_and_b32 v26, 2, v26
    v_and_b32 v28, 3, v1
    v_xor_b32 v26, v26, v28
    v_lshl_add_u32 v9, v26, 4, v27
    v_mul_u32_u24 v26, 4682, v0
    v_lshrrev_b32 v26, 16, v26
    v_mul_u32_u24 v29, 14, v26
    v_sub_u32 v29, v0, v29
    v_and_b32 v27, 0x13, v26
    v_and_b32 v28, 4, v26
    v_lshl_or_b32 v27, v28, 1, v27
    v_and_b32 v28, 8, v26
    v_lshrrev_b32 v28, 1, v28
    v_or_b32 v27, v27, v28
    v_mul_u32_u24 v27, 7168, v27
    v_lshl_add_u32 v8, v29, 4, v27
    s_lshl_b32 s36, s4, 19
    s_lshl_b32 s56, s3, 16
    s_add_u32 s36, s36, s56
    s_add_u32 s50, s36, 2048
    s_lshl_b32 s48, s3, 12
    s_mul_i32 s38, s5, 224
    s_sub_u32 s37, s38, 229376
    s_mov_b32 s39, s37
    s_mov_b32 s40, s38
    s_lshl_b32 s56, s3, 10
    s_add_u32 s42, s56, 71680
    s_add_u32 s43, s56, 92160
    s_add_u32 s44, s56, 78848
    s_add_u32 s45, s56, 99328
    s_mov_b32 s47, 458752
    s_lshl_b32 s57, s5, 6
    s_add_u32 s46, s56, 65536
    s_and_b32 s58, s3, 1
    s_mul_i32 s58, s58, 98304
    s_lshr_b32 s59, s3, 1
    s_lshl_b32 s59, s59, 11
    s_add_u32 s58, s58, s59
    s_sub_u32 s41, s58, 196608
    s_cmp_eq_u32 s3, 6
    s_cselect_b32 s46, 0x15000, s46
    s_cselect_b32 s41, 0x0, s41
    s_cmp_eq_u32 s3, 7
    s_cselect_b32 s46, 0x16400, s46
    s_cselect_b32 s41, 0x19000, s41
    s_add_u32 s41, s41, s57
    s_waitcnt lgkmcnt(0)
    s_mov_b32 s8, s64
    s_and_b32 s9, s65, 0xffff
    s_mov_b32 s10, 0x400000
    s_mov_b32 s11, 0x20000
    s_add_u32 m0, s48, 0
    s_nop 0
    buffer_load_dwordx4 v4, s[8:11], s36 offen offset:0  lds
    s_add_u32 m0, s48, 0
    s_nop 0
    buffer_load_dwordx4 v5, s[8:11], s36 offen offset:1024  lds
    s_add_u32 m0, s48, 0
    s_nop 0
    buffer_load_dwordx4 v6, s[8:11], s36 offen offset:2048  lds
    s_add_u32 m0, s48, 0
    s_nop 0
    buffer_load_dwordx4 v7, s[8:11], s36 offen offset:3072  lds
    s_add_u32 s36, s36, 128
    s_mov_b32 s20, s66
    s_and_b32 s21, s67, 0xffff
    s_mov_b32 s22, 0x600000
    s_mov_b32 s23, 0x20000
    s_mov_b32 s12, s72
    s_and_b32 s13, s73, 0xffff
    s_mov_b32 s14, 0x700000
    s_mov_b32 s15, 0x20000
    s_mov_b32 s16, s74
    s_and_b32 s17, s75, 0xffff
    s_mov_b32 s18, 0x700000
    s_mov_b32 s19, 0x20000
    s_cmp_eq_u32 s3, 7
    s_cbranch_scc0 LA_not7
    s_mov_b32 s12, s20
    s_mov_b32 s13, s21
    s_mov_b32 s14, s22
    s_mov_b32 s16, s20
    s_mov_b32 s17, s21
    s_mov_b32 s18, s22
    s_mov_b32 s42, 0x15400
    s_add_u32 s37, s57, 0x18000
    s_mov_b32 s43, 0x15800
    s_add_u32 s38, s57, 0x800
    s_mov_b32 s44, 0x15c00
    s_add_u32 s39, s57, 0x18800
    s_mov_b32 s45, 0x16000
    s_add_u32 s40, s57, 0x1000
    s_mov_b32 s47, 393216
    v_mov_b32 v8, v9
LA_not7:
    s_add_u32 m0, s42, 0
    s_cmp_lt_i32 s37, 0
    s_cbranch_scc1 LA_skipw0
    buffer_load_dwordx4 v8, s[12:15], s37 offen nt  lds
LA_skipw0:
    s_add_u32 s37, s37, s47
    s_add_u32 m0, s43, 0
    s_cmp_lt_i32 s38, 0
    s_cbranch_scc1 LA_skipw1
    buffer_load_dwordx4 v8, s[12:15], s38 offen nt  lds
LA_skipw1:
    s_add_u32 s38, s38, s47
    s_add_u32 m0, s44, 0
    s_cmp_lt_i32 s39, 0
    s_cbranch_scc1 LA_skipw2
    buffer_load_dwordx4 v8, s[16:19], s39 offen nt  lds
LA_skipw2:
    s_add_u32 s39, s39, s47
    s_add_u32 m0, s45, 0
    s_cmp_lt_i32 s40, 0
    s_cbranch_scc1 LA_skipw3
    buffer_load_dwordx4 v8, s[16:19], s40 offen nt  lds
LA_skipw3:
    s_add_u32 s40, s40, s47
    s_add_u32 m0, s46, 0
    s_cmp_lt_i32 s41, 0
    s_cbranch_scc1 LA_skipw4
    buffer_load_dwordx4 v9, s[20:23], s41 offen nt  lds
LA_skipw4:
    s_add_u32 s41, s41, 393216
    s_mov_b32 s24, s84
    s_and_b32 s25, s85, 0xffff
    s_mov_b32 s26, 0x4000000
    s_mov_b32 s27, 0x20000
    s_mov_b32 s28, s82
    s_and_b32 s29, s83, 0xffff
    s_mov_b32 s30, 0x100
    s_mov_b32 s31, 0x20000
    s_mov_b32 s32, s78
    s_and_b32 s33, s79, 0xffff
    s_mov_b32 s34, 0x800
    s_mov_b32 s35, 0x20000
    s_lshr_b32 s57, s2, 3
    s_lshr_b32 s58, s5, 3
    v_lshlrev_b32 v3, 7, v1
    s_mov_b32 s59, 0
    s_mov_b32 s49, 0
    s_mov_b32 s51, 0
    s_mov_b32 s52, 0
    s_mov_b32 s62, s64
    s_mov_b32 s63, s65
    s_cmp_lg_u32 s3, 6
    s_cbranch_scc1 LA_pf6
    s_mov_b32 s62, s64
    s_mov_b32 s63, s65
    s_mov_b32 s49, 0x400000
    v_and_b32 v26, 31, v1
    v_lshlrev_b32 v26, 11, v26
    v_lshrrev_b32 v3, 5, v1
    v_lshl_add_u32 v3, v3, 7, v26
    s_and_b32 s60, s5, 7
    s_lshl_b32 s60, s60, 16
    s_lshl_b32 s51, s4, 19
    s_add_u32 s51, s51, s60
    s_add_u32 s51, s51, 384
    s_mov_b32 s52, 128
    s_mov_b32 s59, 32
LA_pf6:
    s_cmp_lg_u32 s3, 1
    s_cbranch_scc1 LA_pf1
    s_mov_b32 s62, s72
    s_mov_b32 s63, s73
    s_mov_b32 s49, 0x700000
    v_mul_u32_u24 v26, 4682, v1
    v_lshrrev_b32 v26, 16, v26
    v_mul_u32_u24 v27, 5376, v26
    v_add_u32 v3, v3, v27
    v_lshrrev_b32 v26, 1, v26
    v_mul_u32_u24 v26, 444416, v26
    v_add_u32 v3, v3, v26
    s_mul_i32 s51, s57, 14336
    s_mul_i32 s60, s58, 1792
    s_add_u32 s51, s51, s60
    s_add_u32 s51, s51, 1146880
    s_mov_b32 s52, 458752
    s_mov_b32 s59, 28
LA_pf1:
    s_cmp_lg_u32 s3, 2
    s_cbranch_scc1 LA_pf2
    s_mov_b32 s62, s74
    s_mov_b32 s63, s75
    s_mov_b32 s49, 0x700000
    v_mul_u32_u24 v26, 4682, v1
    v_lshrrev_b32 v26, 16, v26
    v_mul_u32_u24 v27, 5376, v26
    v_add_u32 v3, v3, v27
    v_lshrrev_b32 v26, 1, v26
    v_mul_u32_u24 v26, 444416, v26
    v_add_u32 v3, v3, v26
    s_mul_i32 s51, s57, 14336
    s_mul_i32 s60, s58, 1792
    s_add_u32 s51, s51, s60
    s_add_u32 s51, s51, 1146880
    s_mov_b32 s52, 458752
    s_mov_b32 s59, 28
LA_pf2:
    s_cmp_lg_u32 s3, 3
    s_cbranch_scc1 LA_pf3
    s_mov_b32 s62, s66
    s_mov_b32 s63, s67
    s_mov_b32 s49, 0x600000
    v_lshrrev_b32 v26, 2, v1
    v_lshlrev_b32 v26, 11, v26
    v_and_b32 v3, 3, v1
    v_lshl_add_u32 v3, v3, 7, v26
    v_cmp_le_u32 vcc, 24, v1
    v_add_u32 v26, 380928, v3
    s_nop 0
    v_cndmask_b32 v3, v3, v26, vcc
    s_mul_i32 s51, s57, 12288
    s_lshl_b32 s60, s58, 9
    s_add_u32 s51, s51, s60
    s_add_u32 s51, s51, 983040
    s_mov_b32 s52, 393216
    s_mov_b32 s59, 24
LA_pf3:
    s_cmp_lg_u32 s3, 4
    s_cbranch_scc1 LA_pf4
    s_mov_b32 s62, s76
    s_mov_b32 s63, s77
    s_mov_b32 s49, 0x700000
    s_mul_i32 s51, s53, 3072
    s_mov_b32 s52, 786432
    s_mov_b32 s59, 24
    s_sub_u32 s51, s51, 3145728
LA_pf4:
    s_cmp_lg_u32 s3, 5
    s_cbranch_scc1 LA_pf5
    s_mov_b32 s62, s68
    s_mov_b32 s63, s69
    s_mov_b32 s49, 0x200000
    s_mul_i32 s51, s53, 2048
    s_mov_b32 s52, 524288
    s_mov_b32 s59, 16
    s_sub_u32 s51, s51, 2097152
LA_pf5:
    v_cmp_gt_u32 vcc, s59, v1
    v_bfrev_b32 v26, 1
    s_nop 0
    v_cndmask_b32 v3, v26, v3, vcc
    s_mov_b32 s32, s62
    s_and_b32 s33, s63, 0xffff
    s_mov_b32 s34, s49
    s_add_u32 m0, s42, 40960
    s_nop 0
    buffer_load_dwordx4 v8, s[12:15], s37 offen  lds
    s_add_u32 s37, s37, s47
    s_add_u32 m0, s44, 40960
    s_nop 0
    buffer_load_dwordx4 v8, s[16:19], s39 offen  lds
    s_add_u32 s39, s39, s47
    s_add_u32 m0, s46, 40960
    s_nop 0
    buffer_load_dwordx4 v9, s[20:23], s41 offen  lds
    s_add_u32 s41, s41, 393216
    v_and_b32 v26, 15, v1
    s_lshl_b32 s56, s6, 6
    v_add_u32 v26, s56, v26
    v_lshlrev_b32 v26, 7, v26
    v_lshrrev_b32 v27, 4, v1
    v_bfe_u32 v28, v1, 1, 3
    v_xor_b32 v28, v27, v28
    v_lshl_add_u32 v10, v28, 4, v26
    v_xor_b32 v11, 64, v10
    v_bfe_u32 v26, v1, 2, 3
    v_lshrrev_b32 v27, 5, v1
    v_lshl_add_u32 v26, v27, 4, v26
    v_and_b32 v27, 3, v1
    v_lshlrev_b32 v27, 3, v27
    v_add_u32 v27, 65536, v27
    v_mul_u32_u24 v12, 224, v26
    v_add_u32 v12, v12, v27
    v_add_u32 v13, 40960, v12
    v_lshl_add_u32 v14, v26, 6, v27
    v_bfe_u32 v28, v1, 4, 1
    v_lshl_add_u32 v14, v28, 5, v14
    v_xor_b32 v15, 32, v14
    v_add_u32 v16, 40960, v14
    v_add_u32 v17, 40960, v15
    v_mov_b32 v96, 0
    v_mov_b32 v97, 0
    v_mov_b32 v98, 0
    v_mov_b32 v99, 0
    v_mov_b32 v100, 0
    v_mov_b32 v101, 0
    v_mov_b32 v102, 0
    v_mov_b32 v103, 0
    v_mov_b32 v104, 0
    v_mov_b32 v105, 0
    v_mov_b32 v106, 0
    v_mov_b32 v107, 0
    v_mov_b32 v108, 0
    v_mov_b32 v109, 0
    v_mov_b32 v110, 0
    v_mov_b32 v111, 0
    v_mov_b32 v112, 0
    v_mov_b32 v113, 0
    v_mov_b32 v114, 0
    v_mov_b32 v115, 0
    v_mov_b32 v116, 0
    v_mov_b32 v117, 0
    v_mov_b32 v118, 0
    v_mov_b32 v119, 0
    v_mov_b32 v120, 0
    v_mov_b32 v121, 0
    v_mov_b32 v122, 0
    v_mov_b32 v123, 0
    v_mov_b32 v124, 0
    v_mov_b32 v125, 0
    v_mov_b32 v126, 0
    v_mov_b32 v127, 0
    v_mov_b32 v128, 0
    v_mov_b32 v129, 0
    v_mov_b32 v130, 0
    v_mov_b32 v131, 0
    v_mov_b32 v132, 0
    v_mov_b32 v133, 0
    v_mov_b32 v134, 0
    v_mov_b32 v135, 0
    v_mov_b32 v136, 0
    v_mov_b32 v137, 0
    v_mov_b32 v138, 0
    v_mov_b32 v139, 0
    v_mov_b32 v140, 0
    v_mov_b32 v141, 0
    v_mov_b32 v142, 0
    v_mov_b32 v143, 0
    v_mov_b32 v144, 0
    v_mov_b32 v145, 0
    v_mov_b32 v146, 0
    v_mov_b32 v147, 0
    v_mov_b32 v148, 0
    v_mov_b32 v149, 0
    v_mov_b32 v150, 0
    v_mov_b32 v151, 0
    v_mov_b32 v152, 0
    v_mov_b32 v153, 0
    v_mov_b32 v154, 0
    v_mov_b32 v155, 0
    v_mov_b32 v156, 0
    v_mov_b32 v157, 0
    v_mov_b32 v158, 0
    v_mov_b32 v159, 0
    v_mov_b32 v160, 0
    v_mov_b32 v161, 0
    v_mov_b32 v162, 0
    v_mov_b32 v163, 0
    v_mov_b32 v164, 0
    v_mov_b32 v165, 0
    v_mov_b32 v166, 0
    v_mov_b32 v167, 0
    v_mov_b32 v168, 0
    v_mov_b32 v169, 0
    v_mov_b32 v170, 0
    v_mov_b32 v171, 0
    v_mov_b32 v172, 0
    v_mov_b32 v173, 0
    v_mov_b32 v174, 0
    v_mov_b32 v175, 0
    v_mov_b32 v176, 0
    v_mov_b32 v177, 0
    v_mov_b32 v178, 0
    v_mov_b32 v179, 0
    v_mov_b32 v180, 0
    v_mov_b32 v181, 0
    v_mov_b32 v182, 0
    v_mov_b32 v183, 0
    v_mov_b32 v184, 0
    v_mov_b32 v185, 0
    v_mov_b32 v186, 0
    v_mov_b32 v187, 0
    v_mov_b32 v188, 0
    v_mov_b32 v189, 0
    v_mov_b32 v190, 0
    v_mov_b32 v191, 0
    v_mov_b32 v192, 0
    v_mov_b32 v193, 0
    v_mov_b32 v194, 0
    v_mov_b32 v195, 0
    v_mov_b32 v196, 0
    v_mov_b32 v197, 0
    v_mov_b32 v198, 0
    v_mov_b32 v199, 0
    v_mov_b32 v200, 0
    v_mov_b32 v201, 0
    v_mov_b32 v202, 0
    v_mov_b32 v203, 0
    v_mov_b32 v204, 0
    v_mov_b32 v205, 0
    v_mov_b32 v206, 0
    v_mov_b32 v207, 0
    v_mov_b32 v208, 0
    v_mov_b32 v209, 0
    v_mov_b32 v210, 0
    v_mov_b32 v211, 0
    v_mov_b32 v212, 0
    v_mov_b32 v213, 0
    v_mov_b32 v214, 0
    v_mov_b32 v215, 0
    v_mov_b32 v216, 0
    v_mov_b32 v217, 0
    v_mov_b32 v218, 0
    v_mov_b32 v219, 0
    v_mov_b32 v220, 0
    v_mov_b32 v221, 0
    v_mov_b32 v222, 0
    v_mov_b32 v223, 0
    v_mov_b32 v224, 0
    v_mov_b32 v225, 0
    v_mov_b32 v226, 0
    v_mov_b32 v227, 0
    v_mov_b32 v228, 0
    v_mov_b32 v229, 0
    v_mov_b32 v230, 0
    v_mov_b32 v231, 0
    v_mov_b32 v232, 0
    v_mov_b32 v233, 0
    v_mov_b32 v234, 0
    v_mov_b32 v235, 0
    v_mov_b32 v236, 0
    v_mov_b32 v237, 0
    v_mov_b32 v238, 0
    v_mov_b32 v239, 0
    v_mov_b32 v240, 0
    v_mov_b32 v241, 0
    v_mov_b32 v242, 0
    v_mov_b32 v243, 0
    v_mov_b32 v244, 0
    v_mov_b32 v245, 0
    v_mov_b32 v246, 0
    v_mov_b32 v247, 0
    v_mov_b32 v248, 0
    v_mov_b32 v249, 0
    v_mov_b32 v250, 0
    v_mov_b32 v251, 0
    v_mov_b32 v252, 0
    v_mov_b32 v253, 0
    v_mov_b32 v254, 0
    v_mov_b32 v255, 0
    s_mov_b32 s70, 0xbfb8aa3b
    s_mov_b32 s71, 0xbfb8aa3b
    s_lshl_b32 s55, s53, 3
    s_add_u32 s55, s55, s3
    s_lshl_b32 s55, s55, 11
    v_mov_b32 v40, 0
    v_mov_b32 v41, 0
    v_mov_b32 v25, 0
    v_mov_b32 v43, 0x3f803f80
    v_lshlrev_b32 v42, 2, v1
    s_mov_b32 s50, 0
    s_mov_b32 s96, s78
    s_and_b32 s97, s79, 0xffff
    s_mov_b32 s98, 0x800
    s_mov_b32 s99, 0x20000
    s_mov_b32 s94, 1.0
    s_mov_b32 s95, 1.0
    s_waitcnt vmcnt(3)
    s_barrier
    s_cmp_eq_u32 s7, 1
    s_cbranch_scc1 LA_pre1
    ds_read_b128 v[64:67], v10 offset:0
    ds_read_b128 v[68:71], v10 offset:2048
    ds_read_b128 v[72:75], v10 offset:4096
    ds_read_b128 v[76:79], v10 offset:6144
    ds_read_b64_tr_b16 v[44:45], v14 offset:20480
    ds_read_b64_tr_b16 v[46:47], v14 offset:20992
    ds_read_b64_tr_b16 v[48:49], v15 offset:20480
    ds_read_b64_tr_b16 v[50:51], v15 offset:20992
    ds_read_b64_tr_b16 v[52:53], v14 offset:22528
    ds_read_b64_tr_b16 v[54:55], v14 offset:23040
    ds_read_b64_tr_b16 v[56:57], v15 offset:22528
    ds_read_b64_tr_b16 v[58:59], v15 offset:23040
    s_add_u32 m0, s43, 40960
    s_nop 0
    buffer_load_dwordx4 v8, s[12:15], s38 offen  lds
    s_add_u32 s38, s38, s47
    s_add_u32 m0, s45, 40960
    s_nop 0
    buffer_load_dwordx4 v8, s[16:19], s40 offen  lds
    s_add_u32 s40, s40, s47
    s_add_u32 m0, s48, 32768
    s_nop 0
    buffer_load_dwordx4 v4, s[8:11], s36 offen offset:0  lds
    s_add_u32 m0, s48, 32768
    s_nop 0
    buffer_load_dwordx4 v5, s[8:11], s36 offen offset:1024  lds
    s_mov_b32 s49, 8
    s_mov_b32 s54, 0
    s_waitcnt lgkmcnt(0)
.p2align 6
LA_loop0:
    s_waitcnt lgkmcnt(8)
    v_mfma_f32_16x16x32_bf16 v[96:99], v[44:47], v[64:67], v[96:99]
    ds_read_b64_tr_b16 v[60:61], v12 offset:26624
    ds_read_b64_tr_b16 v[62:63], v12 offset:28416
    v_mfma_f32_16x16x32_bf16 v[100:103], v[44:47], v[68:71], v[100:103]
    s_waitcnt lgkmcnt(9)
    v_mfma_f32_16x16x32_bf16 v[104:107], v[44:47], v[72:75], v[104:107]
    s_waitcnt lgkmcnt(8)
    v_mfma_f32_16x16x32_bf16 v[108:111], v[44:47], v[76:79], v[108:111]
    s_waitcnt lgkmcnt(6)
    v_mfma_f32_16x16x32_bf16 v[124:127], v[48:51], v[76:79], v[124:127]
    ds_read_b64_tr_b16 v[44:45], v12 offset:33792
    ds_read_b64_tr_b16 v[46:47], v12 offset:35584
    v_mfma_f32_16x16x32_bf16 v[120:123], v[48:51], v[72:75], v[120:123]
    s_add_u32 m0, s48, 32768
    v_mfma_f32_16x16x32_bf16 v[116:119], v[48:51], v[68:71], v[116:119]
    buffer_load_dwordx4 v6, s[8:11], s36 offen offset:2048  lds
    v_mfma_f32_16x16x32_bf16 v[112:115], v[48:51], v[64:67], v[112:115]
    s_waitcnt lgkmcnt(6)
    v_mfma_f32_16x16x32_bf16 v[128:131], v[52:55], v[64:67], v[128:131]
    ds_read_b64_tr_b16 v[48:49], v12 offset:26656
    ds_read_b64_tr_b16 v[50:51], v12 offset:28448
    v_mfma_f32_16x16x32_bf16 v[132:135], v[52:55], v[68:71], v[132:135]
    v_mfma_f32_16x16x32_bf16 v[136:139], v[52:55], v[72:75], v[136:139]
    v_mfma_f32_16x16x32_bf16 v[140:143], v[52:55], v[76:79], v[140:143]
    s_waitcnt lgkmcnt(6)
    v_mfma_f32_16x16x32_bf16 v[156:159], v[56:59], v[76:79], v[156:159]
    ds_read_b64_tr_b16 v[52:53], v12 offset:33824
    ds_read_b64_tr_b16 v[54:55], v12 offset:35616
    v_mfma_f32_16x16x32_bf16 v[152:155], v[56:59], v[72:75], v[152:155]
    s_add_u32 m0, s48, 32768
    v_mfma_f32_16x16x32_bf16 v[148:151], v[56:59], v[68:71], v[148:151]
    buffer_load_dwordx4 v7, s[8:11], s36 offen offset:3072  lds
    s_add_u32 s36, s36, 128
    v_mfma_f32_16x16x32_bf16 v[144:147], v[56:59], v[64:67], v[144:147]
    s_waitcnt lgkmcnt(6)
    v_mfma_f32_16x16x32_bf16 v[160:163], v[60:63], v[64:67], v[160:163]
    ds_read_b64_tr_b16 v[56:57], v12 offset:26688
    ds_read_b64_tr_b16 v[58:59], v12 offset:28480
    v_mfma_f32_16x16x32_bf16 v[164:167], v[60:63], v[68:71], v[164:167]
    v_mfma_f32_16x16x32_bf16 v[168:171], v[60:63], v[72:75], v[168:171]
    v_mfma_f32_16x16x32_bf16 v[172:175], v[60:63], v[76:79], v[172:175]
    s_waitcnt lgkmcnt(6)
    v_mfma_f32_16x16x32_bf16 v[188:191], v[44:47], v[76:79], v[188:191]
    ds_read_b64_tr_b16 v[60:61], v12 offset:33856
    ds_read_b64_tr_b16 v[62:63], v12 offset:35648
    v_mfma_f32_16x16x32_bf16 v[184:187], v[44:47], v[72:75], v[184:187]
    ds_read_b128 v[80:83], v11 offset:0
    ds_read_b128 v[84:87], v11 offset:2048
    v_mfma_f32_16x16x32_bf16 v[180:183], v[44:47], v[68:71], v[180:183]
    buffer_load_dword v18, v3, s[32:35], s51 offen
    s_add_u32 s51, s51, s52
    v_mfma_f32_16x16x32_bf16 v[176:179], v[44:47], v[64:67], v[176:179]
    s_waitcnt lgkmcnt(8)
    v_mfma_f32_16x16x32_bf16 v[192:195], v[48:51], v[64:67], v[192:195]
    s_waitcnt vmcnt(5) lgkmcnt(2)
    s_barrier
    ds_read_b64_tr_b16 v[44:45], v16 offset:0
    ds_read_b64_tr_b16 v[46:47], v16 offset:512
    v_mfma_f32_16x16x32_bf16 v[196:199], v[48:51], v[68:71], v[196:199]
    ds_read_b128 v[88:91], v11 offset:4096
    ds_read_b128 v[92:95], v11 offset:6144
    v_mfma_f32_16x16x32_bf16 v[200:203], v[48:51], v[72:75], v[200:203]
    v_mfma_f32_16x16x32_bf16 v[204:207], v[48:51], v[76:79], v[204:207]
    v_mfma_f32_16x16x32_bf16 v[220:223], v[52:55], v[76:79], v[220:223]
    ds_read_b64_tr_b16 v[48:49], v17 offset:0
    ds_read_b64_tr_b16 v[50:51], v17 offset:512
    v_mfma_f32_16x16x32_bf16 v[216:219], v[52:55], v[72:75], v[216:219]
    s_add_u32 m0, s42, 0
    v_mfma_f32_16x16x32_bf16 v[212:215], v[52:55], v[68:71], v[212:215]
    buffer_load_dwordx4 v8, s[12:15], s37 offen  lds
    s_add_u32 s37, s37, s47
    v_mfma_f32_16x16x32_bf16 v[208:211], v[52:55], v[64:67], v[208:211]
    v_mfma_f32_16x16x32_bf16 v[224:227], v[56:59], v[64:67], v[224:227]
    ds_read_b64_tr_b16 v[52:53], v16 offset:2048
    ds_read_b64_tr_b16 v[54:55], v16 offset:2560
    v_mfma_f32_16x16x32_bf16 v[228:231], v[56:59], v[68:71], v[228:231]
    v_mfma_f32_16x16x32_bf16 v[232:235], v[56:59], v[72:75], v[232:235]
    v_mfma_f32_16x16x32_bf16 v[236:239], v[56:59], v[76:79], v[236:239]
    v_mfma_f32_16x16x32_bf16 v[252:255], v[60:63], v[76:79], v[252:255]
    ds_read_b64_tr_b16 v[56:57], v17 offset:2048
    ds_read_b64_tr_b16 v[58:59], v17 offset:2560
    v_mfma_f32_16x16x32_bf16 v[248:251], v[60:63], v[72:75], v[248:251]
    s_add_u32 m0, s43, 0
    v_mfma_f32_16x16x32_bf16 v[244:247], v[60:63], v[68:71], v[244:247]
    buffer_load_dwordx4 v8, s[12:15], s38 offen  lds
    s_add_u32 s38, s38, s47
    v_mfma_f32_16x16x32_bf16 v[240:243], v[60:63], v[64:67], v[240:243]
    s_waitcnt lgkmcnt(8)
    v_mfma_f32_16x16x32_bf16 v[96:99], v[44:47], v[80:83], v[96:99]
    ds_read_b64_tr_b16 v[60:61], v13 offset:6144
    ds_read_b64_tr_b16 v[62:63], v13 offset:7936
    v_mfma_f32_16x16x32_bf16 v[100:103], v[44:47], v[84:87], v[100:103]
    s_waitcnt lgkmcnt(9)
    v_mfma_f32_16x16x32_bf16 v[104:107], v[44:47], v[88:91], v[104:107]
    s_waitcnt lgkmcnt(8)
    v_mfma_f32_16x16x32_bf16 v[108:111], v[44:47], v[92:95], v[108:111]
    s_waitcnt lgkmcnt(6)
    v_mfma_f32_16x16x32_bf16 v[124:127], v[48:51], v[92:95], v[124:127]
    ds_read_b64_tr_b16 v[44:45], v13 offset:13312
    ds_read_b64_tr_b16 v[46:47], v13 offset:15104
    v_mfma_f32_16x16x32_bf16 v[120:123], v[48:51], v[88:91], v[120:123]
    s_add_u32 m0, s44, 0
    v_mfma_f32_16x16x32_bf16 v[116:119], v[48:51], v[84:87], v[116:119]
    buffer_load_dwordx4 v8, s[16:19], s39 offen  lds
    s_add_u32 s39, s39, s47
    v_mfma_f32_16x16x32_bf16 v[112:115], v[48:51], v[80:83], v[112:115]
    s_waitcnt lgkmcnt(6)
    v_mfma_f32_16x16x32_bf16 v[128:131], v[52:55], v[80:83], v[128:131]
    ds_read_b64_tr_b16 v[48:49], v13 offset:6176
    ds_read_b64_tr_b16 v[50:51], v13 offset:7968
    v_mfma_f32_16x16x32_bf16 v[132:135], v[52:55], v[84:87], v[132:135]
    v_mfma_f32_16x16x32_bf16 v[136:139], v[52:55], v[88:91], v[136:139]
    v_mfma_f32_16x16x32_bf16 v[140:143], v[52:55], v[92:95], v[140:143]
    s_waitcnt lgkmcnt(6)
    v_mfma_f32_16x16x32_bf16 v[156:159], v[56:59], v[92:95], v[156:159]
    ds_read_b64_tr_b16 v[52:53], v13 offset:13344
    ds_read_b64_tr_b16 v[54:55], v13 offset:15136
    v_mfma_f32_16x16x32_bf16 v[152:155], v[56:59], v[88:91], v[152:155]
    s_add_u32 m0, s45, 0
    v_mfma_f32_16x16x32_bf16 v[148:151], v[56:59], v[84:87], v[148:151]
    buffer_load_dwordx4 v8, s[16:19], s40 offen  lds
    s_add_u32 s40, s40, s47
    v_mfma_f32_16x16x32_bf16 v[144:147], v[56:59], v[80:83], v[144:147]
    s_waitcnt lgkmcnt(6)
    v_mfma_f32_16x16x32_bf16 v[160:163], v[60:63], v[80:83], v[160:163]
    ds_read_b64_tr_b16 v[56:57], v13 offset:6208
    ds_read_b64_tr_b16 v[58:59], v13 offset:8000
    v_mfma_f32_16x16x32_bf16 v[164:167], v[60:63], v[84:87], v[164:167]
    v_mfma_f32_16x16x32_bf16 v[168:171], v[60:63], v[88:91], v[168:171]
    v_mfma_f32_16x16x32_bf16 v[172:175], v[60:63], v[92:95], v[172:175]
    s_waitcnt lgkmcnt(6)
    v_mfma_f32_16x16x32_bf16 v[188:191], v[44:47], v[92:95], v[188:191]
    s_waitcnt vmcnt(5)
    s_barrier
    ds_read_b64_tr_b16 v[60:61], v13 offset:13376
    ds_read_b64_tr_b16 v[62:63], v13 offset:15168
    v_mfma_f32_16x16x32_bf16 v[184:187], v[44:47], v[88:91], v[184:187]
    ds_read_b128 v[64:67], v10 offset:32768
    ds_read_b128 v[68:71], v10 offset:34816
    s_add_u32 m0, s46, 0
    v_mfma_f32_16x16x32_bf16 v[180:183], v[44:47], v[84:87], v[180:183]
    buffer_load_dwordx4 v9, s[20:23], s41 offen  lds
    s_add_u32 s41, s41, 393216
    v_mfma_f32_16x16x32_bf16 v[176:179], v[44:47], v[80:83], v[176:179]
    s_waitcnt lgkmcnt(8)
    v_mfma_f32_16x16x32_bf16 v[192:195], v[48:51], v[80:83], v[192:195]
    ds_read_b64_tr_b16 v[44:45], v16 offset:20480
    ds_read_b64_tr_b16 v[46:47], v16 offset:20992
    v_mfma_f32_16x16x32_bf16 v[196:199], v[48:51], v[84:87], v[196:199]
    ds_read_b128 v[72:75], v10 offset:36864
    ds_read_b128 v[76:79], v10 offset:38912
    v_mfma_f32_16x16x32_bf16 v[200:203], v[48:51], v[88:91], v[200:203]
    v_mfma_f32_16x16x32_bf16 v[204:207], v[48:51], v[92:95], v[204:207]
    s_waitcnt lgkmcnt(10)
    v_mfma_f32_16x16x32_bf16 v[220:223], v[52:55], v[92:95], v[220:223]
    ds_read_b64_tr_b16 v[48:49], v17 offset:20480
    ds_read_b64_tr_b16 v[50:51], v17 offset:20992
    v_mfma_f32_16x16x32_bf16 v[216:219], v[52:55], v[88:91], v[216:219]
    s_add_u32 m0, s48, 0
    v_mfma_f32_16x16x32_bf16 v[212:215], v[52:55], v[84:87], v[212:215]
    buffer_load_dwordx4 v4, s[8:11], s36 offen offset:0  lds
    v_mfma_f32_16x16x32_bf16 v[208:211], v[52:55], v[80:83], v[208:211]
    s_waitcnt lgkmcnt(10)
    v_mfma_f32_16x16x32_bf16 v[224:227], v[56:59], v[80:83], v[224:227]
    ds_read_b64_tr_b16 v[52:53], v16 offset:22528
    ds_read_b64_tr_b16 v[54:55], v16 offset:23040
    v_mfma_f32_16x16x32_bf16 v[228:231], v[56:59], v[84:87], v[228:231]
    v_mfma_f32_16x16x32_bf16 v[232:235], v[56:59], v[88:91], v[232:235]
    v_mfma_f32_16x16x32_bf16 v[236:239], v[56:59], v[92:95], v[236:239]
    s_waitcnt lgkmcnt(10)
    v_mfma_f32_16x16x32_bf16 v[252:255], v[60:63], v[92:95], v[252:255]
    ds_read_b64_tr_b16 v[56:57], v17 offset:22528
    ds_read_b64_tr_b16 v[58:59], v17 offset:23040
    v_mfma_f32_16x16x32_bf16 v[248:251], v[60:63], v[88:91], v[248:251]
    s_add_u32 m0, s48, 0
    v_mfma_f32_16x16x32_bf16 v[244:247], v[60:63], v[84:87], v[244:247]
    buffer_load_dwordx4 v5, s[8:11], s36 offen offset:1024  lds
    v_mfma_f32_16x16x32_bf16 v[240:243], v[60:63], v[80:83], v[240:243]
    s_waitcnt lgkmcnt(8)
    v_mfma_f32_16x16x32_bf16 v[96:99], v[44:47], v[64:67], v[96:99]
    ds_read_b64_tr_b16 v[60:61], v13 offset:26624
    ds_read_b64_tr_b16 v[62:63], v13 offset:28416
    v_mfma_f32_16x16x32_bf16 v[100:103], v[44:47], v[68:71], v[100:103]
    s_waitcnt lgkmcnt(9)
    v_mfma_f32_16x16x32_bf16 v[104:107], v[44:47], v[72:75], v[104:107]
    s_waitcnt lgkmcnt(8)
    v_mfma_f32_16x16x32_bf16 v[108:111], v[44:47], v[76:79], v[108:111]
    s_waitcnt lgkmcnt(6)
    v_mfma_f32_16x16x32_bf16 v[124:127], v[48:51], v[76:79], v[124:127]
    ds_read_b64_tr_b16 v[44:45], v13 offset:33792
    ds_read_b64_tr_b16 v[46:47], v13 offset:35584
    v_mfma_f32_16x16x32_bf16 v[120:123], v[48:51], v[72:75], v[120:123]
    s_add_u32 m0, s48, 0
    v_mfma_f32_16x16x32_bf16 v[116:119], v[48:51], v[68:71], v[116:119]
    buffer_load_dwordx4 v6, s[8:11], s36 offen offset:2048  lds
    v_mfma_f32_16x16x32_bf16 v[112:115], v[48:51], v[64:67], v[112:115]
    s_waitcnt lgkmcnt(6)
    v_mfma_f32_16x16x32_bf16 v[128:131], v[52:55], v[64:67], v[128:131]
    ds_read_b64_tr_b16 v[48:49], v13 offset:26656
    ds_read_b64_tr_b16 v[50:51], v13 offset:28448
    v_mfma_f32_16x16x32_bf16 v[132:135], v[52:55], v[68:71], v[132:135]
    v_mfma_f32_16x16x32_bf16 v[136:139], v[52:55], v[72:75], v[136:139]
    v_mfma_f32_16x16x32_bf16 v[140:143], v[52:55], v[76:79], v[140:143]
    s_waitcnt lgkmcnt(6)
    v_mfma_f32_16x16x32_bf16 v[156:159], v[56:59], v[76:79], v[156:159]
    ds_read_b64_tr_b16 v[52:53], v13 offset:33824
    ds_read_b64_tr_b16 v[54:55], v13 offset:35616
    v_mfma_f32_16x16x32_bf16 v[152:155], v[56:59], v[72:75], v[152:155]
    s_add_u32 m0, s48, 0
    v_mfma_f32_16x16x32_bf16 v[148:151], v[56:59], v[68:71], v[148:151]
    buffer_load_dwordx4 v7, s[8:11], s36 offen offset:3072  lds
    s_add_u32 s36, s36, 128
    v_mfma_f32_16x16x32_bf16 v[144:147], v[56:59], v[64:67], v[144:147]
    s_waitcnt lgkmcnt(6)
    v_mfma_f32_16x16x32_bf16 v[160:163], v[60:63], v[64:67], v[160:163]
    ds_read_b64_tr_b16 v[56:57], v13 offset:26688
    ds_read_b64_tr_b16 v[58:59], v13 offset:28480
    v_mfma_f32_16x16x32_bf16 v[164:167], v[60:63], v[68:71], v[164:167]
    v_mfma_f32_16x16x32_bf16 v[168:171], v[60:63], v[72:75], v[168:171]
    v_mfma_f32_16x16x32_bf16 v[172:175], v[60:63], v[76:79], v[172:175]
    s_waitcnt lgkmcnt(6)
    v_mfma_f32_16x16x32_bf16 v[188:191], v[44:47], v[76:79], v[188:191]
    ds_read_b64_tr_b16 v[60:61], v13 offset:33856
    ds_read_b64_tr_b16 v[62:63], v13 offset:35648
    v_mfma_f32_16x16x32_bf16 v[184:187], v[44:47], v[72:75], v[184:187]
    ds_read_b128 v[80:83], v11 offset:32768
    ds_read_b128 v[84:87], v11 offset:34816
    v_mfma_f32_16x16x32_bf16 v[180:183], v[44:47], v[68:71], v[180:183]
    buffer_load_dword v18, v3, s[32:35], s51 offen
    s_add_u32 s51, s51, s52
    v_mfma_f32_16x16x32_bf16 v[176:179], v[44:47], v[64:67], v[176:179]
    s_waitcnt lgkmcnt(8)
    v_mfma_f32_16x16x32_bf16 v[192:195], v[48:51], v[64:67], v[192:195]
    s_waitcnt vmcnt(5) lgkmcnt(2)
    s_barrier
    ds_read_b64_tr_b16 v[44:45], v14 offset:0
    ds_read_b64_tr_b16 v[46:47], v14 offset:512
    v_mfma_f32_16x16x32_bf16 v[196:199], v[48:51], v[68:71], v[196:199]
    ds_read_b128 v[88:91], v11 offset:36864
    ds_read_b128 v[92:95], v11 offset:38912
    v_mfma_f32_16x16x32_bf16 v[200:203], v[48:51], v[72:75], v[200:203]
    v_mfma_f32_16x16x32_bf16 v[204:207], v[48:51], v[76:79], v[204:207]
    v_mfma_f32_16x16x32_bf16 v[220:223], v[52:55], v[76:79], v[220:223]
    ds_read_b64_tr_b16 v[48:49], v15 offset:0
    ds_read_b64_tr_b16 v[50:51], v15 offset:512
    v_mfma_f32_16x16x32_bf16 v[216:219], v[52:55], v[72:75], v[216:219]
    s_add_u32 m0, s42, 40960
    v_mfma_f32_16x16x32_bf16 v[212:215], v[52:55], v[68:71], v[212:215]
    buffer_load_dwordx4 v8, s[12:15], s37 offen  lds
    s_add_u32 s37, s37, s47
    v_mfma_f32_16x16x32_bf16 v[208:211], v[52:55], v[64:67], v[208:211]
    v_mfma_f32_16x16x32_bf16 v[224:227], v[56:59], v[64:67], v[224:227]
    ds_read_b64_tr_b16 v[52:53], v14 offset:2048
    ds_read_b64_tr_b16 v[54:55], v14 offset:2560
    v_mfma_f32_16x16x32_bf16 v[228:231], v[56:59], v[68:71], v[228:231]
    v_mfma_f32_16x16x32_bf16 v[232:235], v[56:59], v[72:75], v[232:235]
    v_mfma_f32_16x16x32_bf16 v[236:239], v[56:59], v[76:79], v[236:239]
    v_mfma_f32_16x16x32_bf16 v[252:255], v[60:63], v[76:79], v[252:255]
    ds_read_b64_tr_b16 v[56:57], v15 offset:2048
    ds_read_b64_tr_b16 v[58:59], v15 offset:2560
    v_mfma_f32_16x16x32_bf16 v[248:251], v[60:63], v[72:75], v[248:251]
    s_add_u32 m0, s43, 40960
    v_mfma_f32_16x16x32_bf16 v[244:247], v[60:63], v[68:71], v[244:247]
    buffer_load_dwordx4 v8, s[12:15], s38 offen  lds
    s_add_u32 s38, s38, s47
    v_mfma_f32_16x16x32_bf16 v[240:243], v[60:63], v[64:67], v[240:243]
    s_waitcnt lgkmcnt(8)
    v_mfma_f32_16x16x32_bf16 v[96:99], v[44:47], v[80:83], v[96:99]
    ds_read_b64_tr_b16 v[60:61], v12 offset:6144
    ds_read_b64_tr_b16 v[62:63], v12 offset:7936
    v_mfma_f32_16x16x32_bf16 v[100:103], v[44:47], v[84:87], v[100:103]
    s_waitcnt lgkmcnt(9)
    v_mfma_f32_16x16x32_bf16 v[104:107], v[44:47], v[88:91], v[104:107]
    s_waitcnt lgkmcnt(8)
    v_mfma_f32_16x16x32_bf16 v[108:111], v[44:47], v[92:95], v[108:111]
    s_waitcnt lgkmcnt(6)
    v_mfma_f32_16x16x32_bf16 v[124:127], v[48:51], v[92:95], v[124:127]
    ds_read_b64_tr_b16 v[44:45], v12 offset:13312
    ds_read_b64_tr_b16 v[46:47], v12 offset:15104
    v_mfma_f32_16x16x32_bf16 v[120:123], v[48:51], v[88:91], v[120:123]
    s_add_u32 m0, s44, 40960
    v_mfma_f32_16x16x32_bf16 v[116:119], v[48:51], v[84:87], v[116:119]
    buffer_load_dwordx4 v8, s[16:19], s39 offen  lds
    s_add_u32 s39, s39, s47
    v_mfma_f32_16x16x32_bf16 v[112:115], v[48:51], v[80:83], v[112:115]
    s_waitcnt lgkmcnt(6)
    v_mfma_f32_16x16x32_bf16 v[128:131], v[52:55], v[80:83], v[128:131]
    ds_read_b64_tr_b16 v[48:49], v12 offset:6176
    ds_read_b64_tr_b16 v[50:51], v12 offset:7968
    v_mfma_f32_16x16x32_bf16 v[132:135], v[52:55], v[84:87], v[132:135]
    v_mfma_f32_16x16x32_bf16 v[136:139], v[52:55], v[88:91], v[136:139]
    v_mfma_f32_16x16x32_bf16 v[140:143], v[52:55], v[92:95], v[140:143]
    s_waitcnt lgkmcnt(6)
    v_mfma_f32_16x16x32_bf16 v[156:159], v[56:59], v[92:95], v[156:159]
    ds_read_b64_tr_b16 v[52:53], v12 offset:13344
    ds_read_b64_tr_b16 v[54:55], v12 offset:15136
    v_mfma_f32_16x16x32_bf16 v[152:155], v[56:59], v[88:91], v[152:155]
    s_add_u32 m0, s45, 40960
    v_mfma_f32_16x16x32_bf16 v[148:151], v[56:59], v[84:87], v[148:151]
    buffer_load_dwordx4 v8, s[16:19], s40 offen  lds
    s_add_u32 s40, s40, s47
    v_mfma_f32_16x16x32_bf16 v[144:147], v[56:59], v[80:83], v[144:147]
    s_waitcnt lgkmcnt(6)
    v_mfma_f32_16x16x32_bf16 v[160:163], v[60:63], v[80:83], v[160:163]
    ds_read_b64_tr_b16 v[56:57], v12 offset:6208
    ds_read_b64_tr_b16 v[58:59], v12 offset:8000
    v_mfma_f32_16x16x32_bf16 v[164:167], v[60:63], v[84:87], v[164:167]
    v_mfma_f32_16x16x32_bf16 v[168:171], v[60:63], v[88:91], v[168:171]
    v_mfma_f32_16x16x32_bf16 v[172:175], v[60:63], v[92:95], v[172:175]
    s_waitcnt lgkmcnt(6)
    v_mfma_f32_16x16x32_bf16 v[188:191], v[44:47], v[92:95], v[188:191]
    s_waitcnt vmcnt(5)
    s_barrier
    ds_read_b64_tr_b16 v[60:61], v12 offset:13376
    ds_read_b64_tr_b16 v[62:63], v12 offset:15168
    v_mfma_f32_16x16x32_bf16 v[184:187], v[44:47], v[88:91], v[184:187]
    ds_read_b128 v[64:67], v10 offset:0
    ds_read_b128 v[68:71], v10 offset:2048
    s_add_u32 m0, s46, 40960
    v_mfma_f32_16x16x32_bf16 v[180:183], v[44:47], v[84:87], v[180:183]
    buffer_load_dwordx4 v9, s[20:23], s41 offen  lds
    s_add_u32 s41, s41, 393216
    v_mfma_f32_16x16x32_bf16 v[176:179], v[44:47], v[80:83], v[176:179]
    s_waitcnt lgkmcnt(8)
    v_mfma_f32_16x16x32_bf16 v[192:195], v[48:51], v[80:83], v[192:195]
    ds_read_b64_tr_b16 v[44:45], v14 offset:20480
    ds_read_b64_tr_b16 v[46:47], v14 offset:20992
    v_mfma_f32_16x16x32_bf16 v[196:199], v[48:51], v[84:87], v[196:199]
    ds_read_b128 v[72:75], v10 offset:4096
    ds_read_b128 v[76:79], v10 offset:6144
    v_mfma_f32_16x16x32_bf16 v[200:203], v[48:51], v[88:91], v[200:203]
    v_mfma_f32_16x16x32_bf16 v[204:207], v[48:51], v[92:95], v[204:207]
    s_waitcnt lgkmcnt(10)
    v_mfma_f32_16x16x32_bf16 v[220:223], v[52:55], v[92:95], v[220:223]
    ds_read_b64_tr_b16 v[48:49], v15 offset:20480
    ds_read_b64_tr_b16 v[50:51], v15 offset:20992
    v_mfma_f32_16x16x32_bf16 v[216:219], v[52:55], v[88:91], v[216:219]
    s_add_u32 m0, s48, 32768
    v_mfma_f32_16x16x32_bf16 v[212:215], v[52:55], v[84:87], v[212:215]
    buffer_load_dwordx4 v4, s[8:11], s36 offen offset:0  lds
    v_mfma_f32_16x16x32_bf16 v[208:211], v[52:55], v[80:83], v[208:211]
    s_waitcnt lgkmcnt(10)
    v_mfma_f32_16x16x32_bf16 v[224:227], v[56:59], v[80:83], v[224:227]
    ds_read_b64_tr_b16 v[52:53], v14 offset:22528
    ds_read_b64_tr_b16 v[54:55], v14 offset:23040
    v_mfma_f32_16x16x32_bf16 v[228:231], v[56:59], v[84:87], v[228:231]
    v_mfma_f32_16x16x32_bf16 v[232:235], v[56:59], v[88:91], v[232:235]
    v_mfma_f32_16x16x32_bf16 v[236:239], v[56:59], v[92:95], v[236:239]
    s_waitcnt lgkmcnt(10)
    v_mfma_f32_16x16x32_bf16 v[252:255], v[60:63], v[92:95], v[252:255]
    ds_read_b64_tr_b16 v[56:57], v15 offset:22528
    ds_read_b64_tr_b16 v[58:59], v15 offset:23040
    v_mfma_f32_16x16x32_bf16 v[248:251], v[60:63], v[88:91], v[248:251]
    s_add_u32 m0, s48, 32768
    v_mfma_f32_16x16x32_bf16 v[244:247], v[60:63], v[84:87], v[244:247]
    buffer_load_dwordx4 v5, s[8:11], s36 offen offset:1024  lds
    v_mfma_f32_16x16x32_bf16 v[240:243], v[60:63], v[80:83], v[240:243]
    s_sub_u32 s49, s49, 1
    v_lshlrev_b32 v20, 16, v40
    v_and_b32 v21, 0xffff0000, v40
    v_lshlrev_b32 v22, 16, v41
    v_and_b32 v23, 0xffff0000, v41
    v_pk_mul_f32 v[20:21], v[20:21], v[22:23]
    v_cvt_pk_bf16_f32 v24, v20, v21
    v_dot2_f32_bf16 v25, v24, v43, v25
    buffer_load_dword v40, v42, s[8:11], s55 offen
    buffer_load_dword v41, v42, s[96:99], s50 offen
    s_add_u32 s55, s55, 256
    s_add_u32 s50, s50, 256
    s_cmp_lg_u32 s49, 1
    s_cbranch_scc1 LA_h1_0
    v_cmp_gt_u32 vcc, 128, v19
    s_nop 1
    s_cmp_eq_u64 vcc, 0
    s_cbranch_scc0 LA_slow0
LB_go0:
    buffer_load_dword v38, v42, s[8:11], s55 offen
    buffer_load_dword v39, v42, s[96:99], s50 offen
    s_waitcnt lgkmcnt(8)
    v_mfma_f32_16x16x32_bf16 v[96:99], v[44:47], v[64:67], v[96:99]
    ds_read_b64_tr_b16 v[60:61], v12 offset:26624
    ds_read_b64_tr_b16 v[62:63], v12 offset:28416
    v_mfma_f32_16x16x32_bf16 v[100:103], v[44:47], v[68:71], v[100:103]
    s_waitcnt lgkmcnt(9)
    v_mfma_f32_16x16x32_bf16 v[104:107], v[44:47], v[72:75], v[104:107]
    s_waitcnt lgkmcnt(8)
    v_mfma_f32_16x16x32_bf16 v[108:111], v[44:47], v[76:79], v[108:111]
    s_waitcnt lgkmcnt(6)
    v_mfma_f32_16x16x32_bf16 v[112:115], v[48:51], v[64:67], v[112:115]
    ds_read_b64_tr_b16 v[44:45], v12 offset:33792
    ds_read_b64_tr_b16 v[46:47], v12 offset:35584
    s_lshl_b32 s60, s53, 15
    s_add_u32 s60, s60, 0x1400000
    v_mfma_f32_16x16x32_bf16 v[116:119], v[48:51], v[68:71], v[116:119]
    s_add_u32 m0, s48, 32768
    v_mfma_f32_16x16x32_bf16 v[120:123], v[48:51], v[72:75], v[120:123]
    buffer_load_dwordx4 v6, s[8:11], s36 offen offset:2048  lds
    s_lshl_b32 s61, s6, 13
    v_add_u32 v34, s61, v2
    v_mfma_f32_16x16x32_bf16 v[124:127], v[48:51], v[76:79], v[124:127]
    s_add_u32 s61, s61, s60
    s_cmp_eq_u32 s4, 7
    s_cselect_b32 s61, 0x4000000, s61
    s_waitcnt lgkmcnt(6)
    v_mfma_f32_16x16x32_bf16 v[128:131], v[52:55], v[64:67], v[128:131]
    ds_read_b64_tr_b16 v[48:49], v12 offset:26656
    ds_read_b64_tr_b16 v[50:51], v12 offset:28448
    s_add_u32 s62, s61, 4096
    v_and_b32 v3, 31, v1
    v_mfma_f32_16x16x32_bf16 v[132:135], v[52:55], v[68:71], v[132:135]
    v_lshlrev_b32 v3, 4, v3
    v_lshrrev_b32 v37, 5, v1
    v_mfma_f32_16x16x32_bf16 v[136:139], v[52:55], v[72:75], v[136:139]
    v_mul_u32_u24 v37, 147456, v37
    v_add_u32 v3, v3, v37
    v_mfma_f32_16x16x32_bf16 v[140:143], v[52:55], v[76:79], v[140:143]
    s_lshl_b32 s56, s4, 4
    s_lshl_b32 s57, s6, 2
    s_waitcnt lgkmcnt(6)
    v_mfma_f32_16x16x32_bf16 v[144:147], v[56:59], v[64:67], v[144:147]
    ds_read_b64_tr_b16 v[52:53], v12 offset:33824
    ds_read_b64_tr_b16 v[54:55], v12 offset:35616
    s_add_u32 s56, s56, s57
    s_mul_i32 s92, s56, 147456
    v_mfma_f32_16x16x32_bf16 v[148:151], v[56:59], v[68:71], v[148:151]
    s_add_u32 m0, s48, 32768
    v_mfma_f32_16x16x32_bf16 v[152:155], v[56:59], v[72:75], v[152:155]
    buffer_load_dwordx4 v7, s[8:11], s36 offen offset:3072  lds
    s_add_u32 s36, s36, 128
    s_mul_i32 s56, s5, 3584
    s_add_u32 s92, s92, s56
    v_mfma_f32_16x16x32_bf16 v[156:159], v[56:59], v[76:79], v[156:159]
    s_lshr_b32 s56, s5, 3
    s_lshl_b32 s56, s56, 13
    s_waitcnt lgkmcnt(6)
    v_mfma_f32_16x16x32_bf16 v[160:163], v[60:63], v[64:67], v[160:163]
    ds_read_b64_tr_b16 v[56:57], v12 offset:26688
    ds_read_b64_tr_b16 v[58:59], v12 offset:28480
    s_add_u32 s92, s92, s56
    s_add_u32 s93, s92, 294912
    v_mfma_f32_16x16x32_bf16 v[164:167], v[60:63], v[68:71], v[164:167]
    s_lshl_b32 s63, s53, 9
    s_add_u32 s63, s63, 0x2c10000
    v_mfma_f32_16x16x32_bf16 v[168:171], v[60:63], v[72:75], v[168:171]
    v_mov_b32 v19, 1
    s_mov_b32 s100, 0
    v_mfma_f32_16x16x32_bf16 v[172:175], v[60:63], v[76:79], v[172:175]
    s_sub_u32 s59, s63, 16384
    s_waitcnt lgkmcnt(6)
    v_mfma_f32_16x16x32_bf16 v[176:179], v[44:47], v[64:67], v[176:179]
    ds_read_b64_tr_b16 v[60:61], v12 offset:33856
    ds_read_b64_tr_b16 v[62:63], v12 offset:35648
    v_mfma_f32_16x16x32_bf16 v[180:183], v[44:47], v[68:71], v[180:183]
    ds_read_b128 v[80:83], v11 offset:0
    ds_read_b128 v[84:87], v11 offset:2048
    v_mfma_f32_16x16x32_bf16 v[184:187], v[44:47], v[72:75], v[184:187]
    v_mfma_f32_16x16x32_bf16 v[188:191], v[44:47], v[76:79], v[188:191]
    s_waitcnt lgkmcnt(8)
    v_mfma_f32_16x16x32_bf16 v[192:195], v[48:51], v[64:67], v[192:195]
    s_waitcnt vmcnt(4) lgkmcnt(2)
    s_barrier
    ds_read_b64_tr_b16 v[44:45], v16 offset:0
    ds_read_b64_tr_b16 v[46:47], v16 offset:512
    v_mfma_f32_16x16x32_bf16 v[196:199], v[48:51], v[68:71], v[196:199]
    ds_read_b128 v[88:91], v11 offset:4096
    ds_read_b128 v[92:95], v11 offset:6144
    v_mfma_f32_16x16x32_bf16 v[200:203], v[48:51], v[72:75], v[200:203]
    v_mfma_f32_16x16x32_bf16 v[204:207], v[48:51], v[76:79], v[204:207]
    v_mfma_f32_16x16x32_bf16 v[208:211], v[52:55], v[64:67], v[208:211]
    ds_read_b64_tr_b16 v[48:49], v17 offset:0
    ds_read_b64_tr_b16 v[50:51], v17 offset:512
    v_mfma_f32_16x16x32_bf16 v[212:215], v[52:55], v[68:71], v[212:215]
    s_add_u32 m0, s42, 0
    v_mfma_f32_16x16x32_bf16 v[216:219], v[52:55], v[72:75], v[216:219]
    buffer_load_dwordx4 v8, s[12:15], s37 offen  lds
    s_add_u32 s37, s37, s47
    v_mfma_f32_16x16x32_bf16 v[220:223], v[52:55], v[76:79], v[220:223]
    v_mfma_f32_16x16x32_bf16 v[224:227], v[56:59], v[64:67], v[224:227]
    ds_read_b64_tr_b16 v[52:53], v16 offset:2048
    ds_read_b64_tr_b16 v[54:55], v16 offset:2560
    v_mfma_f32_16x16x32_bf16 v[228:231], v[56:59], v[68:71], v[228:231]
    s_add_u32 m0, s44, 0
    v_mfma_f32_16x16x32_bf16 v[232:235], v[56:59], v[72:75], v[232:235]
    buffer_load_dwordx4 v8, s[16:19], s39 offen  lds
    s_add_u32 s39, s39, s47
    v_mfma_f32_16x16x32_bf16 v[236:239], v[56:59], v[76:79], v[236:239]
    v_mfma_f32_16x16x32_bf16 v[240:243], v[60:63], v[64:67], v[240:243]
    ds_read_b64_tr_b16 v[56:57], v17 offset:2048
    ds_read_b64_tr_b16 v[58:59], v17 offset:2560
    v_mfma_f32_16x16x32_bf16 v[244:247], v[60:63], v[68:71], v[244:247]
    s_add_u32 m0, s46, 0
    v_mfma_f32_16x16x32_bf16 v[248:251], v[60:63], v[72:75], v[248:251]
    buffer_load_dwordx4 v9, s[20:23], s41 offen  lds
    s_add_u32 s41, s41, 393216
    v_mfma_f32_16x16x32_bf16 v[252:255], v[60:63], v[76:79], v[252:255]
    s_waitcnt lgkmcnt(8)
    v_mfma_f32_16x16x32_bf16 v[96:99], v[44:47], v[80:83], v[96:99]
    ds_read_b64_tr_b16 v[60:61], v13 offset:6144
    ds_read_b64_tr_b16 v[62:63], v13 offset:7936
    s_lshr_b32 s23, s5, 3
    s_and_b32 s36, s5, 7
    v_mfma_f32_16x16x32_bf16 v[100:103], v[44:47], v[84:87], v[100:103]
    s_lshl_b32 s56, s36, 8
    s_lshl_b32 s21, s3, 14
    s_waitcnt lgkmcnt(9)
    v_mfma_f32_16x16x32_bf16 v[104:107], v[44:47], v[88:91], v[104:107]
    s_add_u32 s21, s21, s56
    s_lshl_b32 s22, s3, 14
    s_waitcnt lgkmcnt(8)
    v_mfma_f32_16x16x32_bf16 v[108:111], v[44:47], v[92:95], v[108:111]
    s_add_u32 s22, s22, s56
    s_mul_i32 s56, s23, 1835008
    s_waitcnt lgkmcnt(6)
    v_mfma_f32_16x16x32_bf16 v[112:115], v[48:51], v[80:83], v[112:115]
    ds_read_b64_tr_b16 v[44:45], v13 offset:13312
    ds_read_b64_tr_b16 v[46:47], v13 offset:15104
    s_add_u32 s21, s21, s56
    s_lshl_b32 s56, s23, 19
    v_mfma_f32_16x16x32_bf16 v[116:119], v[48:51], v[84:87], v[116:119]
    s_add_u32 s22, s22, s56
    s_lshl_b32 s37, s3, 11
    v_mfma_f32_16x16x32_bf16 v[120:123], v[48:51], v[88:91], v[120:123]
    s_mov_b32 s12, s76
    s_and_b32 s13, s77, 0xffff
    v_mfma_f32_16x16x32_bf16 v[124:127], v[48:51], v[92:95], v[124:127]
    s_mov_b32 s14, 0x700000
    s_mov_b32 s15, 0x20000
    s_waitcnt lgkmcnt(6)
    v_mfma_f32_16x16x32_bf16 v[128:131], v[52:55], v[80:83], v[128:131]
    ds_read_b64_tr_b16 v[48:49], v13 offset:6176
    ds_read_b64_tr_b16 v[50:51], v13 offset:7968
    s_mov_b32 s32, s68
    s_and_b32 s33, s69, 0xffff
    s_mov_b32 s34, 0x200000
    v_mfma_f32_16x16x32_bf16 v[132:135], v[52:55], v[84:87], v[132:135]
    s_mov_b32 s35, 0x20000
    s_mov_b32 s8, s84
    s_and_b32 s9, s85, 0xffff
    v_mfma_f32_16x16x32_bf16 v[136:139], v[52:55], v[88:91], v[136:139]
    s_mov_b32 s10, 0x1200000
    s_mov_b32 s11, 0x20000
    s_mov_b32 s16, s80
    v_mfma_f32_16x16x32_bf16 v[140:143], v[52:55], v[92:95], v[140:143]
    s_and_b32 s17, s81, 0xffff
    s_mov_b32 s18, 0x400000
    s_mov_b32 s19, 0x20000
    s_waitcnt lgkmcnt(6)
    v_mfma_f32_16x16x32_bf16 v[144:147], v[56:59], v[80:83], v[144:147]
    ds_read_b64_tr_b16 v[52:53], v13 offset:13344
    ds_read_b64_tr_b16 v[54:55], v13 offset:15136
    s_lshl_b32 s56, s4, 4
    s_lshl_b32 s20, s3, 1
    s_add_u32 s56, s56, s20
    v_mfma_f32_16x16x32_bf16 v[148:151], v[56:59], v[84:87], v[148:151]
    s_mul_i32 s20, s56, 147456
    s_add_u32 s38, s20, 28672
    s_mul_i32 s56, s23, 36864
    v_mfma_f32_16x16x32_bf16 v[152:155], v[56:59], v[88:91], v[152:155]
    s_add_u32 s20, s20, s56
    v_mov_b32 v6, v2
    v_add_u32 v7, 147456, v2
    v_mfma_f32_16x16x32_bf16 v[156:159], v[56:59], v[92:95], v[156:159]
    v_lshrrev_b32 v26, 4, v1
    v_bfe_u32 v27, v1, 1, 3
    v_xor_b32 v27, v27, v26
    s_waitcnt lgkmcnt(6)
    v_mfma_f32_16x16x32_bf16 v[160:163], v[60:63], v[80:83], v[160:163]
    ds_read_b64_tr_b16 v[56:57], v13 offset:6208
    ds_read_b64_tr_b16 v[58:59], v13 offset:8000
    v_lshlrev_b32 v26, 11, v26
    v_lshl_add_u32 v26, v27, 5, v26
    v_and_b32 v27, 1, v1
    v_mfma_f32_16x16x32_bf16 v[164:167], v[60:63], v[84:87], v[164:167]
    v_lshl_add_u32 v4, v27, 4, v26
    v_xor_b32 v5, 128, v4
    v_add_u32 v5, 7168, v5
    v_mfma_f32_16x16x32_bf16 v[168:171], v[60:63], v[88:91], v[168:171]
    v_and_b32 v18, 7, v1
    v_lshlrev_b32 v18, 9, v18
    v_mfma_f32_16x16x32_bf16 v[172:175], v[60:63], v[92:95], v[172:175]
    s_waitcnt lgkmcnt(6)
    v_mfma_f32_16x16x32_bf16 v[176:179], v[44:47], v[80:83], v[176:179]
    ds_read_b64_tr_b16 v[60:61], v13 offset:13376
    ds_read_b64_tr_b16 v[62:63], v13 offset:15168
    v_mfma_f32_16x16x32_bf16 v[180:183], v[44:47], v[84:87], v[180:183]
    v_mfma_f32_16x16x32_bf16 v[184:187], v[44:47], v[88:91], v[184:187]
    v_mfma_f32_16x16x32_bf16 v[188:191], v[44:47], v[92:95], v[188:191]
    s_waitcnt lgkmcnt(6)
    v_mfma_f32_16x16x32_bf16 v[192:195], v[48:51], v[80:83], v[192:195]
    ds_read_b64_tr_b16 v[44:45], v16 offset:22528
    ds_read_b64_tr_b16 v[46:47], v16 offset:23040
    v_mfma_f32_16x16x32_bf16 v[196:199], v[48:51], v[84:87], v[196:199]
    v_mfma_f32_16x16x32_bf16 v[200:203], v[48:51], v[88:91], v[200:203]
    v_mfma_f32_16x16x32_bf16 v[204:207], v[48:51], v[92:95], v[204:207]
    s_waitcnt lgkmcnt(6)
    v_mfma_f32_16x16x32_bf16 v[208:211], v[52:55], v[80:83], v[208:211]
    s_waitcnt vmcnt(0) lgkmcnt(0)
    s_barrier
    ds_read_b64_tr_b16 v[48:49], v17 offset:22528
    ds_read_b64_tr_b16 v[50:51], v17 offset:23040
    v_mfma_f32_16x16x32_bf16 v[212:215], v[52:55], v[84:87], v[212:215]
    ds_read_b128 v[64:67], v10 offset:32768
    ds_read_b128 v[68:71], v10 offset:34816
    v_mfma_f32_16x16x32_bf16 v[216:219], v[52:55], v[88:91], v[216:219]
    v_mfma_f32_16x16x32_bf16 v[220:223], v[52:55], v[92:95], v[220:223]
    v_mfma_f32_16x16x32_bf16 v[224:227], v[56:59], v[80:83], v[224:227]
    ds_read_b64_tr_b16 v[52:53], v14 offset:2048
    ds_read_b64_tr_b16 v[54:55], v14 offset:2560
    v_lshlrev_b32 v20, 16, v40
    v_and_b32 v21, 0xffff0000, v40
    v_lshlrev_b32 v22, 16, v41
    v_mfma_f32_16x16x32_bf16 v[228:231], v[56:59], v[84:87], v[228:231]
    ds_read_b128 v[72:75], v10 offset:36864
    ds_read_b128 v[76:79], v10 offset:38912
    v_and_b32 v23, 0xffff0000, v41
    v_pk_mul_f32 v[20:21], v[20:21], v[22:23]
    v_cvt_pk_bf16_f32 v24, v20, v21
    v_mfma_f32_16x16x32_bf16 v[232:235], v[56:59], v[88:91], v[232:235]
    v_dot2_f32_bf16 v25, v24, v43, v25
    v_lshlrev_b32 v20, 16, v38
    v_and_b32 v21, 0xffff0000, v38
    v_mfma_f32_16x16x32_bf16 v[236:239], v[56:59], v[92:95], v[236:239]
    v_lshlrev_b32 v22, 16, v39
    v_and_b32 v23, 0xffff0000, v39
    v_pk_mul_f32 v[20:21], v[20:21], v[22:23]
    v_mfma_f32_16x16x32_bf16 v[240:243], v[60:63], v[80:83], v[240:243]
    ds_read_b64_tr_b16 v[56:57], v15 offset:2048
    ds_read_b64_tr_b16 v[58:59], v15 offset:2560
    v_cvt_pk_bf16_f32 v24, v20, v21
    v_dot2_f32_bf16 v25, v24, v43, v25
    s_nop 1
    v_mfma_f32_16x16x32_bf16 v[244:247], v[60:63], v[84:87], v[244:247]
    s_nop 1
    v_add_f32_dpp v25, v25, v25 quad_perm:[1,0,3,2] row_mask:0xf bank_mask:0xf
    s_nop 1
    v_add_f32_dpp v25, v25, v25 quad_perm:[2,3,0,1] row_mask:0xf bank_mask:0xf
    v_mfma_f32_16x16x32_bf16 v[248:251], v[60:63], v[88:91], v[248:251]
    s_nop 1
    v_add_f32_dpp v25, v25, v25 row_half_mirror row_mask:0xf bank_mask:0xf
    s_nop 1
    v_add_f32_dpp v25, v25, v25 row_mirror row_mask:0xf bank_mask:0xf
    v_mfma_f32_16x16x32_bf16 v[252:255], v[60:63], v[92:95], v[252:255]
    s_nop 1
    v_add_f32_dpp v25, v25, v25 row_bcast:15 row_mask:0xa bank_mask:0xf
    s_nop 1
    v_add_f32_dpp v25, v25, v25 row_bcast:31 row_mask:0xc bank_mask:0xf
    s_waitcnt lgkmcnt(7)
    v_mfma_f32_16x16x32_bf16 v[128:131], v[44:47], v[64:67], v[128:131]
    ds_read_b64_tr_b16 v[60:61], v13 offset:26624
    ds_read_b64_tr_b16 v[62:63], v13 offset:28416
    v_cvt_pk_bf16_f32 v20, v25, v25
    v_and_b32 v20, 0xffff0000, v20
    v_mul_f32 v20, 0xbfb8aa3b, v20
    v_exp_f32 v20, v20
    s_nop 0
    s_waitcnt lgkmcnt(8)
    v_mfma_f32_16x16x32_bf16 v[132:135], v[44:47], v[68:71], v[132:135]
    ds_read_b128 v[80:83], v11 offset:32768
    ds_read_b128 v[84:87], v11 offset:34816
    ds_read_b128 v[88:91], v11 offset:36864
    ds_read_b128 v[92:95], v11 offset:38912
    v_add_f32 v20, 1.0, v20
    v_rcp_f32 v20, v20
    s_nop 0
    v_cvt_pk_bf16_f32 v20, v20, v20
    v_and_b32 v20, 0xffff0000, v20
    s_waitcnt lgkmcnt(9)
    v_mfma_f32_16x16x32_bf16 v[136:139], v[44:47], v[72:75], v[136:139]
    s_lshl_b32 s56, s3, 2
    s_add_u32 s56, s56, 163776
    v_mov_b32 v21, s56
    s_mov_b32 exec_lo, 0
    s_brev_b32 exec_hi, 1
    ds_write_b32 v21, v20
    s_mov_b64 exec, -1
    s_waitcnt lgkmcnt(8)
    v_mfma_f32_16x16x32_bf16 v[140:143], v[44:47], v[76:79], v[140:143]
    v_mov_b32 v38, 96256
    v_mov_b32 v39, 0
    ds_write_b32 v38, v39
    ds_write_b32 v38, v39 offset:4
    ds_write_b32 v38, v39 offset:8
    v_mfma_f32_16x16x32_bf16 v[144:147], v[48:51], v[64:67], v[144:147]
    ds_read_b64_tr_b16 v[44:45], v13 offset:33792
    ds_read_b64_tr_b16 v[46:47], v13 offset:35584
    v_and_b32 v27, 15, v1
    v_lshlrev_b32 v27, 4, v27
    v_lshrrev_b32 v28, 5, v1
    v_lshl_add_u32 v27, v28, 8, v27
    v_bfe_u32 v28, v1, 4, 1
    v_mfma_f32_16x16x32_bf16 v[148:151], v[48:51], v[68:71], v[148:151]
    v_lshl_add_u32 v10, v28, 10, v27
    v_lshl_add_u32 v9, v28, 9, v27
    v_mul_u32_u24 v11, 147456, v28
    v_add_u32 v11, v11, v27
    s_lshl_b32 s56, s3, 12
    v_mfma_f32_16x16x32_bf16 v[152:155], v[48:51], v[72:75], v[152:155]
    v_add_u32 v8, s56, v10
    v_add_u32 v9, s56, v9
    s_mov_b32 s58, 147456
    s_lshl_b32 s56, s3, 11
    s_cmp_ge_u32 s3, 6
    s_cselect_b32 s57, 79872, s58
    s_add_u32 s56, s56, s57
    v_add_u32 v10, s56, v10
    s_lshl_b32 s56, s6, 12
    s_cmp_eq_u32 s6, 3
    s_cselect_b32 s57, 79872, s58
    s_add_u32 s56, s56, s57
    v_add_u32 v35, s56, v2
    v_mfma_f32_16x16x32_bf16 v[156:159], v[48:51], v[76:79], v[156:159]
    s_waitcnt lgkmcnt(5)
    v_mfma_f32_16x16x32_bf16 v[128:131], v[52:55], v[80:83], v[128:131]
    ds_read_b64_tr_b16 v[48:49], v12 offset:6144
    ds_read_b64_tr_b16 v[50:51], v12 offset:7936
    s_waitcnt lgkmcnt(6)
    v_mfma_f32_16x16x32_bf16 v[132:135], v[52:55], v[84:87], v[132:135]
    s_waitcnt lgkmcnt(5)
    v_mfma_f32_16x16x32_bf16 v[136:139], v[52:55], v[88:91], v[136:139]
    s_waitcnt lgkmcnt(4)
    v_mfma_f32_16x16x32_bf16 v[140:143], v[52:55], v[92:95], v[140:143]
    v_mfma_f32_16x16x32_bf16 v[144:147], v[56:59], v[80:83], v[144:147]
    s_waitcnt lgkmcnt(0)
    s_barrier
    ds_read_b64_tr_b16 v[52:53], v12 offset:13312
    ds_read_b64_tr_b16 v[54:55], v12 offset:15104
    v_mfma_f32_16x16x32_bf16 v[148:151], v[56:59], v[84:87], v[148:151]
    v_mfma_f32_16x16x32_bf16 v[152:155], v[56:59], v[88:91], v[152:155]
    v_mfma_f32_16x16x32_bf16 v[156:159], v[56:59], v[92:95], v[156:159]
    v_mfma_f32_16x16x32_bf16 v[160:163], v[60:63], v[64:67], v[160:163]
    ds_read_b64_tr_b16 v[56:57], v13 offset:26656
    ds_read_b64_tr_b16 v[58:59], v13 offset:28448
    v_cvt_pk_bf16_f32 v128, v128, v129
    v_cvt_pk_bf16_f32 v129, v130, v131
    v_cvt_pk_bf16_f32 v130, v144, v145
    v_cvt_pk_bf16_f32 v131, v146, v147
    buffer_store_dwordx4 v[128:131], v2, s[24:27], s61 offen offset:0 sc1
    v_mfma_f32_16x16x32_bf16 v[164:167], v[60:63], v[68:71], v[164:167]
    v_cvt_pk_bf16_f32 v132, v132, v133
    v_cvt_pk_bf16_f32 v133, v134, v135
    v_cvt_pk_bf16_f32 v134, v148, v149
    v_cvt_pk_bf16_f32 v135, v150, v151
    buffer_store_dwordx4 v[132:135], v2, s[24:27], s61 offen offset:1024 sc1
    v_mfma_f32_16x16x32_bf16 v[168:171], v[60:63], v[72:75], v[168:171]
    v_cvt_pk_bf16_f32 v136, v136, v137
    v_cvt_pk_bf16_f32 v137, v138, v139
    v_cvt_pk_bf16_f32 v138, v152, v153
    v_cvt_pk_bf16_f32 v139, v154, v155
    buffer_store_dwordx4 v[136:139], v2, s[24:27], s62 offen offset:0 sc1
    v_mfma_f32_16x16x32_bf16 v[172:175], v[60:63], v[76:79], v[172:175]
    v_cvt_pk_bf16_f32 v140, v140, v141
    v_cvt_pk_bf16_f32 v141, v142, v143
    v_cvt_pk_bf16_f32 v142, v156, v157
    v_cvt_pk_bf16_f32 v143, v158, v159
    buffer_store_dwordx4 v[140:143], v2, s[24:27], s62 offen offset:1024 sc1
    v_mfma_f32_16x16x32_bf16 v[176:179], v[44:47], v[64:67], v[176:179]
    ds_read_b64_tr_b16 v[60:61], v13 offset:33824
    ds_read_b64_tr_b16 v[62:63], v13 offset:35616
    ds_write_b128 v34, v[128:131] offset:32768
    ds_write_b128 v34, v[132:135] offset:33792
    ds_write_b128 v34, v[136:139] offset:36864
    ds_write_b128 v34, v[140:143] offset:37888
    s_cmp_lg_u32 s3, 0
    s_cbranch_scc1 LB_nog
    v_lshlrev_b32 v26, 2, v1
    v_add_u32 v27, 163776, v26
    s_mov_b64 exec, 0xff
    ds_read_b32 v27, v27
    s_waitcnt lgkmcnt(0)
    buffer_store_dword v27, v26, s[24:27], s63 offen sc1
    s_mov_b64 exec, -1
LB_nog:
    v_mfma_f32_16x16x32_bf16 v[180:183], v[44:47], v[68:71], v[180:183]
    v_mfma_f32_16x16x32_bf16 v[184:187], v[44:47], v[72:75], v[184:187]
    v_mfma_f32_16x16x32_bf16 v[188:191], v[44:47], v[76:79], v[188:191]
    v_mfma_f32_16x16x32_bf16 v[160:163], v[48:51], v[80:83], v[160:163]
    ds_read_b64_tr_b16 v[44:45], v12 offset:6176
    ds_read_b64_tr_b16 v[46:47], v12 offset:7968
    v_mfma_f32_16x16x32_bf16 v[164:167], v[48:51], v[84:87], v[164:167]
    v_mfma_f32_16x16x32_bf16 v[168:171], v[48:51], v[88:91], v[168:171]
    v_mfma_f32_16x16x32_bf16 v[172:175], v[48:51], v[92:95], v[172:175]
    s_waitcnt lgkmcnt(6)
    v_mfma_f32_16x16x32_bf16 v[176:179], v[52:55], v[80:83], v[176:179]
    ds_read_b64_tr_b16 v[48:49], v12 offset:13344
    ds_read_b64_tr_b16 v[50:51], v12 offset:15136
    v_mfma_f32_16x16x32_bf16 v[180:183], v[52:55], v[84:87], v[180:183]
    v_mfma_f32_16x16x32_bf16 v[184:187], v[52:55], v[88:91], v[184:187]
    v_mfma_f32_16x16x32_bf16 v[188:191], v[52:55], v[92:95], v[188:191]
    s_waitcnt lgkmcnt(6)
    v_mfma_f32_16x16x32_bf16 v[192:195], v[56:59], v[64:67], v[192:195]
    ds_read_b64_tr_b16 v[52:53], v13 offset:26688
    ds_read_b64_tr_b16 v[54:55], v13 offset:28480
    v_pk_mul_f32 v[26:27], v[160:161], s[70:71]
    v_pk_mul_f32 v[28:29], v[162:163], s[70:71]
    v_pk_mul_f32 v[30:31], v[164:165], s[70:71]
    v_pk_mul_f32 v[32:33], v[166:167], s[70:71]
    v_exp_f32 v26, v26
    v_mfma_f32_16x16x32_bf16 v[196:199], v[56:59], v[68:71], v[196:199]
    v_exp_f32 v27, v27
    v_exp_f32 v28, v28
    v_exp_f32 v29, v29
    v_exp_f32 v30, v30
    v_exp_f32 v31, v31
    v_mfma_f32_16x16x32_bf16 v[200:203], v[56:59], v[72:75], v[200:203]
    v_exp_f32 v32, v32
    v_exp_f32 v33, v33
    v_pk_mul_f32 v[160:161], v[160:161], v[176:177]
    v_pk_mul_f32 v[162:163], v[162:163], v[178:179]
    v_pk_mul_f32 v[164:165], v[164:165], v[180:181]
    v_mfma_f32_16x16x32_bf16 v[204:207], v[56:59], v[76:79], v[204:207]
    v_pk_mul_f32 v[166:167], v[166:167], v[182:183]
    v_pk_add_f32 v[26:27], v[26:27], s[94:95]
    v_pk_add_f32 v[28:29], v[28:29], s[94:95]
    v_pk_add_f32 v[30:31], v[30:31], s[94:95]
    v_pk_add_f32 v[32:33], v[32:33], s[94:95]
    s_waitcnt lgkmcnt(6)
    v_mfma_f32_16x16x32_bf16 v[208:211], v[60:63], v[64:67], v[208:211]
    ds_read_b64_tr_b16 v[56:57], v13 offset:33856
    ds_read_b64_tr_b16 v[58:59], v13 offset:35648
    v_rcp_f32 v26, v26
    v_rcp_f32 v27, v27
    v_rcp_f32 v28, v28
    v_rcp_f32 v29, v29
    v_rcp_f32 v30, v30
    v_mfma_f32_16x16x32_bf16 v[212:215], v[60:63], v[68:71], v[212:215]
    v_rcp_f32 v31, v31
    v_rcp_f32 v32, v32
    v_rcp_f32 v33, v33
    s_nop 0
    v_pk_mul_f32 v[160:161], v[160:161], v[26:27]
    v_mfma_f32_16x16x32_bf16 v[216:219], v[60:63], v[72:75], v[216:219]
    v_pk_mul_f32 v[162:163], v[162:163], v[28:29]
    v_pk_mul_f32 v[164:165], v[164:165], v[30:31]
    v_pk_mul_f32 v[166:167], v[166:167], v[32:33]
    v_cvt_pk_bf16_f32 v160, v160, v161
    v_cvt_pk_bf16_f32 v161, v162, v163
    v_mfma_f32_16x16x32_bf16 v[220:223], v[60:63], v[76:79], v[220:223]
    v_cvt_pk_bf16_f32 v162, v164, v165
    v_cvt_pk_bf16_f32 v163, v166, v167
    s_nop 1
    v_permlane32_swap_b32 v160, v162
    v_permlane32_swap_b32 v161, v163
    s_waitcnt lgkmcnt(6)
    v_mfma_f32_16x16x32_bf16 v[192:195], v[44:47], v[80:83], v[192:195]
    ds_read_b64_tr_b16 v[60:61], v12 offset:6208
    ds_read_b64_tr_b16 v[62:63], v12 offset:8000
    s_getreg_b32 s101, hwreg(HW_REG_IB_STS)
    s_and_b32 s101, s101, 0xc0000f
    s_or_b32 s101, s101, s100
    s_cmp_le_u32 s101, 0
    s_cbranch_scc1 LG_s0
LG_r0:
    v_mfma_f32_16x16x32_bf16 v[196:199], v[44:47], v[84:87], v[196:199]
    buffer_store_dwordx4 v[160:163], v3, s[24:27], s92 offen offset:0 sc1
    v_pk_mul_f32 v[26:27], v[168:169], s[70:71]
    v_pk_mul_f32 v[28:29], v[170:171], s[70:71]
    v_pk_mul_f32 v[30:31], v[172:173], s[70:71]
    v_pk_mul_f32 v[32:33], v[174:175], s[70:71]
    v_mfma_f32_16x16x32_bf16 v[200:203], v[44:47], v[88:91], v[200:203]
    v_exp_f32 v26, v26
    v_exp_f32 v27, v27
    v_exp_f32 v28, v28
    v_exp_f32 v29, v29
    v_exp_f32 v30, v30
    v_mfma_f32_16x16x32_bf16 v[204:207], v[44:47], v[92:95], v[204:207]
    v_exp_f32 v31, v31
    v_exp_f32 v32, v32
    v_exp_f32 v33, v33
    v_pk_mul_f32 v[168:169], v[168:169], v[184:185]
    v_pk_mul_f32 v[170:171], v[170:171], v[186:187]
    s_waitcnt lgkmcnt(6)
    v_mfma_f32_16x16x32_bf16 v[208:211], v[48:51], v[80:83], v[208:211]
    ds_read_b64_tr_b16 v[44:45], v12 offset:13376
    ds_read_b64_tr_b16 v[46:47], v12 offset:15168
    v_pk_mul_f32 v[172:173], v[172:173], v[188:189]
    v_pk_mul_f32 v[174:175], v[174:175], v[190:191]
    v_pk_add_f32 v[26:27], v[26:27], s[94:95]
    v_pk_add_f32 v[28:29], v[28:29], s[94:95]
    v_pk_add_f32 v[30:31], v[30:31], s[94:95]
    v_mfma_f32_16x16x32_bf16 v[212:215], v[48:51], v[84:87], v[212:215]
    v_pk_add_f32 v[32:33], v[32:33], s[94:95]
    v_rcp_f32 v26, v26
    v_rcp_f32 v27, v27
    v_rcp_f32 v28, v28
    v_rcp_f32 v29, v29
    v_mfma_f32_16x16x32_bf16 v[216:219], v[48:51], v[88:91], v[216:219]
    v_rcp_f32 v30, v30
    v_rcp_f32 v31, v31
    v_rcp_f32 v32, v32
    v_rcp_f32 v33, v33
    s_nop 0
    v_mfma_f32_16x16x32_bf16 v[220:223], v[48:51], v[92:95], v[220:223]
    v_pk_mul_f32 v[168:169], v[168:169], v[26:27]
    v_pk_mul_f32 v[170:171], v[170:171], v[28:29]
    v_pk_mul_f32 v[172:173], v[172:173], v[30:31]
    v_pk_mul_f32 v[174:175], v[174:175], v[32:33]
    v_cvt_pk_bf16_f32 v168, v168, v169
    s_waitcnt lgkmcnt(6)
    v_mfma_f32_16x16x32_bf16 v[224:227], v[52:55], v[64:67], v[224:227]
    ds_read_b64_tr_b16 v[48:49], v16 offset:20480
    ds_read_b64_tr_b16 v[50:51], v16 offset:20992
    v_cvt_pk_bf16_f32 v169, v170, v171
    v_cvt_pk_bf16_f32 v170, v172, v173
    v_cvt_pk_bf16_f32 v171, v174, v175
    s_nop 1
    v_permlane32_swap_b32 v168, v170
    v_mfma_f32_16x16x32_bf16 v[228:231], v[52:55], v[68:71], v[228:231]
    v_permlane32_swap_b32 v169, v171
    s_getreg_b32 s101, hwreg(HW_REG_IB_STS)
    s_and_b32 s101, s101, 0xc0000f
    s_or_b32 s101, s101, s100
    s_cmp_le_u32 s101, 1
    s_cbranch_scc1 LG_s1
LG_r1:
    v_mfma_f32_16x16x32_bf16 v[232:235], v[52:55], v[72:75], v[232:235]
    buffer_store_dwordx4 v[168:171], v3, s[24:27], s93 offen offset:0 sc1
    v_pk_mul_f32 v[26:27], v[192:193], s[70:71]
    v_pk_mul_f32 v[28:29], v[194:195], s[70:71]
    v_pk_mul_f32 v[30:31], v[196:197], s[70:71]
    v_pk_mul_f32 v[32:33], v[198:199], s[70:71]
    v_mfma_f32_16x16x32_bf16 v[236:239], v[52:55], v[76:79], v[236:239]
    v_exp_f32 v26, v26
    v_exp_f32 v27, v27
    v_exp_f32 v28, v28
    v_exp_f32 v29, v29
    v_exp_f32 v30, v30
    s_waitcnt lgkmcnt(6)
    v_mfma_f32_16x16x32_bf16 v[240:243], v[56:59], v[64:67], v[240:243]
    ds_read_b64_tr_b16 v[52:53], v17 offset:20480
    ds_read_b64_tr_b16 v[54:55], v17 offset:20992
    v_exp_f32 v31, v31
    v_exp_f32 v32, v32
    v_exp_f32 v33, v33
    v_pk_mul_f32 v[192:193], v[192:193], v[208:209]
    v_pk_mul_f32 v[194:195], v[194:195], v[210:211]
    v_mfma_f32_16x16x32_bf16 v[244:247], v[56:59], v[68:71], v[244:247]
    v_pk_mul_f32 v[196:197], v[196:197], v[212:213]
    v_pk_mul_f32 v[198:199], v[198:199], v[214:215]
    v_pk_add_f32 v[26:27], v[26:27], s[94:95]
    v_pk_add_f32 v[28:29], v[28:29], s[94:95]
    v_pk_add_f32 v[30:31], v[30:31], s[94:95]
    v_mfma_f32_16x16x32_bf16 v[248:251], v[56:59], v[72:75], v[248:251]
    v_pk_add_f32 v[32:33], v[32:33], s[94:95]
    v_rcp_f32 v26, v26
    v_rcp_f32 v27, v27
    v_rcp_f32 v28, v28
    v_rcp_f32 v29, v29
    v_mfma_f32_16x16x32_bf16 v[252:255], v[56:59], v[76:79], v[252:255]
    v_rcp_f32 v30, v30
    v_rcp_f32 v31, v31
    v_rcp_f32 v32, v32
    v_rcp_f32 v33, v33
    s_nop 0
    s_waitcnt lgkmcnt(6)
    v_mfma_f32_16x16x32_bf16 v[224:227], v[60:63], v[80:83], v[224:227]
    ds_read_b64_tr_b16 v[56:57], v14 offset:0
    ds_read_b64_tr_b16 v[58:59], v14 offset:512
    buffer_load_dword v36, off, s[24:27], s59 offset:128 sc1
    v_pk_mul_f32 v[192:193], v[192:193], v[26:27]
    v_pk_mul_f32 v[194:195], v[194:195], v[28:29]
    v_pk_mul_f32 v[196:197], v[196:197], v[30:31]
    v_pk_mul_f32 v[198:199], v[198:199], v[32:33]
    v_cvt_pk_bf16_f32 v192, v192, v193
    v_mfma_f32_16x16x32_bf16 v[228:231], v[60:63], v[84:87], v[228:231]
    v_cvt_pk_bf16_f32 v193, v194, v195
    v_cvt_pk_bf16_f32 v194, v196, v197
    v_cvt_pk_bf16_f32 v195, v198, v199
    s_nop 1
    v_permlane32_swap_b32 v192, v194
    v_mfma_f32_16x16x32_bf16 v[232:235], v[60:63], v[88:91], v[232:235]
    v_permlane32_swap_b32 v193, v195
    s_getreg_b32 s101, hwreg(HW_REG_IB_STS)
    s_and_b32 s101, s101, 0xc0000f
    s_or_b32 s101, s101, s100
    s_cmp_le_u32 s101, 2
    s_cbranch_scc1 LG_s2
LG_r2:
    v_mfma_f32_16x16x32_bf16 v[236:239], v[60:63], v[92:95], v[236:239]
    v_pk_mul_f32 v[26:27], v[200:201], s[70:71]
    v_pk_mul_f32 v[28:29], v[202:203], s[70:71]
    v_pk_mul_f32 v[30:31], v[204:205], s[70:71]
    v_pk_mul_f32 v[32:33], v[206:207], s[70:71]
    v_exp_f32 v26, v26
    s_waitcnt lgkmcnt(6)
    v_mfma_f32_16x16x32_bf16 v[240:243], v[44:47], v[80:83], v[240:243]
    ds_read_b64_tr_b16 v[60:61], v15 offset:0
    ds_read_b64_tr_b16 v[62:63], v15 offset:512
    v_exp_f32 v27, v27
    v_exp_f32 v28, v28
    v_exp_f32 v29, v29
    v_exp_f32 v30, v30
    v_exp_f32 v31, v31
    v_mfma_f32_16x16x32_bf16 v[244:247], v[44:47], v[84:87], v[244:247]
    v_exp_f32 v32, v32
    v_exp_f32 v33, v33
    v_pk_mul_f32 v[200:201], v[200:201], v[216:217]
    v_pk_mul_f32 v[202:203], v[202:203], v[218:219]
    v_pk_mul_f32 v[204:205], v[204:205], v[220:221]
    v_mfma_f32_16x16x32_bf16 v[248:251], v[44:47], v[88:91], v[248:251]
    v_pk_mul_f32 v[206:207], v[206:207], v[222:223]
    v_pk_add_f32 v[26:27], v[26:27], s[94:95]
    v_pk_add_f32 v[28:29], v[28:29], s[94:95]
    v_pk_add_f32 v[30:31], v[30:31], s[94:95]
    v_pk_add_f32 v[32:33], v[32:33], s[94:95]
    v_mfma_f32_16x16x32_bf16 v[252:255], v[44:47], v[92:95], v[252:255]
    v_rcp_f32 v26, v26
    v_rcp_f32 v27, v27
    v_rcp_f32 v28, v28
    v_rcp_f32 v29, v29
    v_rcp_f32 v30, v30
    s_waitcnt lgkmcnt(6)
    v_mfma_f32_16x16x32_bf16 v[96:99], v[48:51], v[64:67], v[96:99]
    v_rcp_f32 v31, v31
    v_rcp_f32 v32, v32
    v_rcp_f32 v33, v33
    s_nop 0
    v_pk_mul_f32 v[200:201], v[200:201], v[26:27]
    v_mfma_f32_16x16x32_bf16 v[100:103], v[48:51], v[68:71], v[100:103]
    v_pk_mul_f32 v[202:203], v[202:203], v[28:29]
    v_pk_mul_f32 v[204:205], v[204:205], v[30:31]
    v_pk_mul_f32 v[206:207], v[206:207], v[32:33]
    v_cvt_pk_bf16_f32 v200, v200, v201
    v_cvt_pk_bf16_f32 v201, v202, v203
    v_mfma_f32_16x16x32_bf16 v[104:107], v[48:51], v[72:75], v[104:107]
    v_cvt_pk_bf16_f32 v202, v204, v205
    v_cvt_pk_bf16_f32 v203, v206, v207
    s_nop 1
    v_permlane32_swap_b32 v200, v202
    v_permlane32_swap_b32 v201, v203
    v_mfma_f32_16x16x32_bf16 v[108:111], v[48:51], v[76:79], v[108:111]
    s_getreg_b32 s101, hwreg(HW_REG_IB_STS)
    s_and_b32 s101, s101, 0xc0000f
    s_or_b32 s101, s101, s100
    s_cmp_le_u32 s101, 2
    s_cbranch_scc1 LG_s3
LG_r3:
    s_waitcnt lgkmcnt(4)
    v_mfma_f32_16x16x32_bf16 v[112:115], v[52:55], v[64:67], v[112:115]
    v_pk_mul_f32 v[26:27], v[224:225], s[70:71]
    v_pk_mul_f32 v[28:29], v[226:227], s[70:71]
    v_pk_mul_f32 v[30:31], v[228:229], s[70:71]
    v_pk_mul_f32 v[32:33], v[230:231], s[70:71]
    v_exp_f32 v26, v26
    v_mfma_f32_16x16x32_bf16 v[116:119], v[52:55], v[68:71], v[116:119]
    v_exp_f32 v27, v27
    v_exp_f32 v28, v28
    v_exp_f32 v29, v29
    v_exp_f32 v30, v30
    v_exp_f32 v31, v31
    v_mfma_f32_16x16x32_bf16 v[120:123], v[52:55], v[72:75], v[120:123]
    v_exp_f32 v32, v32
    v_exp_f32 v33, v33
    v_pk_mul_f32 v[224:225], v[224:225], v[240:241]
    v_pk_mul_f32 v[226:227], v[226:227], v[242:243]
    v_pk_mul_f32 v[228:229], v[228:229], v[244:245]
    v_mfma_f32_16x16x32_bf16 v[124:127], v[52:55], v[76:79], v[124:127]
    v_pk_mul_f32 v[230:231], v[230:231], v[246:247]
    v_pk_add_f32 v[26:27], v[26:27], s[94:95]
    v_pk_add_f32 v[28:29], v[28:29], s[94:95]
    v_pk_add_f32 v[30:31], v[30:31], s[94:95]
    v_pk_add_f32 v[32:33], v[32:33], s[94:95]
    s_waitcnt lgkmcnt(2)
    v_mfma_f32_16x16x32_bf16 v[96:99], v[56:59], v[80:83], v[96:99]
    v_rcp_f32 v26, v26
    v_rcp_f32 v27, v27
    v_rcp_f32 v28, v28
    v_rcp_f32 v29, v29
    v_rcp_f32 v30, v30
    v_mfma_f32_16x16x32_bf16 v[100:103], v[56:59], v[84:87], v[100:103]
    v_rcp_f32 v31, v31
    v_rcp_f32 v32, v32
    v_rcp_f32 v33, v33
    s_nop 0
    v_pk_mul_f32 v[224:225], v[224:225], v[26:27]
    v_mfma_f32_16x16x32_bf16 v[104:107], v[56:59], v[88:91], v[104:107]
    v_pk_mul_f32 v[226:227], v[226:227], v[28:29]
    v_pk_mul_f32 v[228:229], v[228:229], v[30:31]
    v_pk_mul_f32 v[230:231], v[230:231], v[32:33]
    v_cvt_pk_bf16_f32 v224, v224, v225
    v_cvt_pk_bf16_f32 v225, v226, v227
    v_mfma_f32_16x16x32_bf16 v[108:111], v[56:59], v[92:95], v[108:111]
    v_cvt_pk_bf16_f32 v226, v228, v229
    v_cvt_pk_bf16_f32 v227, v230, v231
    s_nop 1
    v_permlane32_swap_b32 v224, v226
    v_permlane32_swap_b32 v225, v227
    s_waitcnt lgkmcnt(0)
    v_mfma_f32_16x16x32_bf16 v[112:115], v[60:63], v[80:83], v[112:115]
    s_getreg_b32 s101, hwreg(HW_REG_IB_STS)
    s_and_b32 s101, s101, 0xc0000f
    s_or_b32 s101, s101, s100
    s_cmp_le_u32 s101, 2
    s_cbranch_scc1 LG_s4
LG_r4:
    v_mfma_f32_16x16x32_bf16 v[116:119], v[60:63], v[84:87], v[116:119]
    v_pk_mul_f32 v[26:27], v[232:233], s[70:71]
    v_pk_mul_f32 v[28:29], v[234:235], s[70:71]
    v_pk_mul_f32 v[30:31], v[236:237], s[70:71]
    v_pk_mul_f32 v[32:33], v[238:239], s[70:71]
    v_exp_f32 v26, v26
    v_mfma_f32_16x16x32_bf16 v[120:123], v[60:63], v[88:91], v[120:123]
    v_exp_f32 v27, v27
    v_exp_f32 v28, v28
    v_exp_f32 v29, v29
    v_exp_f32 v30, v30
    v_exp_f32 v31, v31
    v_mfma_f32_16x16x32_bf16 v[124:127], v[60:63], v[92:95], v[124:127]
    v_exp_f32 v32, v32
    v_exp_f32 v33, v33
    v_pk_mul_f32 v[232:233], v[232:233], v[248:249]
    v_pk_mul_f32 v[234:235], v[234:235], v[250:251]
    v_pk_mul_f32 v[236:237], v[236:237], v[252:253]
    s_mov_b32 s61, 0x4000000
    s_cmp_eq_u32 s4, 0
    s_cbranch_scc1 LB_rb0
    s_waitcnt vmcnt(0)
    s_cmp_eq_u32 s100, 0
    s_cbranch_scc1 LG_s6
LG_r6:
    v_readfirstlane_b32 s56, v36
    s_nop 0
    s_cmp_eq_u32 s56, 1
    s_cbranch_scc0 LB_late
    s_sub_u32 s61, s60, 1048576
LB_rb0:
    s_add_u32 s62, s61, 4096
    buffer_load_dwordx4 v[40:43], v34, s[24:27], s61 offen offset:0 sc1
    buffer_load_dwordx4 v[44:47], v34, s[24:27], s61 offen offset:1024 sc1
    buffer_load_dwordx4 v[48:51], v34, s[24:27], s61 offen offset:2048 sc1
    buffer_load_dwordx4 v[52:55], v34, s[24:27], s61 offen offset:3072 sc1
    buffer_load_dwordx4 v[56:59], v34, s[24:27], s62 offen offset:0 sc1
    buffer_load_dwordx4 v[60:63], v34, s[24:27], s62 offen offset:1024 sc1
    buffer_load_dwordx4 v[64:67], v34, s[24:27], s62 offen offset:2048 sc1
    buffer_load_dwordx4 v[68:71], v34, s[24:27], s62 offen offset:3072 sc1
    s_mov_b32 s60, 0
LB_late:
    v_mul_f32 v96, 0x3e8293ee, v96
    v_mul_f32 v97, 0x3e8293ee, v97
    v_mul_f32 v98, 0x3e8293ee, v98
    v_mul_f32 v99, 0x3e8293ee, v99
    v_mul_f32 v100, 0x3e8293ee, v100
    v_mul_f32 v101, 0x3e8293ee, v101
    v_mul_f32 v102, 0x3e8293ee, v102
    v_mul_f32 v103, 0x3e8293ee, v103
    v_mul_f32 v104, 0x3e8293ee, v104
    v_mul_f32 v105, 0x3e8293ee, v105
    v_mul_f32 v106, 0x3e8293ee, v106
    v_mul_f32 v107, 0x3e8293ee, v107
    v_mul_f32 v108, 0x3e8293ee, v108
    v_mul_f32 v109, 0x3e8293ee, v109
    v_mul_f32 v110, 0x3e8293ee, v110
    v_mul_f32 v111, 0x3e8293ee, v111
    v_mul_f32 v112, 0x3e8293ee, v112
    v_mul_f32 v113, 0x3e8293ee, v113
    v_mul_f32 v114, 0x3e8293ee, v114
    v_mul_f32 v115, 0x3e8293ee, v115
    v_mul_f32 v116, 0x3e8293ee, v116
    v_mul_f32 v117, 0x3e8293ee, v117
    v_mul_f32 v118, 0x3e8293ee, v118
    v_mul_f32 v119, 0x3e8293ee, v119
    v_mul_f32 v120, 0x3e8293ee, v120
    v_mul_f32 v121, 0x3e8293ee, v121
    v_mul_f32 v122, 0x3e8293ee, v122
    v_mul_f32 v123, 0x3e8293ee, v123
    v_mul_f32 v124, 0x3e8293ee, v124
    v_mul_f32 v125, 0x3e8293ee, v125
    v_mul_f32 v126, 0x3e8293ee, v126
    v_mul_f32 v127, 0x3e8293ee, v127
    v_cvt_pk_bf16_f32 v96, v96, v97
    v_cvt_pk_bf16_f32 v97, v98, v99
    v_cvt_pk_bf16_f32 v98, v112, v113
    v_cvt_pk_bf16_f32 v99, v114, v115
    v_cvt_pk_bf16_f32 v100, v100, v101
    v_cvt_pk_bf16_f32 v101, v102, v103
    v_cvt_pk_bf16_f32 v102, v116, v117
    v_cvt_pk_bf16_f32 v103, v118, v119
    v_cvt_pk_bf16_f32 v104, v104, v105
    v_cvt_pk_bf16_f32 v105, v106, v107
    v_cvt_pk_bf16_f32 v106, v120, v121
    v_cvt_pk_bf16_f32 v107, v122, v123
    v_cvt_pk_bf16_f32 v108, v108, v109
    v_cvt_pk_bf16_f32 v109, v110, v111
    v_cvt_pk_bf16_f32 v110, v124, v125
    v_cvt_pk_bf16_f32 v111, v126, v127
    ds_write_b128 v35, v[96:99] offset:0
    ds_write_b128 v35, v[100:103] offset:1024
    ds_write_b128 v35, v[104:107] offset:2048
    ds_write_b128 v35, v[108:111] offset:3072
    v_pk_mul_f32 v[238:239], v[238:239], v[254:255]
    v_pk_add_f32 v[26:27], v[26:27], s[94:95]
    v_pk_add_f32 v[28:29], v[28:29], s[94:95]
    v_pk_add_f32 v[30:31], v[30:31], s[94:95]
    v_pk_add_f32 v[32:33], v[32:33], s[94:95]
    v_rcp_f32 v26, v26
    v_rcp_f32 v27, v27
    v_rcp_f32 v28, v28
    v_rcp_f32 v29, v29
    v_rcp_f32 v30, v30
    v_rcp_f32 v31, v31
    v_rcp_f32 v32, v32
    v_rcp_f32 v33, v33
    s_nop 0
    v_pk_mul_f32 v[232:233], v[232:233], v[26:27]
    v_pk_mul_f32 v[234:235], v[234:235], v[28:29]
    v_pk_mul_f32 v[236:237], v[236:237], v[30:31]
    v_pk_mul_f32 v[238:239], v[238:239], v[32:33]
    v_cvt_pk_bf16_f32 v232, v232, v233
    v_cvt_pk_bf16_f32 v233, v234, v235
    v_cvt_pk_bf16_f32 v234, v236, v237
    v_cvt_pk_bf16_f32 v235, v238, v239
    s_nop 1
    v_permlane32_swap_b32 v232, v234
    v_permlane32_swap_b32 v233, v235
    s_cmp_eq_u32 s100, 0
    s_cbranch_scc1 LG_s5
LG_r5:
    v_mov_b32 v80, v192
    v_mov_b32 v81, v193
    v_mov_b32 v82, v194
    v_mov_b32 v83, v195
    v_mov_b32 v84, v200
    v_mov_b32 v85, v201
    v_mov_b32 v86, v202
    v_mov_b32 v87, v203
    v_mov_b32 v88, v224
    v_mov_b32 v89, v225
    v_mov_b32 v90, v226
    v_mov_b32 v91, v227
    v_mov_b32 v92, v232
    v_mov_b32 v93, v233
    v_mov_b32 v94, v234
    v_mov_b32 v95, v235
    s_add_u32 s92, s92, 512
    s_add_u32 s93, s93, 512
    s_cmp_eq_u32 s60, 0
    s_cbranch_scc1 LB_have
    s_mov_b32 s61, 0x8000
LB_spin:
    buffer_load_dword v36, off, s[24:27], s59 offset:128 sc1
    s_waitcnt vmcnt(0)
    v_readfirstlane_b32 s56, v36
    s_nop 0
    s_cmp_eq_u32 s56, 1
    s_cbranch_scc1 LB_spin_ok
    s_sub_u32 s61, s61, 1
    s_cbranch_scc1 LB_spin_ok
    s_sleep 2
    s_branch LB_spin
LB_spin_ok:
    s_sub_u32 s61, s60, 1048576
    s_add_u32 s62, s61, 4096
    buffer_load_dwordx4 v[40:43], v34, s[24:27], s61 offen offset:0 sc1
    buffer_load_dwordx4 v[44:47], v34, s[24:27], s61 offen offset:1024 sc1
    buffer_load_dwordx4 v[48:51], v34, s[24:27], s61 offen offset:2048 sc1
    buffer_load_dwordx4 v[52:55], v34, s[24:27], s61 offen offset:3072 sc1
    buffer_load_dwordx4 v[56:59], v34, s[24:27], s62 offen offset:0 sc1
    buffer_load_dwordx4 v[60:63], v34, s[24:27], s62 offen offset:1024 sc1
    buffer_load_dwordx4 v[64:67], v34, s[24:27], s62 offen offset:2048 sc1
    buffer_load_dwordx4 v[68:71], v34, s[24:27], s62 offen offset:3072 sc1
    s_waitcnt vmcnt(0)
LB_have:
    s_branch LB_common
LA_pre1:
    ds_read_b128 v[64:67], v10 offset:0
    ds_read_b128 v[68:71], v10 offset:2048
    ds_read_b128 v[72:75], v10 offset:4096
    ds_read_b128 v[76:79], v10 offset:6144
    ds_read_b64_tr_b16 v[44:45], v14 offset:24576
    ds_read_b64_tr_b16 v[46:47], v14 offset:25088
    ds_read_b64_tr_b16 v[48:49], v15 offset:24576
    ds_read_b64_tr_b16 v[50:51], v15 offset:25088
    ds_read_b64_tr_b16 v[52:53], v12 offset:26720
    ds_read_b64_tr_b16 v[54:55], v12 offset:28512
    ds_read_b64_tr_b16 v[56:57], v12 offset:33888
    ds_read_b64_tr_b16 v[58:59], v12 offset:35680
    s_add_u32 m0, s43, 40960
    s_nop 0
    buffer_load_dwordx4 v8, s[12:15], s38 offen  lds
    s_add_u32 s38, s38, s47
    s_add_u32 m0, s45, 40960
    s_nop 0
    buffer_load_dwordx4 v8, s[16:19], s40 offen  lds
    s_add_u32 s40, s40, s47
    s_add_u32 m0, s48, 32768
    s_nop 0
    buffer_load_dwordx4 v4, s[8:11], s36 offen offset:0  lds
    s_add_u32 m0, s48, 32768
    s_nop 0
    buffer_load_dwordx4 v5, s[8:11], s36 offen offset:1024  lds
    s_mov_b32 s49, 8
    s_mov_b32 s54, 0
    s_waitcnt lgkmcnt(0)
.p2align 6
LA_loop1:
    s_waitcnt lgkmcnt(8)
    v_mfma_f32_16x16x32_bf16 v[96:99], v[64:67], v[44:47], v[96:99]
    ds_read_b64_tr_b16 v[60:61], v12 offset:26752
    ds_read_b64_tr_b16 v[62:63], v12 offset:28544
    v_mfma_f32_16x16x32_bf16 v[100:103], v[68:71], v[44:47], v[100:103]
    s_waitcnt lgkmcnt(9)
    v_mfma_f32_16x16x32_bf16 v[104:107], v[72:75], v[44:47], v[104:107]
    s_waitcnt lgkmcnt(8)
    v_mfma_f32_16x16x32_bf16 v[108:111], v[76:79], v[44:47], v[108:111]
    s_waitcnt lgkmcnt(6)
    v_mfma_f32_16x16x32_bf16 v[124:127], v[76:79], v[48:51], v[124:127]
    ds_read_b64_tr_b16 v[44:45], v12 offset:33920
    ds_read_b64_tr_b16 v[46:47], v12 offset:35712
    v_mfma_f32_16x16x32_bf16 v[120:123], v[72:75], v[48:51], v[120:123]
    s_add_u32 m0, s48, 32768
    v_mfma_f32_16x16x32_bf16 v[116:119], v[68:71], v[48:51], v[116:119]
    buffer_load_dwordx4 v6, s[8:11], s36 offen offset:2048  lds
    v_mfma_f32_16x16x32_bf16 v[112:115], v[64:67], v[48:51], v[112:115]
    s_waitcnt lgkmcnt(6)
    v_mfma_f32_16x16x32_bf16 v[128:131], v[52:55], v[64:67], v[128:131]
    ds_read_b64_tr_b16 v[48:49], v12 offset:26784
    ds_read_b64_tr_b16 v[50:51], v12 offset:28576
    v_mfma_f32_16x16x32_bf16 v[132:135], v[52:55], v[68:71], v[132:135]
    v_mfma_f32_16x16x32_bf16 v[136:139], v[52:55], v[72:75], v[136:139]
    v_mfma_f32_16x16x32_bf16 v[140:143], v[52:55], v[76:79], v[140:143]
    s_waitcnt lgkmcnt(6)
    v_mfma_f32_16x16x32_bf16 v[156:159], v[56:59], v[76:79], v[156:159]
    ds_read_b64_tr_b16 v[52:53], v12 offset:33952
    ds_read_b64_tr_b16 v[54:55], v12 offset:35744
    v_mfma_f32_16x16x32_bf16 v[152:155], v[56:59], v[72:75], v[152:155]
    s_add_u32 m0, s48, 32768
    v_mfma_f32_16x16x32_bf16 v[148:151], v[56:59], v[68:71], v[148:151]
    buffer_load_dwordx4 v7, s[8:11], s36 offen offset:3072  lds
    s_add_u32 s36, s36, 128
    v_mfma_f32_16x16x32_bf16 v[144:147], v[56:59], v[64:67], v[144:147]
    s_waitcnt lgkmcnt(6)
    v_mfma_f32_16x16x32_bf16 v[160:163], v[60:63], v[64:67], v[160:163]
    ds_read_b64_tr_b16 v[56:57], v12 offset:26816
    ds_read_b64_tr_b16 v[58:59], v12 offset:28608
    v_mfma_f32_16x16x32_bf16 v[164:167], v[60:63], v[68:71], v[164:167]
    v_mfma_f32_16x16x32_bf16 v[168:171], v[60:63], v[72:75], v[168:171]
    v_mfma_f32_16x16x32_bf16 v[172:175], v[60:63], v[76:79], v[172:175]
    s_waitcnt lgkmcnt(6)
    v_mfma_f32_16x16x32_bf16 v[188:191], v[44:47], v[76:79], v[188:191]
    ds_read_b64_tr_b16 v[60:61], v12 offset:33984
    ds_read_b64_tr_b16 v[62:63], v12 offset:35776
    v_mfma_f32_16x16x32_bf16 v[184:187], v[44:47], v[72:75], v[184:187]
    ds_read_b128 v[80:83], v11 offset:0
    ds_read_b128 v[84:87], v11 offset:2048
    v_mfma_f32_16x16x32_bf16 v[180:183], v[44:47], v[68:71], v[180:183]
    buffer_load_dword v18, v3, s[32:35], s51 offen
    s_add_u32 s51, s51, s52
    v_mfma_f32_16x16x32_bf16 v[176:179], v[44:47], v[64:67], v[176:179]
    s_waitcnt lgkmcnt(8)
    v_mfma_f32_16x16x32_bf16 v[192:195], v[48:51], v[64:67], v[192:195]
    s_waitcnt vmcnt(5) lgkmcnt(2)
    s_barrier
    ds_read_b64_tr_b16 v[44:45], v16 offset:4096
    ds_read_b64_tr_b16 v[46:47], v16 offset:4608
    v_mfma_f32_16x16x32_bf16 v[196:199], v[48:51], v[68:71], v[196:199]
    ds_read_b128 v[88:91], v11 offset:4096
    ds_read_b128 v[92:95], v11 offset:6144
    v_mfma_f32_16x16x32_bf16 v[200:203], v[48:51], v[72:75], v[200:203]
    v_mfma_f32_16x16x32_bf16 v[204:207], v[48:51], v[76:79], v[204:207]
    v_mfma_f32_16x16x32_bf16 v[220:223], v[52:55], v[76:79], v[220:223]
    ds_read_b64_tr_b16 v[48:49], v17 offset:4096
    ds_read_b64_tr_b16 v[50:51], v17 offset:4608
    v_mfma_f32_16x16x32_bf16 v[216:219], v[52:55], v[72:75], v[216:219]
    s_add_u32 m0, s42, 0
    v_mfma_f32_16x16x32_bf16 v[212:215], v[52:55], v[68:71], v[212:215]
    buffer_load_dwordx4 v8, s[12:15], s37 offen  lds
    s_add_u32 s37, s37, s47
    v_mfma_f32_16x16x32_bf16 v[208:211], v[52:55], v[64:67], v[208:211]
    v_mfma_f32_16x16x32_bf16 v[224:227], v[56:59], v[64:67], v[224:227]
    ds_read_b64_tr_b16 v[52:53], v13 offset:6240
    ds_read_b64_tr_b16 v[54:55], v13 offset:8032
    v_mfma_f32_16x16x32_bf16 v[228:231], v[56:59], v[68:71], v[228:231]
    v_mfma_f32_16x16x32_bf16 v[232:235], v[56:59], v[72:75], v[232:235]
    v_mfma_f32_16x16x32_bf16 v[236:239], v[56:59], v[76:79], v[236:239]
    v_mfma_f32_16x16x32_bf16 v[252:255], v[60:63], v[76:79], v[252:255]
    ds_read_b64_tr_b16 v[56:57], v13 offset:13408
    ds_read_b64_tr_b16 v[58:59], v13 offset:15200
    v_mfma_f32_16x16x32_bf16 v[248:251], v[60:63], v[72:75], v[248:251]
    s_add_u32 m0, s43, 0
    v_mfma_f32_16x16x32_bf16 v[244:247], v[60:63], v[68:71], v[244:247]
    buffer_load_dwordx4 v8, s[12:15], s38 offen  lds
    s_add_u32 s38, s38, s47
    v_mfma_f32_16x16x32_bf16 v[240:243], v[60:63], v[64:67], v[240:243]
    s_waitcnt lgkmcnt(8)
    v_mfma_f32_16x16x32_bf16 v[96:99], v[80:83], v[44:47], v[96:99]
    ds_read_b64_tr_b16 v[60:61], v13 offset:6272
    ds_read_b64_tr_b16 v[62:63], v13 offset:8064
    v_mfma_f32_16x16x32_bf16 v[100:103], v[84:87], v[44:47], v[100:103]
    s_waitcnt lgkmcnt(9)
    v_mfma_f32_16x16x32_bf16 v[104:107], v[88:91], v[44:47], v[104:107]
    s_waitcnt lgkmcnt(8)
    v_mfma_f32_16x16x32_bf16 v[108:111], v[92:95], v[44:47], v[108:111]
    s_waitcnt lgkmcnt(6)
    v_mfma_f32_16x16x32_bf16 v[124:127], v[92:95], v[48:51], v[124:127]
    ds_read_b64_tr_b16 v[44:45], v13 offset:13440
    ds_read_b64_tr_b16 v[46:47], v13 offset:15232
    v_mfma_f32_16x16x32_bf16 v[120:123], v[88:91], v[48:51], v[120:123]
    s_add_u32 m0, s44, 0
    v_mfma_f32_16x16x32_bf16 v[116:119], v[84:87], v[48:51], v[116:119]
    buffer_load_dwordx4 v8, s[16:19], s39 offen  lds
    s_add_u32 s39, s39, s47
    v_mfma_f32_16x16x32_bf16 v[112:115], v[80:83], v[48:51], v[112:115]
    s_waitcnt lgkmcnt(6)
    v_mfma_f32_16x16x32_bf16 v[128:131], v[52:55], v[80:83], v[128:131]
    ds_read_b64_tr_b16 v[48:49], v13 offset:6304
    ds_read_b64_tr_b16 v[50:51], v13 offset:8096
    v_mfma_f32_16x16x32_bf16 v[132:135], v[52:55], v[84:87], v[132:135]
    v_mfma_f32_16x16x32_bf16 v[136:139], v[52:55], v[88:91], v[136:139]
    v_mfma_f32_16x16x32_bf16 v[140:143], v[52:55], v[92:95], v[140:143]
    s_waitcnt lgkmcnt(6)
    v_mfma_f32_16x16x32_bf16 v[156:159], v[56:59], v[92:95], v[156:159]
    ds_read_b64_tr_b16 v[52:53], v13 offset:13472
    ds_read_b64_tr_b16 v[54:55], v13 offset:15264
    v_mfma_f32_16x16x32_bf16 v[152:155], v[56:59], v[88:91], v[152:155]
    s_add_u32 m0, s45, 0
    v_mfma_f32_16x16x32_bf16 v[148:151], v[56:59], v[84:87], v[148:151]
    buffer_load_dwordx4 v8, s[16:19], s40 offen  lds
    s_add_u32 s40, s40, s47
    v_mfma_f32_16x16x32_bf16 v[144:147], v[56:59], v[80:83], v[144:147]
    s_waitcnt lgkmcnt(6)
    v_mfma_f32_16x16x32_bf16 v[160:163], v[60:63], v[80:83], v[160:163]
    ds_read_b64_tr_b16 v[56:57], v13 offset:6336
    ds_read_b64_tr_b16 v[58:59], v13 offset:8128
    v_mfma_f32_16x16x32_bf16 v[164:167], v[60:63], v[84:87], v[164:167]
    v_mfma_f32_16x16x32_bf16 v[168:171], v[60:63], v[88:91], v[168:171]
    v_mfma_f32_16x16x32_bf16 v[172:175], v[60:63], v[92:95], v[172:175]
    s_waitcnt lgkmcnt(6)
    v_mfma_f32_16x16x32_bf16 v[188:191], v[44:47], v[92:95], v[188:191]
    s_waitcnt vmcnt(5)
    s_barrier
    ds_read_b64_tr_b16 v[60:61], v13 offset:13504
    ds_read_b64_tr_b16 v[62:63], v13 offset:15296
    v_mfma_f32_16x16x32_bf16 v[184:187], v[44:47], v[88:91], v[184:187]
    ds_read_b128 v[64:67], v10 offset:32768
    ds_read_b128 v[68:71], v10 offset:34816
    s_add_u32 m0, s46, 0
    v_mfma_f32_16x16x32_bf16 v[180:183], v[44:47], v[84:87], v[180:183]
    buffer_load_dwordx4 v9, s[20:23], s41 offen  lds
    s_add_u32 s41, s41, 393216
    v_mfma_f32_16x16x32_bf16 v[176:179], v[44:47], v[80:83], v[176:179]
    s_waitcnt lgkmcnt(8)
    v_mfma_f32_16x16x32_bf16 v[192:195], v[48:51], v[80:83], v[192:195]
    ds_read_b64_tr_b16 v[44:45], v16 offset:24576
    ds_read_b64_tr_b16 v[46:47], v16 offset:25088
    v_mfma_f32_16x16x32_bf16 v[196:199], v[48:51], v[84:87], v[196:199]
    ds_read_b128 v[72:75], v10 offset:36864
    ds_read_b128 v[76:79], v10 offset:38912
    v_mfma_f32_16x16x32_bf16 v[200:203], v[48:51], v[88:91], v[200:203]
    v_mfma_f32_16x16x32_bf16 v[204:207], v[48:51], v[92:95], v[204:207]
    s_waitcnt lgkmcnt(10)
    v_mfma_f32_16x16x32_bf16 v[220:223], v[52:55], v[92:95], v[220:223]
    ds_read_b64_tr_b16 v[48:49], v17 offset:24576
    ds_read_b64_tr_b16 v[50:51], v17 offset:25088
    v_mfma_f32_16x16x32_bf16 v[216:219], v[52:55], v[88:91], v[216:219]
    s_add_u32 m0, s48, 0
    v_mfma_f32_16x16x32_bf16 v[212:215], v[52:55], v[84:87], v[212:215]
    buffer_load_dwordx4 v4, s[8:11], s36 offen offset:0  lds
    v_mfma_f32_16x16x32_bf16 v[208:211], v[52:55], v[80:83], v[208:211]
    s_waitcnt lgkmcnt(10)
    v_mfma_f32_16x16x32_bf16 v[224:227], v[56:59], v[80:83], v[224:227]
    ds_read_b64_tr_b16 v[52:53], v13 offset:26720
    ds_read_b64_tr_b16 v[54:55], v13 offset:28512
    v_mfma_f32_16x16x32_bf16 v[228:231], v[56:59], v[84:87], v[228:231]
    v_mfma_f32_16x16x32_bf16 v[232:235], v[56:59], v[88:91], v[232:235]
    v_mfma_f32_16x16x32_bf16 v[236:239], v[56:59], v[92:95], v[236:239]
    s_waitcnt lgkmcnt(10)
    v_mfma_f32_16x16x32_bf16 v[252:255], v[60:63], v[92:95], v[252:255]
    ds_read_b64_tr_b16 v[56:57], v13 offset:33888
    ds_read_b64_tr_b16 v[58:59], v13 offset:35680
    v_mfma_f32_16x16x32_bf16 v[248:251], v[60:63], v[88:91], v[248:251]
    s_add_u32 m0, s48, 0
    v_mfma_f32_16x16x32_bf16 v[244:247], v[60:63], v[84:87], v[244:247]
    buffer_load_dwordx4 v5, s[8:11], s36 offen offset:1024  lds
    v_mfma_f32_16x16x32_bf16 v[240:243], v[60:63], v[80:83], v[240:243]
    s_waitcnt lgkmcnt(8)
    v_mfma_f32_16x16x32_bf16 v[96:99], v[64:67], v[44:47], v[96:99]
    ds_read_b64_tr_b16 v[60:61], v13 offset:26752
    ds_read_b64_tr_b16 v[62:63], v13 offset:28544
    v_mfma_f32_16x16x32_bf16 v[100:103], v[68:71], v[44:47], v[100:103]
    s_waitcnt lgkmcnt(9)
    v_mfma_f32_16x16x32_bf16 v[104:107], v[72:75], v[44:47], v[104:107]
    s_waitcnt lgkmcnt(8)
    v_mfma_f32_16x16x32_bf16 v[108:111], v[76:79], v[44:47], v[108:111]
    s_waitcnt lgkmcnt(6)
    v_mfma_f32_16x16x32_bf16 v[124:127], v[76:79], v[48:51], v[124:127]
    ds_read_b64_tr_b16 v[44:45], v13 offset:33920
    ds_read_b64_tr_b16 v[46:47], v13 offset:35712
    v_mfma_f32_16x16x32_bf16 v[120:123], v[72:75], v[48:51], v[120:123]
    s_add_u32 m0, s48, 0
    v_mfma_f32_16x16x32_bf16 v[116:119], v[68:71], v[48:51], v[116:119]
    buffer_load_dwordx4 v6, s[8:11], s36 offen offset:2048  lds
    v_mfma_f32_16x16x32_bf16 v[112:115], v[64:67], v[48:51], v[112:115]
    s_waitcnt lgkmcnt(6)
    v_mfma_f32_16x16x32_bf16 v[128:131], v[52:55], v[64:67], v[128:131]
    ds_read_b64_tr_b16 v[48:49], v13 offset:26784
    ds_read_b64_tr_b16 v[50:51], v13 offset:28576
    v_mfma_f32_16x16x32_bf16 v[132:135], v[52:55], v[68:71], v[132:135]
    v_mfma_f32_16x16x32_bf16 v[136:139], v[52:55], v[72:75], v[136:139]
    v_mfma_f32_16x16x32_bf16 v[140:143], v[52:55], v[76:79], v[140:143]
    s_waitcnt lgkmcnt(6)
    v_mfma_f32_16x16x32_bf16 v[156:159], v[56:59], v[76:79], v[156:159]
    ds_read_b64_tr_b16 v[52:53], v13 offset:33952
    ds_read_b64_tr_b16 v[54:55], v13 offset:35744
    v_mfma_f32_16x16x32_bf16 v[152:155], v[56:59], v[72:75], v[152:155]
    s_add_u32 m0, s48, 0
    v_mfma_f32_16x16x32_bf16 v[148:151], v[56:59], v[68:71], v[148:151]
    buffer_load_dwordx4 v7, s[8:11], s36 offen offset:3072  lds
    s_add_u32 s36, s36, 128
    v_mfma_f32_16x16x32_bf16 v[144:147], v[56:59], v[64:67], v[144:147]
    s_waitcnt lgkmcnt(6)
    v_mfma_f32_16x16x32_bf16 v[160:163], v[60:63], v[64:67], v[160:163]
    ds_read_b64_tr_b16 v[56:57], v13 offset:26816
    ds_read_b64_tr_b16 v[58:59], v13 offset:28608
    v_mfma_f32_16x16x32_bf16 v[164:167], v[60:63], v[68:71], v[164:167]
    v_mfma_f32_16x16x32_bf16 v[168:171], v[60:63], v[72:75], v[168:171]
    v_mfma_f32_16x16x32_bf16 v[172:175], v[60:63], v[76:79], v[172:175]
    s_waitcnt lgkmcnt(6)
    v_mfma_f32_16x16x32_bf16 v[188:191], v[44:47], v[76:79], v[188:191]
    ds_read_b64_tr_b16 v[60:61], v13 offset:33984
    ds_read_b64_tr_b16 v[62:63], v13 offset:35776
    v_mfma_f32_16x16x32_bf16 v[184:187], v[44:47], v[72:75], v[184:187]
    ds_read_b128 v[80:83], v11 offset:32768
    ds_read_b128 v[84:87], v11 offset:34816
    v_mfma_f32_16x16x32_bf16 v[180:183], v[44:47], v[68:71], v[180:183]
    buffer_load_dword v18, v3, s[32:35], s51 offen
    s_add_u32 s51, s51, s52
    v_mfma_f32_16x16x32_bf16 v[176:179], v[44:47], v[64:67], v[176:179]
    s_waitcnt lgkmcnt(8)
    v_mfma_f32_16x16x32_bf16 v[192:195], v[48:51], v[64:67], v[192:195]
    s_waitcnt vmcnt(5) lgkmcnt(2)
    s_barrier
    ds_read_b64_tr_b16 v[44:45], v14 offset:4096
    ds_read_b64_tr_b16 v[46:47], v14 offset:4608
    v_mfma_f32_16x16x32_bf16 v[196:199], v[48:51], v[68:71], v[196:199]
    ds_read_b128 v[88:91], v11 offset:36864
    ds_read_b128 v[92:95], v11 offset:38912
    v_mfma_f32_16x16x32_bf16 v[200:203], v[48:51], v[72:75], v[200:203]
    v_mfma_f32_16x16x32_bf16 v[204:207], v[48:51], v[76:79], v[204:207]
    v_mfma_f32_16x16x32_bf16 v[220:223], v[52:55], v[76:79], v[220:223]
    ds_read_b64_tr_b16 v[48:49], v15 offset:4096
    ds_read_b64_tr_b16 v[50:51], v15 offset:4608
    v_mfma_f32_16x16x32_bf16 v[216:219], v[52:55], v[72:75], v[216:219]
    s_add_u32 m0, s42, 40960
    v_mfma_f32_16x16x32_bf16 v[212:215], v[52:55], v[68:71], v[212:215]
    buffer_load_dwordx4 v8, s[12:15], s37 offen  lds
    s_add_u32 s37, s37, s47
    v_mfma_f32_16x16x32_bf16 v[208:211], v[52:55], v[64:67], v[208:211]
    v_mfma_f32_16x16x32_bf16 v[224:227], v[56:59], v[64:67], v[224:227]
    ds_read_b64_tr_b16 v[52:53], v12 offset:6240
    ds_read_b64_tr_b16 v[54:55], v12 offset:8032
    v_mfma_f32_16x16x32_bf16 v[228:231], v[56:59], v[68:71], v[228:231]
    v_mfma_f32_16x16x32_bf16 v[232:235], v[56:59], v[72:75], v[232:235]
    v_mfma_f32_16x16x32_bf16 v[236:239], v[56:59], v[76:79], v[236:239]
    v_mfma_f32_16x16x32_bf16 v[252:255], v[60:63], v[76:79], v[252:255]
    ds_read_b64_tr_b16 v[56:57], v12 offset:13408
    ds_read_b64_tr_b16 v[58:59], v12 offset:15200
    v_mfma_f32_16x16x32_bf16 v[248:251], v[60:63], v[72:75], v[248:251]
    s_add_u32 m0, s43, 40960
    v_mfma_f32_16x16x32_bf16 v[244:247], v[60:63], v[68:71], v[244:247]
    buffer_load_dwordx4 v8, s[12:15], s38 offen  lds
    s_add_u32 s38, s38, s47
    v_mfma_f32_16x16x32_bf16 v[240:243], v[60:63], v[64:67], v[240:243]
    s_waitcnt lgkmcnt(8)
    v_mfma_f32_16x16x32_bf16 v[96:99], v[80:83], v[44:47], v[96:99]
    ds_read_b64_tr_b16 v[60:61], v12 offset:6272
    ds_read_b64_tr_b16 v[62:63], v12 offset:8064
    v_mfma_f32_16x16x32_bf16 v[100:103], v[84:87], v[44:47], v[100:103]
    s_waitcnt lgkmcnt(9)
    v_mfma_f32_16x16x32_bf16 v[104:107], v[88:91], v[44:47], v[104:107]
    s_waitcnt lgkmcnt(8)
    v_mfma_f32_16x16x32_bf16 v[108:111], v[92:95], v[44:47], v[108:111]
    s_waitcnt lgkmcnt(6)
    v_mfma_f32_16x16x32_bf16 v[124:127], v[92:95], v[48:51], v[124:127]
    ds_read_b64_tr_b16 v[44:45], v12 offset:13440
    ds_read_b64_tr_b16 v[46:47], v12 offset:15232
    v_mfma_f32_16x16x32_bf16 v[120:123], v[88:91], v[48:51], v[120:123]
    s_add_u32 m0, s44, 40960
    v_mfma_f32_16x16x32_bf16 v[116:119], v[84:87], v[48:51], v[116:119]
    buffer_load_dwordx4 v8, s[16:19], s39 offen  lds
    s_add_u32 s39, s39, s47
    v_mfma_f32_16x16x32_bf16 v[112:115], v[80:83], v[48:51], v[112:115]
    s_waitcnt lgkmcnt(6)
    v_mfma_f32_16x16x32_bf16 v[128:131], v[52:55], v[80:83], v[128:131]
    ds_read_b64_tr_b16 v[48:49], v12 offset:6304
    ds_read_b64_tr_b16 v[50:51], v12 offset:8096
    v_mfma_f32_16x16x32_bf16 v[132:135], v[52:55], v[84:87], v[132:135]
    v_mfma_f32_16x16x32_bf16 v[136:139], v[52:55], v[88:91], v[136:139]
    v_mfma_f32_16x16x32_bf16 v[140:143], v[52:55], v[92:95], v[140:143]
    s_waitcnt lgkmcnt(6)
    v_mfma_f32_16x16x32_bf16 v[156:159], v[56:59], v[92:95], v[156:159]
    ds_read_b64_tr_b16 v[52:53], v12 offset:13472
    ds_read_b64_tr_b16 v[54:55], v12 offset:15264
    v_mfma_f32_16x16x32_bf16 v[152:155], v[56:59], v[88:91], v[152:155]
    s_add_u32 m0, s45, 40960
    v_mfma_f32_16x16x32_bf16 v[148:151], v[56:59], v[84:87], v[148:151]
    buffer_load_dwordx4 v8, s[16:19], s40 offen  lds
    s_add_u32 s40, s40, s47
    v_mfma_f32_16x16x32_bf16 v[144:147], v[56:59], v[80:83], v[144:147]
    s_waitcnt lgkmcnt(6)
    v_mfma_f32_16x16x32_bf16 v[160:163], v[60:63], v[80:83], v[160:163]
    ds_read_b64_tr_b16 v[56:57], v12 offset:6336
    ds_read_b64_tr_b16 v[58:59], v12 offset:8128
    v_mfma_f32_16x16x32_bf16 v[164:167], v[60:63], v[84:87], v[164:167]
    v_mfma_f32_16x16x32_bf16 v[168:171], v[60:63], v[88:91], v[168:171]
    v_mfma_f32_16x16x32_bf16 v[172:175], v[60:63], v[92:95], v[172:175]
    s_waitcnt lgkmcnt(6)
    v_mfma_f32_16x16x32_bf16 v[188:191], v[44:47], v[92:95], v[188:191]
    s_waitcnt vmcnt(5)
    s_barrier
    ds_read_b64_tr_b16 v[60:61], v12 offset:13504
    ds_read_b64_tr_b16 v[62:63], v12 offset:15296
    v_mfma_f32_16x16x32_bf16 v[184:187], v[44:47], v[88:91], v[184:187]
    ds_read_b128 v[64:67], v10 offset:0
    ds_read_b128 v[68:71], v10 offset:2048
    s_add_u32 m0, s46, 40960
    v_mfma_f32_16x16x32_bf16 v[180:183], v[44:47], v[84:87], v[180:183]
    buffer_load_dwordx4 v9, s[20:23], s41 offen  lds
    s_add_u32 s41, s41, 393216
    v_mfma_f32_16x16x32_bf16 v[176:179], v[44:47], v[80:83], v[176:179]
    s_waitcnt lgkmcnt(8)
    v_mfma_f32_16x16x32_bf16 v[192:195], v[48:51], v[80:83], v[192:195]
    ds_read_b64_tr_b16 v[44:45], v14 offset:24576
    ds_read_b64_tr_b16 v[46:47], v14 offset:25088
    v_mfma_f32_16x16x32_bf16 v[196:199], v[48:51], v[84:87], v[196:199]
    ds_read_b128 v[72:75], v10 offset:4096
    ds_read_b128 v[76:79], v10 offset:6144
    v_mfma_f32_16x16x32_bf16 v[200:203], v[48:51], v[88:91], v[200:203]
    v_mfma_f32_16x16x32_bf16 v[204:207], v[48:51], v[92:95], v[204:207]
    s_waitcnt lgkmcnt(10)
    v_mfma_f32_16x16x32_bf16 v[220:223], v[52:55], v[92:95], v[220:223]
    ds_read_b64_tr_b16 v[48:49], v15 offset:24576
    ds_read_b64_tr_b16 v[50:51], v15 offset:25088
    v_mfma_f32_16x16x32_bf16 v[216:219], v[52:55], v[88:91], v[216:219]
    s_add_u32 m0, s48, 32768
    v_mfma_f32_16x16x32_bf16 v[212:215], v[52:55], v[84:87], v[212:215]
    buffer_load_dwordx4 v4, s[8:11], s36 offen offset:0  lds
    v_mfma_f32_16x16x32_bf16 v[208:211], v[52:55], v[80:83], v[208:211]
    s_waitcnt lgkmcnt(10)
    v_mfma_f32_16x16x32_bf16 v[224:227], v[56:59], v[80:83], v[224:227]
    ds_read_b64_tr_b16 v[52:53], v12 offset:26720
    ds_read_b64_tr_b16 v[54:55], v12 offset:28512
    v_mfma_f32_16x16x32_bf16 v[228:231], v[56:59], v[84:87], v[228:231]
    v_mfma_f32_16x16x32_bf16 v[232:235], v[56:59], v[88:91], v[232:235]
    v_mfma_f32_16x16x32_bf16 v[236:239], v[56:59], v[92:95], v[236:239]
    s_waitcnt lgkmcnt(10)
    v_mfma_f32_16x16x32_bf16 v[252:255], v[60:63], v[92:95], v[252:255]
    ds_read_b64_tr_b16 v[56:57], v12 offset:33888
    ds_read_b64_tr_b16 v[58:59], v12 offset:35680
    v_mfma_f32_16x16x32_bf16 v[248:251], v[60:63], v[88:91], v[248:251]
    s_add_u32 m0, s48, 32768
    v_mfma_f32_16x16x32_bf16 v[244:247], v[60:63], v[84:87], v[244:247]
    buffer_load_dwordx4 v5, s[8:11], s36 offen offset:1024  lds
    v_mfma_f32_16x16x32_bf16 v[240:243], v[60:63], v[80:83], v[240:243]
    s_sub_u32 s49, s49, 1
    v_lshlrev_b32 v20, 16, v40
    v_and_b32 v21, 0xffff0000, v40
    v_lshlrev_b32 v22, 16, v41
    v_and_b32 v23, 0xffff0000, v41
    v_pk_mul_f32 v[20:21], v[20:21], v[22:23]
    v_cvt_pk_bf16_f32 v24, v20, v21
    v_dot2_f32_bf16 v25, v24, v43, v25
    buffer_load_dword v40, v42, s[8:11], s55 offen
    buffer_load_dword v41, v42, s[96:99], s50 offen
    s_add_u32 s55, s55, 256
    s_add_u32 s50, s50, 256
    s_cmp_lg_u32 s49, 1
    s_cbranch_scc1 LA_h1_1
    v_cmp_gt_u32 vcc, 128, v19
    s_nop 1
    s_cmp_eq_u64 vcc, 0
    s_cbranch_scc0 LA_slow1
LB_go1:
    buffer_load_dword v38, v42, s[8:11], s55 offen
    buffer_load_dword v39, v42, s[96:99], s50 offen
    s_waitcnt lgkmcnt(8)
    v_mfma_f32_16x16x32_bf16 v[96:99], v[64:67], v[44:47], v[96:99]
    ds_read_b64_tr_b16 v[60:61], v12 offset:26752
    ds_read_b64_tr_b16 v[62:63], v12 offset:28544
    v_mfma_f32_16x16x32_bf16 v[100:103], v[68:71], v[44:47], v[100:103]
    s_waitcnt lgkmcnt(9)
    v_mfma_f32_16x16x32_bf16 v[104:107], v[72:75], v[44:47], v[104:107]
    s_waitcnt lgkmcnt(8)
    v_mfma_f32_16x16x32_bf16 v[108:111], v[76:79], v[44:47], v[108:111]
    s_waitcnt lgkmcnt(6)
    v_mfma_f32_16x16x32_bf16 v[112:115], v[64:67], v[48:51], v[112:115]
    ds_read_b64_tr_b16 v[44:45], v12 offset:33920
    ds_read_b64_tr_b16 v[46:47], v12 offset:35712
    s_lshl_b32 s60, s53, 15
    s_add_u32 s60, s60, 0x1400000
    v_mfma_f32_16x16x32_bf16 v[116:119], v[68:71], v[48:51], v[116:119]
    s_add_u32 m0, s48, 32768
    v_mfma_f32_16x16x32_bf16 v[120:123], v[72:75], v[48:51], v[120:123]
    buffer_load_dwordx4 v6, s[8:11], s36 offen offset:2048  lds
    s_lshl_b32 s61, s6, 13
    v_add_u32 v34, s61, v2
    v_mfma_f32_16x16x32_bf16 v[124:127], v[76:79], v[48:51], v[124:127]
    s_add_u32 s61, s61, s60
    s_cmp_eq_u32 s4, 7
    s_cselect_b32 s61, 0x4000000, s61
    s_waitcnt lgkmcnt(6)
    v_mfma_f32_16x16x32_bf16 v[128:131], v[52:55], v[64:67], v[128:131]
    ds_read_b64_tr_b16 v[48:49], v12 offset:26784
    ds_read_b64_tr_b16 v[50:51], v12 offset:28576
    s_add_u32 s62, s61, 4096
    v_and_b32 v3, 31, v1
    v_mfma_f32_16x16x32_bf16 v[132:135], v[52:55], v[68:71], v[132:135]
    v_lshlrev_b32 v3, 4, v3
    v_lshrrev_b32 v37, 5, v1
    v_mfma_f32_16x16x32_bf16 v[136:139], v[52:55], v[72:75], v[136:139]
    v_mul_u32_u24 v37, 147456, v37
    v_add_u32 v3, v3, v37
    v_mfma_f32_16x16x32_bf16 v[140:143], v[52:55], v[76:79], v[140:143]
    s_lshl_b32 s56, s4, 4
    s_lshl_b32 s57, s6, 2
    s_waitcnt lgkmcnt(6)
    v_mfma_f32_16x16x32_bf16 v[144:147], v[56:59], v[64:67], v[144:147]
    ds_read_b64_tr_b16 v[52:53], v12 offset:33952
    ds_read_b64_tr_b16 v[54:55], v12 offset:35744
    s_add_u32 s56, s56, s57
    s_mul_i32 s92, s56, 147456
    v_mfma_f32_16x16x32_bf16 v[148:151], v[56:59], v[68:71], v[148:151]
    s_add_u32 m0, s48, 32768
    v_mfma_f32_16x16x32_bf16 v[152:155], v[56:59], v[72:75], v[152:155]
    buffer_load_dwordx4 v7, s[8:11], s36 offen offset:3072  lds
    s_add_u32 s36, s36, 128
    s_mul_i32 s56, s5, 3584
    s_add_u32 s92, s92, s56
    v_mfma_f32_16x16x32_bf16 v[156:159], v[56:59], v[76:79], v[156:159]
    s_lshr_b32 s56, s5, 3
    s_lshl_b32 s56, s56, 13
    s_waitcnt lgkmcnt(6)
    v_mfma_f32_16x16x32_bf16 v[160:163], v[60:63], v[64:67], v[160:163]
    ds_read_b64_tr_b16 v[56:57], v12 offset:26816
    ds_read_b64_tr_b16 v[58:59], v12 offset:28608
    s_add_u32 s92, s92, s56
    s_add_u32 s92, s92, 1536
    v_mfma_f32_16x16x32_bf16 v[164:167], v[60:63], v[68:71], v[164:167]
    s_add_u32 s93, s92, 294912
    s_lshl_b32 s63, s53, 9
    v_mfma_f32_16x16x32_bf16 v[168:171], v[60:63], v[72:75], v[168:171]
    s_add_u32 s63, s63, 0x2c10000
    v_mov_b32 v19, 1
    v_mfma_f32_16x16x32_bf16 v[172:175], v[60:63], v[76:79], v[172:175]
    s_mov_b32 s100, 0
    s_sub_u32 s59, s63, 16384
    s_waitcnt lgkmcnt(6)
    v_mfma_f32_16x16x32_bf16 v[176:179], v[44:47], v[64:67], v[176:179]
    ds_read_b64_tr_b16 v[60:61], v12 offset:33984
    ds_read_b64_tr_b16 v[62:63], v12 offset:35776
    v_mfma_f32_16x16x32_bf16 v[180:183], v[44:47], v[68:71], v[180:183]
    ds_read_b128 v[80:83], v11 offset:0
    ds_read_b128 v[84:87], v11 offset:2048
    v_mfma_f32_16x16x32_bf16 v[184:187], v[44:47], v[72:75], v[184:187]
    v_mfma_f32_16x16x32_bf16 v[188:191], v[44:47], v[76:79], v[188:191]
    s_waitcnt lgkmcnt(8)
    v_mfma_f32_16x16x32_bf16 v[192:195], v[48:51], v[64:67], v[192:195]
    s_waitcnt vmcnt(4) lgkmcnt(2)
    s_barrier
    ds_read_b64_tr_b16 v[44:45], v16 offset:4096
    ds_read_b64_tr_b16 v[46:47], v16 offset:4608
    v_mfma_f32_16x16x32_bf16 v[196:199], v[48:51], v[68:71], v[196:199]
    ds_read_b128 v[88:91], v11 offset:4096
    ds_read_b128 v[92:95], v11 offset:6144
    v_mfma_f32_16x16x32_bf16 v[200:203], v[48:51], v[72:75], v[200:203]
    v_mfma_f32_16x16x32_bf16 v[204:207], v[48:51], v[76:79], v[204:207]
    v_mfma_f32_16x16x32_bf16 v[208:211], v[52:55], v[64:67], v[208:211]
    ds_read_b64_tr_b16 v[48:49], v17 offset:4096
    ds_read_b64_tr_b16 v[50:51], v17 offset:4608
    v_mfma_f32_16x16x32_bf16 v[212:215], v[52:55], v[68:71], v[212:215]
    s_add_u32 m0, s42, 0
    v_mfma_f32_16x16x32_bf16 v[216:219], v[52:55], v[72:75], v[216:219]
    buffer_load_dwordx4 v8, s[12:15], s37 offen  lds
    s_add_u32 s37, s37, s47
    v_mfma_f32_16x16x32_bf16 v[220:223], v[52:55], v[76:79], v[220:223]
    v_mfma_f32_16x16x32_bf16 v[224:227], v[56:59], v[64:67], v[224:227]
    ds_read_b64_tr_b16 v[52:53], v13 offset:6240
    ds_read_b64_tr_b16 v[54:55], v13 offset:8032
    v_mfma_f32_16x16x32_bf16 v[228:231], v[56:59], v[68:71], v[228:231]
    s_add_u32 m0, s44, 0
    v_mfma_f32_16x16x32_bf16 v[232:235], v[56:59], v[72:75], v[232:235]
    buffer_load_dwordx4 v8, s[16:19], s39 offen  lds
    s_add_u32 s39, s39, s47
    v_mfma_f32_16x16x32_bf16 v[236:239], v[56:59], v[76:79], v[236:239]
    v_mfma_f32_16x16x32_bf16 v[240:243], v[60:63], v[64:67], v[240:243]
    ds_read_b64_tr_b16 v[56:57], v13 offset:13408
    ds_read_b64_tr_b16 v[58:59], v13 offset:15200
    v_mfma_f32_16x16x32_bf16 v[244:247], v[60:63], v[68:71], v[244:247]
    s_add_u32 m0, s46, 0
    v_mfma_f32_16x16x32_bf16 v[248:251], v[60:63], v[72:75], v[248:251]
    buffer_load_dwordx4 v9, s[20:23], s41 offen  lds
    s_add_u32 s41, s41, 393216
    v_mfma_f32_16x16x32_bf16 v[252:255], v[60:63], v[76:79], v[252:255]
    s_waitcnt lgkmcnt(8)
    v_mfma_f32_16x16x32_bf16 v[96:99], v[80:83], v[44:47], v[96:99]
    ds_read_b64_tr_b16 v[60:61], v13 offset:6272
    ds_read_b64_tr_b16 v[62:63], v13 offset:8064
    s_lshr_b32 s23, s5, 3
    s_and_b32 s36, s5, 7
    v_mfma_f32_16x16x32_bf16 v[100:103], v[84:87], v[44:47], v[100:103]
    s_lshl_b32 s56, s36, 8
    s_lshl_b32 s21, s3, 14
    s_waitcnt lgkmcnt(9)
    v_mfma_f32_16x16x32_bf16 v[104:107], v[88:91], v[44:47], v[104:107]
    s_add_u32 s21, s21, s56
    s_lshl_b32 s22, s3, 14
    s_waitcnt lgkmcnt(8)
    v_mfma_f32_16x16x32_bf16 v[108:111], v[92:95], v[44:47], v[108:111]
    s_add_u32 s22, s22, s56
    s_mul_i32 s56, s23, 1835008
    s_waitcnt lgkmcnt(6)
    v_mfma_f32_16x16x32_bf16 v[112:115], v[80:83], v[48:51], v[112:115]
    ds_read_b64_tr_b16 v[44:45], v13 offset:13440
    ds_read_b64_tr_b16 v[46:47], v13 offset:15232
    s_add_u32 s21, s21, s56
    s_lshl_b32 s56, s23, 19
    v_mfma_f32_16x16x32_bf16 v[116:119], v[84:87], v[48:51], v[116:119]
    s_add_u32 s22, s22, s56
    s_lshl_b32 s37, s3, 11
    v_mfma_f32_16x16x32_bf16 v[120:123], v[88:91], v[48:51], v[120:123]
    s_mov_b32 s12, s76
    s_and_b32 s13, s77, 0xffff
    v_mfma_f32_16x16x32_bf16 v[124:127], v[92:95], v[48:51], v[124:127]
    s_mov_b32 s14, 0x700000
    s_mov_b32 s15, 0x20000
    s_waitcnt lgkmcnt(6)
    v_mfma_f32_16x16x32_bf16 v[128:131], v[52:55], v[80:83], v[128:131]
    ds_read_b64_tr_b16 v[48:49], v13 offset:6304
    ds_read_b64_tr_b16 v[50:51], v13 offset:8096
    s_mov_b32 s32, s68
    s_and_b32 s33, s69, 0xffff
    s_mov_b32 s34, 0x200000
    v_mfma_f32_16x16x32_bf16 v[132:135], v[52:55], v[84:87], v[132:135]
    s_mov_b32 s35, 0x20000
    s_mov_b32 s8, s84
    s_and_b32 s9, s85, 0xffff
    v_mfma_f32_16x16x32_bf16 v[136:139], v[52:55], v[88:91], v[136:139]
    s_mov_b32 s10, 0x1200000
    s_mov_b32 s11, 0x20000
    s_mov_b32 s16, s80
    v_mfma_f32_16x16x32_bf16 v[140:143], v[52:55], v[92:95], v[140:143]
    s_and_b32 s17, s81, 0xffff
    s_mov_b32 s18, 0x400000
    s_mov_b32 s19, 0x20000
    s_waitcnt lgkmcnt(6)
    v_mfma_f32_16x16x32_bf16 v[144:147], v[56:59], v[80:83], v[144:147]
    ds_read_b64_tr_b16 v[52:53], v13 offset:13472
    ds_read_b64_tr_b16 v[54:55], v13 offset:15264
    s_lshl_b32 s56, s4, 4
    s_lshl_b32 s20, s3, 1
    s_add_u32 s56, s56, s20
    v_mfma_f32_16x16x32_bf16 v[148:151], v[56:59], v[84:87], v[148:151]
    s_mul_i32 s20, s56, 147456
    s_add_u32 s38, s20, 28672
    s_mul_i32 s56, s23, 36864
    v_mfma_f32_16x16x32_bf16 v[152:155], v[56:59], v[88:91], v[152:155]
    s_add_u32 s20, s20, s56
    v_mov_b32 v6, v2
    v_add_u32 v7, 147456, v2
    v_mfma_f32_16x16x32_bf16 v[156:159], v[56:59], v[92:95], v[156:159]
    v_lshrrev_b32 v26, 4, v1
    v_bfe_u32 v27, v1, 1, 3
    v_xor_b32 v27, v27, v26
    s_waitcnt lgkmcnt(6)
    v_mfma_f32_16x16x32_bf16 v[160:163], v[60:63], v[80:83], v[160:163]
    ds_read_b64_tr_b16 v[56:57], v13 offset:6336
    ds_read_b64_tr_b16 v[58:59], v13 offset:8128
    v_lshlrev_b32 v26, 11, v26
    v_lshl_add_u32 v26, v27, 5, v26
    v_and_b32 v27, 1, v1
    v_mfma_f32_16x16x32_bf16 v[164:167], v[60:63], v[84:87], v[164:167]
    v_lshl_add_u32 v4, v27, 4, v26
    v_xor_b32 v5, 128, v4
    v_add_u32 v5, 7168, v5
    v_mfma_f32_16x16x32_bf16 v[168:171], v[60:63], v[88:91], v[168:171]
    v_and_b32 v18, 7, v1
    v_lshlrev_b32 v18, 9, v18
    v_mfma_f32_16x16x32_bf16 v[172:175], v[60:63], v[92:95], v[172:175]
    s_waitcnt lgkmcnt(6)
    v_mfma_f32_16x16x32_bf16 v[176:179], v[44:47], v[80:83], v[176:179]
    ds_read_b64_tr_b16 v[60:61], v13 offset:13504
    ds_read_b64_tr_b16 v[62:63], v13 offset:15296
    v_mfma_f32_16x16x32_bf16 v[180:183], v[44:47], v[84:87], v[180:183]
    v_mfma_f32_16x16x32_bf16 v[184:187], v[44:47], v[88:91], v[184:187]
    v_mfma_f32_16x16x32_bf16 v[188:191], v[44:47], v[92:95], v[188:191]
    s_waitcnt lgkmcnt(6)
    v_mfma_f32_16x16x32_bf16 v[192:195], v[48:51], v[80:83], v[192:195]
    ds_read_b64_tr_b16 v[44:45], v16 offset:24576
    ds_read_b64_tr_b16 v[46:47], v16 offset:25088
    v_mfma_f32_16x16x32_bf16 v[196:199], v[48:51], v[84:87], v[196:199]
    v_mfma_f32_16x16x32_bf16 v[200:203], v[48:51], v[88:91], v[200:203]
    v_mfma_f32_16x16x32_bf16 v[204:207], v[48:51], v[92:95], v[204:207]
    s_waitcnt lgkmcnt(6)
    v_mfma_f32_16x16x32_bf16 v[208:211], v[52:55], v[80:83], v[208:211]
    s_waitcnt vmcnt(0) lgkmcnt(0)
    s_barrier
    ds_read_b64_tr_b16 v[48:49], v17 offset:24576
    ds_read_b64_tr_b16 v[50:51], v17 offset:25088
    v_mfma_f32_16x16x32_bf16 v[212:215], v[52:55], v[84:87], v[212:215]
    ds_read_b128 v[64:67], v10 offset:32768
    ds_read_b128 v[68:71], v10 offset:34816
    v_mfma_f32_16x16x32_bf16 v[216:219], v[52:55], v[88:91], v[216:219]
    v_mfma_f32_16x16x32_bf16 v[220:223], v[52:55], v[92:95], v[220:223]
    v_mfma_f32_16x16x32_bf16 v[224:227], v[56:59], v[80:83], v[224:227]
    ds_read_b64_tr_b16 v[52:53], v14 offset:4096
    ds_read_b64_tr_b16 v[54:55], v14 offset:4608
    v_lshlrev_b32 v20, 16, v40
    v_and_b32 v21, 0xffff0000, v40
    v_lshlrev_b32 v22, 16, v41
    v_mfma_f32_16x16x32_bf16 v[228:231], v[56:59], v[84:87], v[228:231]
    ds_read_b128 v[72:75], v10 offset:36864
    ds_read_b128 v[76:79], v10 offset:38912
    v_and_b32 v23, 0xffff0000, v41
    v_pk_mul_f32 v[20:21], v[20:21], v[22:23]
    v_cvt_pk_bf16_f32 v24, v20, v21
    v_mfma_f32_16x16x32_bf16 v[232:235], v[56:59], v[88:91], v[232:235]
    v_dot2_f32_bf16 v25, v24, v43, v25
    v_lshlrev_b32 v20, 16, v38
    v_and_b32 v21, 0xffff0000, v38
    v_mfma_f32_16x16x32_bf16 v[236:239], v[56:59], v[92:95], v[236:239]
    v_lshlrev_b32 v22, 16, v39
    v_and_b32 v23, 0xffff0000, v39
    v_pk_mul_f32 v[20:21], v[20:21], v[22:23]
    v_mfma_f32_16x16x32_bf16 v[240:243], v[60:63], v[80:83], v[240:243]
    ds_read_b64_tr_b16 v[56:57], v15 offset:4096
    ds_read_b64_tr_b16 v[58:59], v15 offset:4608
    v_cvt_pk_bf16_f32 v24, v20, v21
    v_dot2_f32_bf16 v25, v24, v43, v25
    s_nop 1
    v_mfma_f32_16x16x32_bf16 v[244:247], v[60:63], v[84:87], v[244:247]
    s_nop 1
    v_add_f32_dpp v25, v25, v25 quad_perm:[1,0,3,2] row_mask:0xf bank_mask:0xf
    s_nop 1
    v_add_f32_dpp v25, v25, v25 quad_perm:[2,3,0,1] row_mask:0xf bank_mask:0xf
    v_mfma_f32_16x16x32_bf16 v[248:251], v[60:63], v[88:91], v[248:251]
    s_nop 1
    v_add_f32_dpp v25, v25, v25 row_half_mirror row_mask:0xf bank_mask:0xf
    s_nop 1
    v_add_f32_dpp v25, v25, v25 row_mirror row_mask:0xf bank_mask:0xf
    v_mfma_f32_16x16x32_bf16 v[252:255], v[60:63], v[92:95], v[252:255]
    s_nop 1
    v_add_f32_dpp v25, v25, v25 row_bcast:15 row_mask:0xa bank_mask:0xf
    s_nop 1
    v_add_f32_dpp v25, v25, v25 row_bcast:31 row_mask:0xc bank_mask:0xf
    s_waitcnt lgkmcnt(7)
    v_mfma_f32_16x16x32_bf16 v[96:99], v[64:67], v[44:47], v[96:99]
    ds_read_b64_tr_b16 v[60:61], v13 offset:26720
    ds_read_b64_tr_b16 v[62:63], v13 offset:28512
    v_cvt_pk_bf16_f32 v20, v25, v25
    v_and_b32 v20, 0xffff0000, v20
    v_mul_f32 v20, 0xbfb8aa3b, v20
    v_exp_f32 v20, v20
    s_nop 0
    s_waitcnt lgkmcnt(8)
    v_mfma_f32_16x16x32_bf16 v[100:103], v[68:71], v[44:47], v[100:103]
    ds_read_b128 v[80:83], v11 offset:32768
    ds_read_b128 v[84:87], v11 offset:34816
    ds_read_b128 v[88:91], v11 offset:36864
    ds_read_b128 v[92:95], v11 offset:38912
    v_add_f32 v20, 1.0, v20
    v_rcp_f32 v20, v20
    s_nop 0
    v_cvt_pk_bf16_f32 v20, v20, v20
    v_and_b32 v20, 0xffff0000, v20
    s_waitcnt lgkmcnt(9)
    v_mfma_f32_16x16x32_bf16 v[104:107], v[72:75], v[44:47], v[104:107]
    s_lshl_b32 s56, s3, 2
    s_add_u32 s56, s56, 163776
    v_mov_b32 v21, s56
    s_mov_b32 exec_lo, 0
    s_brev_b32 exec_hi, 1
    ds_write_b32 v21, v20
    s_mov_b64 exec, -1
    s_waitcnt lgkmcnt(8)
    v_mfma_f32_16x16x32_bf16 v[108:111], v[76:79], v[44:47], v[108:111]
    v_mfma_f32_16x16x32_bf16 v[112:115], v[64:67], v[48:51], v[112:115]
    ds_read_b64_tr_b16 v[44:45], v13 offset:33888
    ds_read_b64_tr_b16 v[46:47], v13 offset:35680
    v_and_b32 v27, 15, v1
    v_lshlrev_b32 v27, 4, v27
    v_lshrrev_b32 v28, 5, v1
    v_lshl_add_u32 v27, v28, 8, v27
    v_bfe_u32 v28, v1, 4, 1
    v_mfma_f32_16x16x32_bf16 v[116:119], v[68:71], v[48:51], v[116:119]
    v_lshl_add_u32 v10, v28, 10, v27
    v_lshl_add_u32 v9, v28, 9, v27
    v_mul_u32_u24 v11, 147456, v28
    v_add_u32 v11, v11, v27
    s_lshl_b32 s56, s3, 12
    v_mfma_f32_16x16x32_bf16 v[120:123], v[72:75], v[48:51], v[120:123]
    v_add_u32 v8, s56, v10
    v_add_u32 v9, s56, v9
    s_mov_b32 s58, 147456
    s_lshl_b32 s56, s3, 11
    s_cmp_ge_u32 s3, 6
    s_cselect_b32 s57, 79872, s58
    s_add_u32 s56, s56, s57
    v_add_u32 v10, s56, v10
    v_mfma_f32_16x16x32_bf16 v[124:127], v[76:79], v[48:51], v[124:127]
    s_waitcnt lgkmcnt(5)
    v_mfma_f32_16x16x32_bf16 v[96:99], v[80:83], v[52:55], v[96:99]
    ds_read_b64_tr_b16 v[48:49], v12 offset:6240
    ds_read_b64_tr_b16 v[50:51], v12 offset:8032
    s_waitcnt lgkmcnt(6)
    v_mfma_f32_16x16x32_bf16 v[100:103], v[84:87], v[52:55], v[100:103]
    s_waitcnt lgkmcnt(5)
    v_mfma_f32_16x16x32_bf16 v[104:107], v[88:91], v[52:55], v[104:107]
    s_waitcnt lgkmcnt(4)
    v_mfma_f32_16x16x32_bf16 v[108:111], v[92:95], v[52:55], v[108:111]
    v_mfma_f32_16x16x32_bf16 v[112:115], v[80:83], v[56:59], v[112:115]
    s_waitcnt lgkmcnt(0)
    s_barrier
    ds_read_b64_tr_b16 v[52:53], v12 offset:13408
    ds_read_b64_tr_b16 v[54:55], v12 offset:15200
    v_mfma_f32_16x16x32_bf16 v[116:119], v[84:87], v[56:59], v[116:119]
    v_mfma_f32_16x16x32_bf16 v[120:123], v[88:91], v[56:59], v[120:123]
    v_mfma_f32_16x16x32_bf16 v[124:127], v[92:95], v[56:59], v[124:127]
    v_mfma_f32_16x16x32_bf16 v[128:131], v[60:63], v[64:67], v[128:131]
    ds_read_b64_tr_b16 v[56:57], v13 offset:26752
    ds_read_b64_tr_b16 v[58:59], v13 offset:28544
    v_cvt_pk_bf16_f32 v96, v96, v97
    v_cvt_pk_bf16_f32 v97, v98, v99
    v_cvt_pk_bf16_f32 v98, v112, v113
    v_cvt_pk_bf16_f32 v99, v114, v115
    s_nop 1
    v_mfma_f32_16x16x32_bf16 v[132:135], v[60:63], v[68:71], v[132:135]
    v_permlane32_swap_b32 v96, v98
    v_permlane32_swap_b32 v97, v99
    buffer_store_dwordx4 v[96:99], v2, s[24:27], s61 offen offset:2048 sc1
    v_cvt_pk_bf16_f32 v100, v100, v101
    v_cvt_pk_bf16_f32 v101, v102, v103
    v_mfma_f32_16x16x32_bf16 v[136:139], v[60:63], v[72:75], v[136:139]
    v_cvt_pk_bf16_f32 v102, v116, v117
    v_cvt_pk_bf16_f32 v103, v118, v119
    s_nop 1
    v_permlane32_swap_b32 v100, v102
    v_permlane32_swap_b32 v101, v103
    v_mfma_f32_16x16x32_bf16 v[140:143], v[60:63], v[76:79], v[140:143]
    buffer_store_dwordx4 v[100:103], v2, s[24:27], s61 offen offset:3072 sc1
    v_cvt_pk_bf16_f32 v104, v104, v105
    v_cvt_pk_bf16_f32 v105, v106, v107
    v_cvt_pk_bf16_f32 v106, v120, v121
    v_cvt_pk_bf16_f32 v107, v122, v123
    v_mfma_f32_16x16x32_bf16 v[144:147], v[44:47], v[64:67], v[144:147]
    ds_read_b64_tr_b16 v[60:61], v13 offset:33920
    ds_read_b64_tr_b16 v[62:63], v13 offset:35712
    s_nop 1
    v_permlane32_swap_b32 v104, v106
    v_permlane32_swap_b32 v105, v107
    buffer_store_dwordx4 v[104:107], v2, s[24:27], s62 offen offset:2048 sc1
    v_cvt_pk_bf16_f32 v108, v108, v109
    v_mfma_f32_16x16x32_bf16 v[148:151], v[44:47], v[68:71], v[148:151]
    v_cvt_pk_bf16_f32 v109, v110, v111
    v_cvt_pk_bf16_f32 v110, v124, v125
    v_cvt_pk_bf16_f32 v111, v126, v127
    s_nop 1
    v_permlane32_swap_b32 v108, v110
    v_mfma_f32_16x16x32_bf16 v[152:155], v[44:47], v[72:75], v[152:155]
    v_permlane32_swap_b32 v109, v111
    buffer_store_dwordx4 v[108:111], v2, s[24:27], s62 offen offset:3072 sc1
    ds_write_b128 v34, v[96:99] offset:34816
    ds_write_b128 v34, v[100:103] offset:35840
    ds_write_b128 v34, v[104:107] offset:38912
    v_mfma_f32_16x16x32_bf16 v[156:159], v[44:47], v[76:79], v[156:159]
    ds_write_b128 v34, v[108:111] offset:39936
    v_mfma_f32_16x16x32_bf16 v[128:131], v[48:51], v[80:83], v[128:131]
    ds_read_b64_tr_b16 v[44:45], v12 offset:6272
    ds_read_b64_tr_b16 v[46:47], v12 offset:8064
    v_mfma_f32_16x16x32_bf16 v[132:135], v[48:51], v[84:87], v[132:135]
    v_mfma_f32_16x16x32_bf16 v[136:139], v[48:51], v[88:91], v[136:139]
    v_mfma_f32_16x16x32_bf16 v[140:143], v[48:51], v[92:95], v[140:143]
    s_waitcnt lgkmcnt(6)
    v_mfma_f32_16x16x32_bf16 v[144:147], v[52:55], v[80:83], v[144:147]
    ds_read_b64_tr_b16 v[48:49], v12 offset:13440
    ds_read_b64_tr_b16 v[50:51], v12 offset:15232
    v_mfma_f32_16x16x32_bf16 v[148:151], v[52:55], v[84:87], v[148:151]
    v_mfma_f32_16x16x32_bf16 v[152:155], v[52:55], v[88:91], v[152:155]
    v_mfma_f32_16x16x32_bf16 v[156:159], v[52:55], v[92:95], v[156:159]
    s_waitcnt lgkmcnt(6)
    v_mfma_f32_16x16x32_bf16 v[160:163], v[56:59], v[64:67], v[160:163]
    ds_read_b64_tr_b16 v[52:53], v13 offset:26784
    ds_read_b64_tr_b16 v[54:55], v13 offset:28576
    v_pk_mul_f32 v[26:27], v[128:129], s[70:71]
    v_pk_mul_f32 v[28:29], v[130:131], s[70:71]
    v_pk_mul_f32 v[30:31], v[132:133], s[70:71]
    v_pk_mul_f32 v[32:33], v[134:135], s[70:71]
    v_exp_f32 v26, v26
    v_mfma_f32_16x16x32_bf16 v[164:167], v[56:59], v[68:71], v[164:167]
    v_exp_f32 v27, v27
    v_exp_f32 v28, v28
    v_exp_f32 v29, v29
    v_exp_f32 v30, v30
    v_exp_f32 v31, v31
    v_mfma_f32_16x16x32_bf16 v[168:171], v[56:59], v[72:75], v[168:171]
    v_exp_f32 v32, v32
    v_exp_f32 v33, v33
    v_pk_mul_f32 v[128:129], v[128:129], v[144:145]
    v_pk_mul_f32 v[130:131], v[130:131], v[146:147]
    v_pk_mul_f32 v[132:133], v[132:133], v[148:149]
    v_mfma_f32_16x16x32_bf16 v[172:175], v[56:59], v[76:79], v[172:175]
    v_pk_mul_f32 v[134:135], v[134:135], v[150:151]
    v_pk_add_f32 v[26:27], v[26:27], s[94:95]
    v_pk_add_f32 v[28:29], v[28:29], s[94:95]
    v_pk_add_f32 v[30:31], v[30:31], s[94:95]
    v_pk_add_f32 v[32:33], v[32:33], s[94:95]
    s_waitcnt lgkmcnt(6)
    v_mfma_f32_16x16x32_bf16 v[176:179], v[60:63], v[64:67], v[176:179]
    ds_read_b64_tr_b16 v[56:57], v13 offset:33952
    ds_read_b64_tr_b16 v[58:59], v13 offset:35744
    v_rcp_f32 v26, v26
    v_rcp_f32 v27, v27
    v_rcp_f32 v28, v28
    v_rcp_f32 v29, v29
    v_rcp_f32 v30, v30
    v_mfma_f32_16x16x32_bf16 v[180:183], v[60:63], v[68:71], v[180:183]
    v_rcp_f32 v31, v31
    v_rcp_f32 v32, v32
    v_rcp_f32 v33, v33
    s_nop 0
    v_pk_mul_f32 v[128:129], v[128:129], v[26:27]
    v_mfma_f32_16x16x32_bf16 v[184:187], v[60:63], v[72:75], v[184:187]
    v_pk_mul_f32 v[130:131], v[130:131], v[28:29]
    v_pk_mul_f32 v[132:133], v[132:133], v[30:31]
    v_pk_mul_f32 v[134:135], v[134:135], v[32:33]
    v_cvt_pk_bf16_f32 v128, v128, v129
    v_cvt_pk_bf16_f32 v129, v130, v131
    v_mfma_f32_16x16x32_bf16 v[188:191], v[60:63], v[76:79], v[188:191]
    v_cvt_pk_bf16_f32 v130, v132, v133
    v_cvt_pk_bf16_f32 v131, v134, v135
    s_nop 1
    v_permlane32_swap_b32 v128, v130
    v_permlane32_swap_b32 v129, v131
    s_waitcnt lgkmcnt(6)
    v_mfma_f32_16x16x32_bf16 v[160:163], v[44:47], v[80:83], v[160:163]
    ds_read_b64_tr_b16 v[60:61], v12 offset:6304
    ds_read_b64_tr_b16 v[62:63], v12 offset:8096
    s_getreg_b32 s101, hwreg(HW_REG_IB_STS)
    s_and_b32 s101, s101, 0xc0000f
    s_or_b32 s101, s101, s100
    s_cmp_le_u32 s101, 0
    s_cbranch_scc1 LG_s7
LG_r7:
    v_mfma_f32_16x16x32_bf16 v[164:167], v[44:47], v[84:87], v[164:167]
    buffer_store_dwordx4 v[128:131], v3, s[24:27], s92 offen offset:0 sc1
    v_pk_mul_f32 v[26:27], v[136:137], s[70:71]
    v_pk_mul_f32 v[28:29], v[138:139], s[70:71]
    v_pk_mul_f32 v[30:31], v[140:141], s[70:71]
    v_pk_mul_f32 v[32:33], v[142:143], s[70:71]
    v_mfma_f32_16x16x32_bf16 v[168:171], v[44:47], v[88:91], v[168:171]
    v_exp_f32 v26, v26
    v_exp_f32 v27, v27
    v_exp_f32 v28, v28
    v_exp_f32 v29, v29
    v_exp_f32 v30, v30
    v_mfma_f32_16x16x32_bf16 v[172:175], v[44:47], v[92:95], v[172:175]
    v_exp_f32 v31, v31
    v_exp_f32 v32, v32
    v_exp_f32 v33, v33
    v_pk_mul_f32 v[136:137], v[136:137], v[152:153]
    v_pk_mul_f32 v[138:139], v[138:139], v[154:155]
    s_waitcnt lgkmcnt(6)
    v_mfma_f32_16x16x32_bf16 v[176:179], v[48:51], v[80:83], v[176:179]
    ds_read_b64_tr_b16 v[44:45], v12 offset:13472
    ds_read_b64_tr_b16 v[46:47], v12 offset:15264
    v_pk_mul_f32 v[140:141], v[140:141], v[156:157]
    v_pk_mul_f32 v[142:143], v[142:143], v[158:159]
    v_pk_add_f32 v[26:27], v[26:27], s[94:95]
    v_pk_add_f32 v[28:29], v[28:29], s[94:95]
    v_pk_add_f32 v[30:31], v[30:31], s[94:95]
    v_mfma_f32_16x16x32_bf16 v[180:183], v[48:51], v[84:87], v[180:183]
    v_pk_add_f32 v[32:33], v[32:33], s[94:95]
    v_rcp_f32 v26, v26
    v_rcp_f32 v27, v27
    v_rcp_f32 v28, v28
    v_rcp_f32 v29, v29
    v_mfma_f32_16x16x32_bf16 v[184:187], v[48:51], v[88:91], v[184:187]
    v_rcp_f32 v30, v30
    v_rcp_f32 v31, v31
    v_rcp_f32 v32, v32
    v_rcp_f32 v33, v33
    s_nop 0
    v_mfma_f32_16x16x32_bf16 v[188:191], v[48:51], v[92:95], v[188:191]
    v_pk_mul_f32 v[136:137], v[136:137], v[26:27]
    v_pk_mul_f32 v[138:139], v[138:139], v[28:29]
    v_pk_mul_f32 v[140:141], v[140:141], v[30:31]
    v_pk_mul_f32 v[142:143], v[142:143], v[32:33]
    v_cvt_pk_bf16_f32 v136, v136, v137
    s_waitcnt lgkmcnt(6)
    v_mfma_f32_16x16x32_bf16 v[192:195], v[52:55], v[64:67], v[192:195]
    ds_read_b64_tr_b16 v[48:49], v13 offset:26816
    ds_read_b64_tr_b16 v[50:51], v13 offset:28608
    v_cvt_pk_bf16_f32 v137, v138, v139
    v_cvt_pk_bf16_f32 v138, v140, v141
    v_cvt_pk_bf16_f32 v139, v142, v143
    s_nop 1
    v_permlane32_swap_b32 v136, v138
    v_mfma_f32_16x16x32_bf16 v[196:199], v[52:55], v[68:71], v[196:199]
    v_permlane32_swap_b32 v137, v139
    s_getreg_b32 s101, hwreg(HW_REG_IB_STS)
    s_and_b32 s101, s101, 0xc0000f
    s_or_b32 s101, s101, s100
    s_cmp_le_u32 s101, 1
    s_cbranch_scc1 LG_s8
LG_r8:
    v_mfma_f32_16x16x32_bf16 v[200:203], v[52:55], v[72:75], v[200:203]
    buffer_store_dwordx4 v[136:139], v3, s[24:27], s93 offen offset:0 sc1
    v_pk_mul_f32 v[26:27], v[160:161], s[70:71]
    v_pk_mul_f32 v[28:29], v[162:163], s[70:71]
    v_pk_mul_f32 v[30:31], v[164:165], s[70:71]
    v_pk_mul_f32 v[32:33], v[166:167], s[70:71]
    v_mfma_f32_16x16x32_bf16 v[204:207], v[52:55], v[76:79], v[204:207]
    v_exp_f32 v26, v26
    v_exp_f32 v27, v27
    v_exp_f32 v28, v28
    v_exp_f32 v29, v29
    v_exp_f32 v30, v30
    s_waitcnt lgkmcnt(6)
    v_mfma_f32_16x16x32_bf16 v[208:211], v[56:59], v[64:67], v[208:211]
    ds_read_b64_tr_b16 v[52:53], v13 offset:33984
    ds_read_b64_tr_b16 v[54:55], v13 offset:35776
    v_exp_f32 v31, v31
    v_exp_f32 v32, v32
    v_exp_f32 v33, v33
    v_pk_mul_f32 v[160:161], v[160:161], v[176:177]
    v_pk_mul_f32 v[162:163], v[162:163], v[178:179]
    v_mfma_f32_16x16x32_bf16 v[212:215], v[56:59], v[68:71], v[212:215]
    v_pk_mul_f32 v[164:165], v[164:165], v[180:181]
    v_pk_mul_f32 v[166:167], v[166:167], v[182:183]
    v_pk_add_f32 v[26:27], v[26:27], s[94:95]
    v_pk_add_f32 v[28:29], v[28:29], s[94:95]
    v_pk_add_f32 v[30:31], v[30:31], s[94:95]
    v_mfma_f32_16x16x32_bf16 v[216:219], v[56:59], v[72:75], v[216:219]
    v_pk_add_f32 v[32:33], v[32:33], s[94:95]
    v_rcp_f32 v26, v26
    v_rcp_f32 v27, v27
    v_rcp_f32 v28, v28
    v_rcp_f32 v29, v29
    v_mfma_f32_16x16x32_bf16 v[220:223], v[56:59], v[76:79], v[220:223]
    v_rcp_f32 v30, v30
    v_rcp_f32 v31, v31
    v_rcp_f32 v32, v32
    v_rcp_f32 v33, v33
    s_nop 0
    s_waitcnt lgkmcnt(6)
    v_mfma_f32_16x16x32_bf16 v[192:195], v[60:63], v[80:83], v[192:195]
    ds_read_b64_tr_b16 v[56:57], v12 offset:6336
    ds_read_b64_tr_b16 v[58:59], v12 offset:8128
    v_pk_mul_f32 v[160:161], v[160:161], v[26:27]
    v_pk_mul_f32 v[162:163], v[162:163], v[28:29]
    v_pk_mul_f32 v[164:165], v[164:165], v[30:31]
    v_pk_mul_f32 v[166:167], v[166:167], v[32:33]
    v_cvt_pk_bf16_f32 v160, v160, v161
    v_mfma_f32_16x16x32_bf16 v[196:199], v[60:63], v[84:87], v[196:199]
    v_cvt_pk_bf16_f32 v161, v162, v163
    v_cvt_pk_bf16_f32 v162, v164, v165
    v_cvt_pk_bf16_f32 v163, v166, v167
    s_nop 1
    v_permlane32_swap_b32 v160, v162
    v_mfma_f32_16x16x32_bf16 v[200:203], v[60:63], v[88:91], v[200:203]
    v_permlane32_swap_b32 v161, v163
    s_getreg_b32 s101, hwreg(HW_REG_IB_STS)
    s_and_b32 s101, s101, 0xc0000f
    s_or_b32 s101, s101, s100
    s_cmp_le_u32 s101, 2
    s_cbranch_scc1 LG_s9
LG_r9:
    v_mfma_f32_16x16x32_bf16 v[204:207], v[60:63], v[92:95], v[204:207]
    buffer_store_dwordx4 v[160:163], v3, s[24:27], s92 offen offset:512 sc1
    v_pk_mul_f32 v[26:27], v[168:169], s[70:71]
    v_pk_mul_f32 v[28:29], v[170:171], s[70:71]
    v_pk_mul_f32 v[30:31], v[172:173], s[70:71]
    v_pk_mul_f32 v[32:33], v[174:175], s[70:71]
    s_waitcnt lgkmcnt(6)
    v_mfma_f32_16x16x32_bf16 v[208:211], v[44:47], v[80:83], v[208:211]
    ds_read_b64_tr_b16 v[60:61], v12 offset:13504
    ds_read_b64_tr_b16 v[62:63], v12 offset:15296
    v_exp_f32 v26, v26
    v_exp_f32 v27, v27
    v_exp_f32 v28, v28
    v_exp_f32 v29, v29
    v_exp_f32 v30, v30
    v_mfma_f32_16x16x32_bf16 v[212:215], v[44:47], v[84:87], v[212:215]
    v_exp_f32 v31, v31
    v_exp_f32 v32, v32
    v_exp_f32 v33, v33
    v_pk_mul_f32 v[168:169], v[168:169], v[184:185]
    v_pk_mul_f32 v[170:171], v[170:171], v[186:187]
    v_mfma_f32_16x16x32_bf16 v[216:219], v[44:47], v[88:91], v[216:219]
    v_pk_mul_f32 v[172:173], v[172:173], v[188:189]
    v_pk_mul_f32 v[174:175], v[174:175], v[190:191]
    v_pk_add_f32 v[26:27], v[26:27], s[94:95]
    v_pk_add_f32 v[28:29], v[28:29], s[94:95]
    v_pk_add_f32 v[30:31], v[30:31], s[94:95]
    v_mfma_f32_16x16x32_bf16 v[220:223], v[44:47], v[92:95], v[220:223]
    v_pk_add_f32 v[32:33], v[32:33], s[94:95]
    v_rcp_f32 v26, v26
    v_rcp_f32 v27, v27
    v_rcp_f32 v28, v28
    v_rcp_f32 v29, v29
    s_waitcnt lgkmcnt(6)
    v_mfma_f32_16x16x32_bf16 v[224:227], v[48:51], v[64:67], v[224:227]
    v_rcp_f32 v30, v30
    v_rcp_f32 v31, v31
    v_rcp_f32 v32, v32
    v_rcp_f32 v33, v33
    s_nop 0
    v_mfma_f32_16x16x32_bf16 v[228:231], v[48:51], v[68:71], v[228:231]
    v_pk_mul_f32 v[168:169], v[168:169], v[26:27]
    v_pk_mul_f32 v[170:171], v[170:171], v[28:29]
    v_pk_mul_f32 v[172:173], v[172:173], v[30:31]
    v_pk_mul_f32 v[174:175], v[174:175], v[32:33]
    v_cvt_pk_bf16_f32 v168, v168, v169
    v_mfma_f32_16x16x32_bf16 v[232:235], v[48:51], v[72:75], v[232:235]
    v_cvt_pk_bf16_f32 v169, v170, v171
    v_cvt_pk_bf16_f32 v170, v172, v173
    v_cvt_pk_bf16_f32 v171, v174, v175
    s_nop 1
    v_permlane32_swap_b32 v168, v170
    v_mfma_f32_16x16x32_bf16 v[236:239], v[48:51], v[76:79], v[236:239]
    v_permlane32_swap_b32 v169, v171
    s_getreg_b32 s101, hwreg(HW_REG_IB_STS)
    s_and_b32 s101, s101, 0xc0000f
    s_or_b32 s101, s101, s100
    s_cmp_le_u32 s101, 3
    s_cbranch_scc1 LG_s10
LG_r10:
    s_waitcnt lgkmcnt(4)
    v_mfma_f32_16x16x32_bf16 v[240:243], v[52:55], v[64:67], v[240:243]
    buffer_store_dwordx4 v[168:171], v3, s[24:27], s93 offen offset:512 sc1
    v_pk_mul_f32 v[26:27], v[192:193], s[70:71]
    v_pk_mul_f32 v[28:29], v[194:195], s[70:71]
    v_pk_mul_f32 v[30:31], v[196:197], s[70:71]
    v_pk_mul_f32 v[32:33], v[198:199], s[70:71]
    v_mfma_f32_16x16x32_bf16 v[244:247], v[52:55], v[68:71], v[244:247]
    v_exp_f32 v26, v26
    v_exp_f32 v27, v27
    v_exp_f32 v28, v28
    v_exp_f32 v29, v29
    v_exp_f32 v30, v30
    v_mfma_f32_16x16x32_bf16 v[248:251], v[52:55], v[72:75], v[248:251]
    v_exp_f32 v31, v31
    v_exp_f32 v32, v32
    v_exp_f32 v33, v33
    v_pk_mul_f32 v[192:193], v[192:193], v[208:209]
    v_pk_mul_f32 v[194:195], v[194:195], v[210:211]
    v_mfma_f32_16x16x32_bf16 v[252:255], v[52:55], v[76:79], v[252:255]
    v_pk_mul_f32 v[196:197], v[196:197], v[212:213]
    v_pk_mul_f32 v[198:199], v[198:199], v[214:215]
    v_pk_add_f32 v[26:27], v[26:27], s[94:95]
    v_pk_add_f32 v[28:29], v[28:29], s[94:95]
    v_pk_add_f32 v[30:31], v[30:31], s[94:95]
    s_waitcnt lgkmcnt(2)
    v_mfma_f32_16x16x32_bf16 v[224:227], v[56:59], v[80:83], v[224:227]
    v_pk_add_f32 v[32:33], v[32:33], s[94:95]
    v_rcp_f32 v26, v26
    v_rcp_f32 v27, v27
    v_rcp_f32 v28, v28
    v_rcp_f32 v29, v29
    v_mfma_f32_16x16x32_bf16 v[228:231], v[56:59], v[84:87], v[228:231]
    v_rcp_f32 v30, v30
    v_rcp_f32 v31, v31
    v_rcp_f32 v32, v32
    v_rcp_f32 v33, v33
    s_nop 0
    v_mfma_f32_16x16x32_bf16 v[232:235], v[56:59], v[88:91], v[232:235]
    v_pk_mul_f32 v[192:193], v[192:193], v[26:27]
    v_pk_mul_f32 v[194:195], v[194:195], v[28:29]
    v_pk_mul_f32 v[196:197], v[196:197], v[30:31]
    v_pk_mul_f32 v[198:199], v[198:199], v[32:33]
    v_cvt_pk_bf16_f32 v192, v192, v193
    v_mfma_f32_16x16x32_bf16 v[236:239], v[56:59], v[92:95], v[236:239]
    v_cvt_pk_bf16_f32 v193, v194, v195
    v_cvt_pk_bf16_f32 v194, v196, v197
    v_cvt_pk_bf16_f32 v195, v198, v199
    s_nop 1
    v_permlane32_swap_b32 v192, v194
    s_waitcnt lgkmcnt(0)
    v_mfma_f32_16x16x32_bf16 v[240:243], v[60:63], v[80:83], v[240:243]
    v_permlane32_swap_b32 v193, v195
    s_getreg_b32 s101, hwreg(HW_REG_IB_STS)
    s_and_b32 s101, s101, 0xc0000f
    s_or_b32 s101, s101, s100
    s_cmp_le_u32 s101, 4
    s_cbranch_scc1 LG_s11
LG_r11:
    v_mfma_f32_16x16x32_bf16 v[244:247], v[60:63], v[84:87], v[244:247]
    v_pk_mul_f32 v[26:27], v[200:201], s[70:71]
    v_pk_mul_f32 v[28:29], v[202:203], s[70:71]
    v_pk_mul_f32 v[30:31], v[204:205], s[70:71]
    v_pk_mul_f32 v[32:33], v[206:207], s[70:71]
    v_exp_f32 v26, v26
    v_mfma_f32_16x16x32_bf16 v[248:251], v[60:63], v[88:91], v[248:251]
    v_exp_f32 v27, v27
    v_exp_f32 v28, v28
    v_exp_f32 v29, v29
    v_exp_f32 v30, v30
    v_exp_f32 v31, v31
    v_mfma_f32_16x16x32_bf16 v[252:255], v[60:63], v[92:95], v[252:255]
    v_exp_f32 v32, v32
    v_exp_f32 v33, v33
    v_pk_mul_f32 v[200:201], v[200:201], v[216:217]
    v_pk_mul_f32 v[202:203], v[202:203], v[218:219]
    v_pk_mul_f32 v[204:205], v[204:205], v[220:221]
    s_nop 7
    v_pk_mul_f32 v[206:207], v[206:207], v[222:223]
    v_pk_add_f32 v[26:27], v[26:27], s[94:95]
    v_pk_add_f32 v[28:29], v[28:29], s[94:95]
    v_pk_add_f32 v[30:31], v[30:31], s[94:95]
    v_pk_add_f32 v[32:33], v[32:33], s[94:95]
    v_rcp_f32 v26, v26
    v_rcp_f32 v27, v27
    v_rcp_f32 v28, v28
    v_rcp_f32 v29, v29
    v_rcp_f32 v30, v30
    v_rcp_f32 v31, v31
    v_rcp_f32 v32, v32
    v_rcp_f32 v33, v33
    s_nop 0
    v_pk_mul_f32 v[200:201], v[200:201], v[26:27]
    v_pk_mul_f32 v[202:203], v[202:203], v[28:29]
    v_pk_mul_f32 v[204:205], v[204:205], v[30:31]
    v_pk_mul_f32 v[206:207], v[206:207], v[32:33]
    v_cvt_pk_bf16_f32 v200, v200, v201
    v_cvt_pk_bf16_f32 v201, v202, v203
    v_cvt_pk_bf16_f32 v202, v204, v205
    v_cvt_pk_bf16_f32 v203, v206, v207
    s_nop 1
    v_permlane32_swap_b32 v200, v202
    v_permlane32_swap_b32 v201, v203
    s_getreg_b32 s101, hwreg(HW_REG_IB_STS)
    s_and_b32 s101, s101, 0xc0000f
    s_or_b32 s101, s101, s100
    s_cmp_le_u32 s101, 4
    s_cbranch_scc1 LG_s12
LG_r12:
    v_pk_mul_f32 v[26:27], v[224:225], s[70:71]
    v_pk_mul_f32 v[28:29], v[226:227], s[70:71]
    v_pk_mul_f32 v[30:31], v[228:229], s[70:71]
    v_pk_mul_f32 v[32:33], v[230:231], s[70:71]
    v_exp_f32 v26, v26
    v_exp_f32 v27, v27
    v_exp_f32 v28, v28
    v_exp_f32 v29, v29
    v_exp_f32 v30, v30
    v_exp_f32 v31, v31
    v_exp_f32 v32, v32
    v_exp_f32 v33, v33
    v_pk_mul_f32 v[224:225], v[224:225], v[240:241]
    v_pk_mul_f32 v[226:227], v[226:227], v[242:243]
    v_pk_mul_f32 v[228:229], v[228:229], v[244:245]
    v_pk_mul_f32 v[230:231], v[230:231], v[246:247]
    v_pk_add_f32 v[26:27], v[26:27], s[94:95]
    v_pk_add_f32 v[28:29], v[28:29], s[94:95]
    v_pk_add_f32 v[30:31], v[30:31], s[94:95]
    v_pk_add_f32 v[32:33], v[32:33], s[94:95]
    v_rcp_f32 v26, v26
    v_rcp_f32 v27, v27
    v_rcp_f32 v28, v28
    v_rcp_f32 v29, v29
    v_rcp_f32 v30, v30
    v_rcp_f32 v31, v31
    v_rcp_f32 v32, v32
    v_rcp_f32 v33, v33
    s_nop 0
    v_pk_mul_f32 v[224:225], v[224:225], v[26:27]
    v_pk_mul_f32 v[226:227], v[226:227], v[28:29]
    v_pk_mul_f32 v[228:229], v[228:229], v[30:31]
    v_pk_mul_f32 v[230:231], v[230:231], v[32:33]
    v_cvt_pk_bf16_f32 v224, v224, v225
    v_cvt_pk_bf16_f32 v225, v226, v227
    v_cvt_pk_bf16_f32 v226, v228, v229
    v_cvt_pk_bf16_f32 v227, v230, v231
    s_nop 1
    v_permlane32_swap_b32 v224, v226
    v_permlane32_swap_b32 v225, v227
    s_getreg_b32 s101, hwreg(HW_REG_IB_STS)
    s_and_b32 s101, s101, 0xc0000f
    s_or_b32 s101, s101, s100
    s_cmp_le_u32 s101, 4
    s_cbranch_scc1 LG_s13
LG_r13:
    v_pk_mul_f32 v[26:27], v[232:233], s[70:71]
    v_pk_mul_f32 v[28:29], v[234:235], s[70:71]
    v_pk_mul_f32 v[30:31], v[236:237], s[70:71]
    v_pk_mul_f32 v[32:33], v[238:239], s[70:71]
    v_exp_f32 v26, v26
    v_exp_f32 v27, v27
    v_exp_f32 v28, v28
    v_exp_f32 v29, v29
    v_exp_f32 v30, v30
    v_exp_f32 v31, v31
    v_exp_f32 v32, v32
    v_exp_f32 v33, v33
    v_pk_mul_f32 v[232:233], v[232:233], v[248:249]
    v_pk_mul_f32 v[234:235], v[234:235], v[250:251]
    v_pk_mul_f32 v[236:237], v[236:237], v[252:253]
    v_pk_mul_f32 v[238:239], v[238:239], v[254:255]
    v_pk_add_f32 v[26:27], v[26:27], s[94:95]
    v_pk_add_f32 v[28:29], v[28:29], s[94:95]
    v_pk_add_f32 v[30:31], v[30:31], s[94:95]
    v_pk_add_f32 v[32:33], v[32:33], s[94:95]
    v_rcp_f32 v26, v26
    v_rcp_f32 v27, v27
    v_rcp_f32 v28, v28
    v_rcp_f32 v29, v29
    v_rcp_f32 v30, v30
    v_rcp_f32 v31, v31
    v_rcp_f32 v32, v32
    v_rcp_f32 v33, v33
    s_nop 0
    v_pk_mul_f32 v[232:233], v[232:233], v[26:27]
    v_pk_mul_f32 v[234:235], v[234:235], v[28:29]
    v_pk_mul_f32 v[236:237], v[236:237], v[30:31]
    v_pk_mul_f32 v[238:239], v[238:239], v[32:33]
    v_cvt_pk_bf16_f32 v232, v232, v233
    v_cvt_pk_bf16_f32 v233, v234, v235
    v_cvt_pk_bf16_f32 v234, v236, v237
    v_cvt_pk_bf16_f32 v235, v238, v239
    s_nop 1
    v_permlane32_swap_b32 v232, v234
    v_permlane32_swap_b32 v233, v235
    s_cmp_eq_u32 s100, 0
    s_cbranch_scc1 LG_s14
LG_r14:
    v_mov_b32 v80, v192
    v_mov_b32 v81, v193
    v_mov_b32 v82, v194
    v_mov_b32 v83, v195
    v_mov_b32 v84, v200
    v_mov_b32 v85, v201
    v_mov_b32 v86, v202
    v_mov_b32 v87, v203
    v_mov_b32 v88, v224
    v_mov_b32 v89, v225
    v_mov_b32 v90, v226
    v_mov_b32 v91, v227
    v_mov_b32 v92, v232
    v_mov_b32 v93, v233
    v_mov_b32 v94, v234
    v_mov_b32 v95, v235
    s_add_u32 s92, s92, 1024
    s_add_u32 s93, s93, 1024
LB_common:
    s_mov_b32 s100, 0
    s_andn2_b32 s60, s53, 7
    s_lshl_b32 s60, s60, 9
    s_add_u32 s60, s60, 0x2c10000
    s_cmp_eq_u32 s7, 1
    s_cbranch_scc1 LB_nokv
    s_waitcnt vmcnt(7)
    ds_write_b128 v34, v[40:43] offset:0
    s_waitcnt vmcnt(6)
    ds_write_b128 v34, v[44:47] offset:1024
    s_waitcnt vmcnt(5)
    ds_write_b128 v34, v[48:51] offset:2048
    s_waitcnt vmcnt(4)
    ds_write_b128 v34, v[52:55] offset:3072
    s_waitcnt vmcnt(3)
    ds_write_b128 v34, v[56:59] offset:4096
    s_waitcnt vmcnt(2)
    ds_write_b128 v34, v[60:63] offset:5120
    s_waitcnt vmcnt(1)
    ds_write_b128 v34, v[64:67] offset:6144
    s_waitcnt vmcnt(0)
    ds_write_b128 v34, v[68:71] offset:7168
LB_nokv:
    s_waitcnt lgkmcnt(0)
    s_barrier
    ds_read_b128 v[32:35], v10 offset:0
    ds_read_b128 v[36:39], v10 offset:512
    ds_read_b128 v[216:219], v8 offset:0
    ds_read_b128 v[220:223], v8 offset:512
    ds_read_b128 v[224:227], v8 offset:32768
    ds_read_b128 v[228:231], v8 offset:33280
    ds_read_b128 v[232:235], v8 offset:4096
    ds_read_b128 v[236:239], v8 offset:4608
    ds_read_b128 v[112:115], v8 offset:8192
    ds_read_b128 v[116:119], v8 offset:8704
    s_mov_b32 s58, 0
    s_cmp_eq_u32 s4, 0
    s_cbranch_scc1 LB_nb
LB_nbr:
    v_and_b32 v26, 31, v1
    v_mov_b32 v27, 2
    v_lshlrev_b32 v26, v26, v27
    v_add_u32 v26, -1, v26
    v_lshrrev_b32 v27, 5, v1
    v_lshlrev_b32 v27, 2, v27
    v_lshrrev_b32 v26, v27, v26
    s_mov_b32 s70, 0xffff
    buffer_store_dwordx4 v[80:83], v3, s[24:27], s92 offen offset:0 sc1
    buffer_store_dwordx4 v[84:87], v3, s[24:27], s93 offen offset:0 sc1
    buffer_store_dwordx4 v[88:91], v3, s[24:27], s92 offen offset:512 sc1
    buffer_store_dwordx4 v[92:95], v3, s[24:27], s93 offen offset:512 sc1
    s_waitcnt lgkmcnt(7)
    s_cmp_gt_u32 s58, 0
    s_cbranch_scc1 LB_m0
    v_mfma_f32_32x32x16_bf16 v[136:151], v[216:219], v[32:35], 0
LB_n0:
    s_waitcnt lgkmcnt(5)
    v_mfma_f32_32x32x16_bf16 v[152:167], v[224:227], v[32:35], 0
    v_bfe_i32 v184, v26, 0, 1
    v_bfe_i32 v185, v26, 1, 1
    v_bfe_i32 v186, v26, 2, 1
    v_bfe_i32 v187, v26, 3, 1
    v_bfe_i32 v188, v26, 8, 1
    v_bfe_i32 v189, v26, 9, 1
    v_bfe_i32 v190, v26, 10, 1
    v_bfe_i32 v191, v26, 11, 1
    v_bfe_i32 v192, v26, 16, 1
    v_bfe_i32 v193, v26, 17, 1
    v_bfe_i32 v194, v26, 18, 1
    v_bfe_i32 v195, v26, 19, 1
    v_bfe_i32 v196, v26, 24, 1
    v_bfe_i32 v197, v26, 25, 1
    v_bfe_i32 v198, v26, 26, 1
    v_bfe_i32 v199, v26, 27, 1
    v_mfma_f32_32x32x16_bf16 v[136:151], v[220:223], v[36:39], v[136:151]
    ds_read_b128 v[216:219], v8 offset:12288
    ds_read_b128 v[220:223], v8 offset:12800
    s_waitcnt lgkmcnt(6)
    v_mfma_f32_32x32x16_bf16 v[152:167], v[228:231], v[36:39], v[152:167]
    ds_read_b128 v[224:227], v8 offset:16384
    ds_read_b128 v[228:231], v8 offset:16896
    ds_read_b128 v[40:43], v9 offset:2048
    ds_read_b128 v[44:47], v9 offset:3072
    ds_read_b128 v[48:51], v9 offset:34816
    ds_read_b128 v[52:55], v9 offset:35840
    ds_read_b128 v[56:59], v9 offset:6144
    ds_read_b128 v[60:63], v9 offset:7168
    v_bfi_b32 v72, s70, v184, v185
    v_bfi_b32 v73, s70, v186, v187
    v_bfi_b32 v74, s70, v188, v189
    v_bfi_b32 v75, s70, v190, v191
    v_bfi_b32 v76, s70, v192, v193
    v_bfi_b32 v77, s70, v194, v195
    v_bfi_b32 v78, s70, v196, v197
    v_bfi_b32 v79, s70, v198, v199
    s_getreg_b32 s101, hwreg(HW_REG_IB_STS)
    s_and_b32 s101, s101, 0xc0000f
    s_or_b32 s101, s101, s100
    s_cmp_le_u32 s101, 0
    s_cbranch_scc1 LG_s15
LG_r15:
    v_bfi_b32 v152, v184, v152, v136
    v_bfi_b32 v153, v185, v153, v137
    v_bfi_b32 v154, v186, v154, v138
    v_bfi_b32 v155, v187, v155, v139
    v_bfi_b32 v156, v188, v156, v140
    v_bfi_b32 v157, v189, v157, v141
    v_bfi_b32 v158, v190, v158, v142
    v_bfi_b32 v159, v191, v159, v143
    v_bfi_b32 v160, v192, v160, v144
    v_bfi_b32 v161, v193, v161, v145
    v_bfi_b32 v162, v194, v162, v146
    v_bfi_b32 v163, v195, v163, v147
    v_bfi_b32 v164, v196, v164, v148
    v_bfi_b32 v165, v197, v165, v149
    v_bfi_b32 v166, v198, v166, v150
    v_bfi_b32 v167, v199, v167, v151
    v_max_f32 v26, v152, v153
    v_max_f32 v27, v154, v155
    v_max3_f32 v26, v26, v156, v157
    v_max3_f32 v27, v27, v158, v159
    v_max3_f32 v26, v26, v160, v161
    v_max3_f32 v27, v27, v162, v163
    v_max3_f32 v26, v26, v164, v165
    v_max3_f32 v27, v27, v166, v167
    v_max_f32 v26, v26, v27
    v_mov_b32 v27, v26
    s_nop 1
    v_permlane32_swap_b32 v26, v27
    v_max_f32 v26, v26, v27
    v_mul_f32 v26, -1.0, v26
    v_mov_b32 v27, v26
    v_mov_b32 v200, v26
    v_mov_b32 v201, v26
    v_mov_b32 v202, v26
    v_mov_b32 v203, v26
    v_mov_b32 v204, v26
    v_mov_b32 v205, v26
    v_mov_b32 v206, v26
    v_mov_b32 v207, v26
    v_mov_b32 v208, v26
    v_mov_b32 v209, v26
    v_mov_b32 v210, v26
    v_mov_b32 v211, v26
    v_mov_b32 v212, v26
    v_mov_b32 v213, v26
    v_mov_b32 v214, v26
    v_mov_b32 v215, v26
    v_pk_add_f32 v[152:153], v[152:153], v[26:27]
    v_pk_add_f32 v[154:155], v[154:155], v[26:27]
    s_waitcnt lgkmcnt(13)
    s_cmp_gt_u32 s58, 1
    s_cbranch_scc1 LB_m1
    v_mfma_f32_32x32x16_bf16 v[168:183], v[232:235], v[32:35], v[200:215]
LB_n1:
    v_pk_add_f32 v[156:157], v[156:157], v[26:27]
    v_pk_add_f32 v[158:159], v[158:159], v[26:27]
    v_pk_add_f32 v[160:161], v[160:161], v[26:27]
    v_pk_add_f32 v[162:163], v[162:163], v[26:27]
    v_pk_add_f32 v[164:165], v[164:165], v[26:27]
    v_pk_add_f32 v[166:167], v[166:167], v[26:27]
    s_getreg_b32 s101, hwreg(HW_REG_IB_STS)
    s_and_b32 s101, s101, 0xc0000f
    s_or_b32 s101, s101, s100
    s_cmp_le_u32 s101, 0
    s_cbranch_scc1 LG_s16
LG_r16:
    v_exp_f32 v152, v152
    v_exp_f32 v153, v153
    s_waitcnt lgkmcnt(12)
    v_mfma_f32_32x32x16_bf16 v[168:183], v[236:239], v[36:39], v[168:183]
    ds_read_b128 v[232:235], v8 offset:20480
    ds_read_b128 v[236:239], v8 offset:20992
    v_exp_f32 v154, v154
    v_exp_f32 v155, v155
    v_exp_f32 v156, v156
    v_exp_f32 v157, v157
    v_exp_f32 v158, v158
    s_waitcnt lgkmcnt(13)
    s_cmp_gt_u32 s58, 2
    s_cbranch_scc1 LB_m2
    v_mfma_f32_32x32x16_bf16 v[184:199], v[112:115], v[32:35], v[200:215]
LB_n2:
    v_exp_f32 v159, v159
    v_exp_f32 v160, v160
    v_exp_f32 v161, v161
    v_exp_f32 v162, v162
    v_exp_f32 v163, v163
    s_waitcnt lgkmcnt(12)
    v_mfma_f32_32x32x16_bf16 v[184:199], v[116:119], v[36:39], v[184:199]
    ds_read_b128 v[112:115], v8 offset:24576
    ds_read_b128 v[116:119], v8 offset:25088
    v_exp_f32 v164, v164
    v_exp_f32 v165, v165
    v_exp_f32 v166, v166
    v_exp_f32 v167, v167
    ds_read_b128 v[64:67], v9 offset:10240
    ds_read_b128 v[68:71], v9 offset:11264
    ds_read_b128 v[96:99], v9 offset:14336
    ds_read_b128 v[100:103], v9 offset:15360
    ds_read_b128 v[104:107], v9 offset:18432
    ds_read_b128 v[108:111], v9 offset:19456
    v_pk_add_f32 v[28:29], v[152:153], v[156:157]
    v_pk_add_f32 v[30:31], v[154:155], v[158:159]
    v_pk_add_f32 v[28:29], v[28:29], v[160:161]
    v_pk_add_f32 v[30:31], v[30:31], v[162:163]
    v_pk_add_f32 v[28:29], v[28:29], v[164:165]
    v_pk_add_f32 v[30:31], v[30:31], v[166:167]
    v_cvt_pk_bf16_f32 v152, v152, v153
    v_cvt_pk_bf16_f32 v153, v154, v155
    v_cvt_pk_bf16_f32 v154, v156, v157
    v_cvt_pk_bf16_f32 v155, v158, v159
    v_cvt_pk_bf16_f32 v156, v160, v161
    v_cvt_pk_bf16_f32 v157, v162, v163
    v_cvt_pk_bf16_f32 v158, v164, v165
    v_cvt_pk_bf16_f32 v159, v166, v167
    v_bfi_b32 v136, v72, 0, v152
    v_bfi_b32 v137, v73, 0, v153
    v_bfi_b32 v138, v74, 0, v154
    v_bfi_b32 v139, v75, 0, v155
    v_bfi_b32 v140, v76, 0, v156
    v_bfi_b32 v141, v77, 0, v157
    v_bfi_b32 v142, v78, 0, v158
    v_bfi_b32 v143, v79, 0, v159
    v_and_b32 v152, v72, v152
    v_and_b32 v153, v73, v153
    v_and_b32 v154, v74, v154
    v_and_b32 v155, v75, v155
    v_and_b32 v156, v76, v156
    v_and_b32 v157, v77, v157
    v_and_b32 v158, v78, v158
    v_and_b32 v159, v79, v159
    s_getreg_b32 s101, hwreg(HW_REG_IB_STS)
    s_and_b32 s101, s101, 0xc0000f
    s_or_b32 s101, s101, s100
    s_cmp_le_u32 s101, 0
    s_cbranch_scc1 LG_s17
LG_r17:
    s_cmp_eq_u32 s7, 0
    s_cbranch_scc1 LP_2
    s_setprio 1
LP_2:
    v_exp_f32 v168, v168
    v_exp_f32 v169, v169
    s_waitcnt lgkmcnt(15)
    v_mfma_f32_32x32x16_bf16 v[120:135], v[40:43], v[136:139], 0
    v_exp_f32 v170, v170
    v_exp_f32 v171, v171
    v_exp_f32 v172, v172
    v_exp_f32 v173, v173
    s_waitcnt lgkmcnt(14)
    v_mfma_f32_32x32x16_bf16 v[120:135], v[44:47], v[140:143], v[120:135]
    ds_read_b128 v[40:43], v9 offset:22528
    ds_read_b128 v[44:47], v9 offset:23552
    v_exp_f32 v174, v174
    v_exp_f32 v175, v175
    v_exp_f32 v176, v176
    v_exp_f32 v177, v177
    s_waitcnt lgkmcnt(15)
    v_mfma_f32_32x32x16_bf16 v[120:135], v[48:51], v[152:155], v[120:135]
    v_exp_f32 v178, v178
    v_exp_f32 v179, v179
    v_exp_f32 v180, v180
    v_exp_f32 v181, v181
    s_waitcnt lgkmcnt(14)
    v_mfma_f32_32x32x16_bf16 v[120:135], v[52:55], v[156:159], v[120:135]
    ds_read_b128 v[48:51], v9 offset:26624
    ds_read_b128 v[52:55], v9 offset:27648
    v_exp_f32 v182, v182
    v_exp_f32 v183, v183
    v_pk_add_f32 v[28:29], v[28:29], v[168:169]
    v_pk_add_f32 v[30:31], v[30:31], v[170:171]
    v_pk_add_f32 v[28:29], v[28:29], v[172:173]
    s_cmp_gt_u32 s58, 3
    s_cbranch_scc1 LB_m3
    v_mfma_f32_32x32x16_bf16 v[136:151], v[216:219], v[32:35], v[200:215]
LB_n3:
    v_pk_add_f32 v[30:31], v[30:31], v[174:175]
    v_pk_add_f32 v[28:29], v[28:29], v[176:177]
    v_pk_add_f32 v[30:31], v[30:31], v[178:179]
    v_pk_add_f32 v[28:29], v[28:29], v[180:181]
    v_pk_add_f32 v[30:31], v[30:31], v[182:183]
    v_cvt_pk_bf16_f32 v168, v168, v169
    v_cvt_pk_bf16_f32 v169, v170, v171
    v_cvt_pk_bf16_f32 v170, v172, v173
    v_mfma_f32_32x32x16_bf16 v[136:151], v[220:223], v[36:39], v[136:151]
    ds_read_b128 v[216:219], v8 offset:28672
    ds_read_b128 v[220:223], v8 offset:29184
    v_cvt_pk_bf16_f32 v171, v174, v175
    v_cvt_pk_bf16_f32 v172, v176, v177
    v_cvt_pk_bf16_f32 v173, v178, v179
    v_cvt_pk_bf16_f32 v174, v180, v181
    v_cvt_pk_bf16_f32 v175, v182, v183
    s_getreg_b32 s101, hwreg(HW_REG_IB_STS)
    s_and_b32 s101, s101, 0xc0000f
    s_or_b32 s101, s101, s100
    s_cmp_le_u32 s101, 0
    s_cbranch_scc1 LG_s18
LG_r18:
    s_add_u32 m0, s37, 98304
    s_nop 0
    buffer_load_dwordx4 v4, s[12:15], s21 offen offset:0 lds
    buffer_load_dwordx4 v5, s[12:15], s21 offen offset:1024 lds
    s_setprio 0
    v_exp_f32 v184, v184
    v_exp_f32 v185, v185
    s_waitcnt lgkmcnt(15)
    v_mfma_f32_32x32x16_bf16 v[120:135], v[56:59], v[168:171], v[120:135]
    v_exp_f32 v186, v186
    v_exp_f32 v187, v187
    v_exp_f32 v188, v188
    v_exp_f32 v189, v189
    v_exp_f32 v190, v190
    s_waitcnt lgkmcnt(15)
    v_mfma_f32_32x32x16_bf16 v[120:135], v[60:63], v[172:175], v[120:135]
    ds_read_b128 v[56:59], v9 offset:30720
    ds_read_b128 v[60:63], v9 offset:31744
    v_exp_f32 v191, v191
    v_exp_f32 v192, v192
    v_exp_f32 v193, v193
    v_exp_f32 v194, v194
    v_exp_f32 v195, v195
    s_cmp_gt_u32 s58, 4
    s_cbranch_scc1 LB_m4
    v_mfma_f32_32x32x16_bf16 v[152:167], v[224:227], v[32:35], v[200:215]
LB_n4:
    v_exp_f32 v196, v196
    v_exp_f32 v197, v197
    v_exp_f32 v198, v198
    v_exp_f32 v199, v199
    v_pk_add_f32 v[28:29], v[28:29], v[184:185]
    v_pk_add_f32 v[30:31], v[30:31], v[186:187]
    v_pk_add_f32 v[28:29], v[28:29], v[188:189]
    v_mfma_f32_32x32x16_bf16 v[152:167], v[228:231], v[36:39], v[152:167]
    v_pk_add_f32 v[30:31], v[30:31], v[190:191]
    v_pk_add_f32 v[28:29], v[28:29], v[192:193]
    v_pk_add_f32 v[30:31], v[30:31], v[194:195]
    v_pk_add_f32 v[28:29], v[28:29], v[196:197]
    v_pk_add_f32 v[30:31], v[30:31], v[198:199]
    v_cvt_pk_bf16_f32 v184, v184, v185
    v_cvt_pk_bf16_f32 v185, v186, v187
    v_cvt_pk_bf16_f32 v186, v188, v189
    v_cvt_pk_bf16_f32 v187, v190, v191
    v_cvt_pk_bf16_f32 v188, v192, v193
    v_cvt_pk_bf16_f32 v189, v194, v195
    v_cvt_pk_bf16_f32 v190, v196, v197
    v_cvt_pk_bf16_f32 v191, v198, v199
    s_getreg_b32 s101, hwreg(HW_REG_IB_STS)
    s_and_b32 s101, s101, 0xc0000f
    s_or_b32 s101, s101, s100
    s_cmp_le_u32 s101, 2
    s_cbranch_scc1 LG_s19
LG_r19:
    s_add_u32 m0, s37, 114688
    s_nop 0
    s_add_u32 s21, s21, 0x20000
    buffer_load_dwordx4 v4, s[12:15], s21 offen offset:0 lds
    buffer_load_dwordx4 v5, s[12:15], s21 offen offset:1024 lds
    s_cmp_eq_u32 s7, 0
    s_cbranch_scc1 LP_4
    s_setprio 1
LP_4:
    v_exp_f32 v136, v136
    v_exp_f32 v137, v137
    s_waitcnt lgkmcnt(13)
    v_mfma_f32_32x32x16_bf16 v[120:135], v[64:67], v[184:187], v[120:135]
    v_exp_f32 v138, v138
    v_exp_f32 v139, v139
    v_exp_f32 v140, v140
    v_exp_f32 v141, v141
    v_exp_f32 v142, v142
    s_waitcnt lgkmcnt(12)
    v_mfma_f32_32x32x16_bf16 v[120:135], v[68:71], v[188:191], v[120:135]
    v_exp_f32 v143, v143
    v_exp_f32 v144, v144
    v_exp_f32 v145, v145
    v_exp_f32 v146, v146
    v_exp_f32 v147, v147
    s_cmp_gt_u32 s58, 5
    s_cbranch_scc1 LB_m5
    v_mfma_f32_32x32x16_bf16 v[168:183], v[232:235], v[32:35], v[200:215]
LB_n5:
    v_exp_f32 v148, v148
    v_exp_f32 v149, v149
    v_exp_f32 v150, v150
    v_exp_f32 v151, v151
    v_pk_add_f32 v[28:29], v[28:29], v[136:137]
    v_pk_add_f32 v[30:31], v[30:31], v[138:139]
    v_pk_add_f32 v[28:29], v[28:29], v[140:141]
    v_mfma_f32_32x32x16_bf16 v[168:183], v[236:239], v[36:39], v[168:183]
    v_pk_add_f32 v[30:31], v[30:31], v[142:143]
    v_pk_add_f32 v[28:29], v[28:29], v[144:145]
    v_pk_add_f32 v[30:31], v[30:31], v[146:147]
    v_pk_add_f32 v[28:29], v[28:29], v[148:149]
    v_pk_add_f32 v[30:31], v[30:31], v[150:151]
    v_cvt_pk_bf16_f32 v136, v136, v137
    v_cvt_pk_bf16_f32 v137, v138, v139
    v_cvt_pk_bf16_f32 v138, v140, v141
    v_cvt_pk_bf16_f32 v139, v142, v143
    v_cvt_pk_bf16_f32 v140, v144, v145
    v_cvt_pk_bf16_f32 v141, v146, v147
    v_cvt_pk_bf16_f32 v142, v148, v149
    v_cvt_pk_bf16_f32 v143, v150, v151
    s_getreg_b32 s101, hwreg(HW_REG_IB_STS)
    s_and_b32 s101, s101, 0xc0000f
    s_or_b32 s101, s101, s100
    s_cmp_le_u32 s101, 4
    s_cbranch_scc1 LG_s20
LG_r20:
    s_add_u32 m0, s37, 131072
    s_nop 0
    s_add_u32 s21, s21, 0x20000
    buffer_load_dwordx4 v4, s[12:15], s21 offen offset:0 lds
    buffer_load_dwordx4 v5, s[12:15], s21 offen offset:1024 lds
    s_setprio 0
    v_exp_f32 v152, v152
    v_exp_f32 v153, v153
    s_waitcnt lgkmcnt(11)
    v_mfma_f32_32x32x16_bf16 v[120:135], v[96:99], v[136:139], v[120:135]
    v_exp_f32 v154, v154
    v_exp_f32 v155, v155
    v_exp_f32 v156, v156
    v_exp_f32 v157, v157
    v_exp_f32 v158, v158
    s_waitcnt lgkmcnt(10)
    v_mfma_f32_32x32x16_bf16 v[120:135], v[100:103], v[140:143], v[120:135]
    v_exp_f32 v159, v159
    v_exp_f32 v160, v160
    v_exp_f32 v161, v161
    v_exp_f32 v162, v162
    v_exp_f32 v163, v163
    s_cmp_gt_u32 s58, 6
    s_cbranch_scc1 LB_m6
    v_mfma_f32_32x32x16_bf16 v[184:199], v[112:115], v[32:35], v[200:215]
LB_n6:
    v_exp_f32 v164, v164
    v_exp_f32 v165, v165
    v_exp_f32 v166, v166
    v_exp_f32 v167, v167
    v_pk_add_f32 v[28:29], v[28:29], v[152:153]
    v_pk_add_f32 v[30:31], v[30:31], v[154:155]
    v_pk_add_f32 v[28:29], v[28:29], v[156:157]
    v_mfma_f32_32x32x16_bf16 v[184:199], v[116:119], v[36:39], v[184:199]
    v_pk_add_f32 v[30:31], v[30:31], v[158:159]
    v_pk_add_f32 v[28:29], v[28:29], v[160:161]
    v_pk_add_f32 v[30:31], v[30:31], v[162:163]
    v_pk_add_f32 v[28:29], v[28:29], v[164:165]
    v_pk_add_f32 v[30:31], v[30:31], v[166:167]
    v_cvt_pk_bf16_f32 v152, v152, v153
    v_cvt_pk_bf16_f32 v153, v154, v155
    v_cvt_pk_bf16_f32 v154, v156, v157
    v_cvt_pk_bf16_f32 v155, v158, v159
    v_cvt_pk_bf16_f32 v156, v160, v161
    v_cvt_pk_bf16_f32 v157, v162, v163
    v_cvt_pk_bf16_f32 v158, v164, v165
    v_cvt_pk_bf16_f32 v159, v166, v167
    s_getreg_b32 s101, hwreg(HW_REG_IB_STS)
    s_and_b32 s101, s101, 0xc0000f
    s_or_b32 s101, s101, s100
    s_cmp_le_u32 s101, 6
    s_cbranch_scc1 LG_s21
LG_r21:
    buffer_load_dword v16, v18, s[24:27], s60 offen offset:256 sc1
    s_cmp_eq_u32 s7, 0
    s_cbranch_scc1 LP_6
    s_setprio 1
LP_6:
    v_exp_f32 v168, v168
    v_exp_f32 v169, v169
    s_waitcnt lgkmcnt(9)
    v_mfma_f32_32x32x16_bf16 v[120:135], v[104:107], v[152:155], v[120:135]
    v_exp_f32 v170, v170
    v_exp_f32 v171, v171
    v_exp_f32 v172, v172
    v_exp_f32 v173, v173
    v_exp_f32 v174, v174
    s_waitcnt lgkmcnt(8)
    v_mfma_f32_32x32x16_bf16 v[120:135], v[108:111], v[156:159], v[120:135]
    v_exp_f32 v175, v175
    v_exp_f32 v176, v176
    v_exp_f32 v177, v177
    v_exp_f32 v178, v178
    v_exp_f32 v179, v179
    s_waitcnt lgkmcnt(3)
    s_cmp_gt_u32 s58, 7
    s_cbranch_scc1 LB_m7
    v_mfma_f32_32x32x16_bf16 v[136:151], v[216:219], v[32:35], v[200:215]
LB_n7:
    v_exp_f32 v180, v180
    v_exp_f32 v181, v181
    v_exp_f32 v182, v182
    v_exp_f32 v183, v183
    v_pk_add_f32 v[28:29], v[28:29], v[168:169]
    v_pk_add_f32 v[30:31], v[30:31], v[170:171]
    v_pk_add_f32 v[28:29], v[28:29], v[172:173]
    s_waitcnt lgkmcnt(2)
    v_mfma_f32_32x32x16_bf16 v[136:151], v[220:223], v[36:39], v[136:151]
    v_pk_add_f32 v[30:31], v[30:31], v[174:175]
    v_pk_add_f32 v[28:29], v[28:29], v[176:177]
    v_pk_add_f32 v[30:31], v[30:31], v[178:179]
    v_pk_add_f32 v[28:29], v[28:29], v[180:181]
    v_pk_add_f32 v[30:31], v[30:31], v[182:183]
    v_cvt_pk_bf16_f32 v168, v168, v169
    v_cvt_pk_bf16_f32 v169, v170, v171
    v_cvt_pk_bf16_f32 v170, v172, v173
    v_cvt_pk_bf16_f32 v171, v174, v175
    v_cvt_pk_bf16_f32 v172, v176, v177
    v_cvt_pk_bf16_f32 v173, v178, v179
    v_cvt_pk_bf16_f32 v174, v180, v181
    v_cvt_pk_bf16_f32 v175, v182, v183
    s_getreg_b32 s101, hwreg(HW_REG_IB_STS)
    s_and_b32 s101, s101, 0xc0000f
    s_or_b32 s101, s101, s100
    s_cmp_le_u32 s101, 7
    s_cbranch_scc1 LG_s22
LG_r22:
    s_setprio 0
    v_exp_f32 v184, v184
    v_exp_f32 v185, v185
    v_mfma_f32_32x32x16_bf16 v[120:135], v[40:43], v[168:171], v[120:135]
    v_exp_f32 v186, v186
    v_exp_f32 v187, v187
    v_exp_f32 v188, v188
    v_exp_f32 v189, v189
    v_exp_f32 v190, v190
    v_exp_f32 v191, v191
    v_exp_f32 v192, v192
    v_mfma_f32_32x32x16_bf16 v[120:135], v[44:47], v[172:175], v[120:135]
    v_exp_f32 v193, v193
    v_exp_f32 v194, v194
    v_exp_f32 v195, v195
    v_exp_f32 v196, v196
    v_exp_f32 v197, v197
    v_exp_f32 v198, v198
    v_exp_f32 v199, v199
    v_pk_add_f32 v[28:29], v[28:29], v[184:185]
    v_pk_add_f32 v[30:31], v[30:31], v[186:187]
    v_pk_add_f32 v[28:29], v[28:29], v[188:189]
    v_pk_add_f32 v[30:31], v[30:31], v[190:191]
    v_pk_add_f32 v[28:29], v[28:29], v[192:193]
    v_pk_add_f32 v[30:31], v[30:31], v[194:195]
    v_pk_add_f32 v[28:29], v[28:29], v[196:197]
    v_pk_add_f32 v[30:31], v[30:31], v[198:199]
    v_cvt_pk_bf16_f32 v184, v184, v185
    v_cvt_pk_bf16_f32 v185, v186, v187
    v_cvt_pk_bf16_f32 v186, v188, v189
    v_cvt_pk_bf16_f32 v187, v190, v191
    v_cvt_pk_bf16_f32 v188, v192, v193
    v_cvt_pk_bf16_f32 v189, v194, v195
    v_cvt_pk_bf16_f32 v190, v196, v197
    v_cvt_pk_bf16_f32 v191, v198, v199
    s_cmp_eq_u32 s100, 0
    s_cbranch_scc1 LG_s23
LG_r23:
    s_mov_b32 s55, 0
    s_waitcnt vmcnt(0)
    v_cmp_ne_u32 vcc, 1, v16
    s_nop 1
    s_cmp_eq_u64 vcc, 0
    s_cbranch_scc0 LB_noe
    buffer_load_dwordx4 v[76:79], v6, s[8:11], s20 offen offset:0 sc1
    buffer_load_dwordx4 v[80:83], v7, s[8:11], s20 offen offset:0 sc1
    buffer_load_dwordx4 v[84:87], v6, s[8:11], s20 offen offset:1024 sc1
    buffer_load_dwordx4 v[88:91], v7, s[8:11], s20 offen offset:1024 sc1
    s_mov_b32 s55, 1
    s_branch LB_e2
LB_noe:
    buffer_load_dword v16, v18, s[24:27], s60 offen offset:256 sc1
LB_e2:
    s_cmp_eq_u32 s7, 0
    s_cbranch_scc1 LP_8
    s_setprio 1
LP_8:
    v_exp_f32 v136, v136
    v_exp_f32 v137, v137
    v_mfma_f32_32x32x16_bf16 v[120:135], v[48:51], v[184:187], v[120:135]
    v_exp_f32 v138, v138
    v_exp_f32 v139, v139
    v_exp_f32 v140, v140
    v_exp_f32 v141, v141
    v_exp_f32 v142, v142
    v_exp_f32 v143, v143
    v_exp_f32 v144, v144
    v_mfma_f32_32x32x16_bf16 v[120:135], v[52:55], v[188:191], v[120:135]
    v_exp_f32 v145, v145
    v_exp_f32 v146, v146
    v_exp_f32 v147, v147
    v_exp_f32 v148, v148
    v_exp_f32 v149, v149
    v_exp_f32 v150, v150
    v_exp_f32 v151, v151
    v_pk_add_f32 v[28:29], v[28:29], v[136:137]
    v_pk_add_f32 v[30:31], v[30:31], v[138:139]
    v_pk_add_f32 v[28:29], v[28:29], v[140:141]
    v_pk_add_f32 v[30:31], v[30:31], v[142:143]
    v_pk_add_f32 v[28:29], v[28:29], v[144:145]
    v_pk_add_f32 v[30:31], v[30:31], v[146:147]
    v_pk_add_f32 v[28:29], v[28:29], v[148:149]
    v_pk_add_f32 v[30:31], v[30:31], v[150:151]
    v_cvt_pk_bf16_f32 v136, v136, v137
    v_cvt_pk_bf16_f32 v137, v138, v139
    v_cvt_pk_bf16_f32 v138, v140, v141
    v_cvt_pk_bf16_f32 v139, v142, v143
    v_cvt_pk_bf16_f32 v140, v144, v145
    v_cvt_pk_bf16_f32 v141, v146, v147
    v_cvt_pk_bf16_f32 v142, v148, v149
    v_cvt_pk_bf16_f32 v143, v150, v151
    s_nop 1
    s_waitcnt lgkmcnt(1)
    v_mfma_f32_32x32x16_bf16 v[120:135], v[56:59], v[136:139], v[120:135]
    s_waitcnt lgkmcnt(0)
    v_mfma_f32_32x32x16_bf16 v[120:135], v[60:63], v[140:143], v[120:135]
    v_pk_add_f32 v[28:29], v[28:29], v[30:31]
    v_add_f32 v28, v28, v29
    v_mov_b32 v29, v28
    s_nop 1
    v_permlane32_swap_b32 v28, v29
    v_add_f32 v28, v28, v29
    v_cmp_ngt_f32 vcc, 0x5f800000, v28
    s_nop 1
    s_cmp_lg_u64 vcc, 0
    s_cbranch_scc1 LB_exact
LB_norm:
    v_rcp_f32 v28, v28
    s_lshl_b32 s56, s4, 4
    s_lshl_b32 s57, s3, 1
    s_add_u32 s56, s56, s57
    s_lshl_b32 s57, s36, 10
    s_add_u32 s57, s57, s20
    s_add_u32 s57, s57, 28672
    s_setprio 0
    s_cmp_eq_u32 s55, 1
    s_cbranch_scc1 LC_haveA
    s_waitcnt vmcnt(0)
    v_cmp_ne_u32 vcc, 1, v16
    s_nop 1
    s_cmp_eq_u64 vcc, 0
    s_cbranch_scc0 LC_slowH
LC_goH:
    buffer_load_dwordx4 v[76:79], v6, s[8:11], s20 offen offset:0 sc1
    buffer_load_dwordx4 v[80:83], v7, s[8:11], s20 offen offset:0 sc1
    buffer_load_dwordx4 v[84:87], v6, s[8:11], s20 offen offset:1024 sc1
    buffer_load_dwordx4 v[88:91], v7, s[8:11], s20 offen offset:1024 sc1
LC_haveA:
    v_mul_f32 v120, v120, v28
    v_mul_f32 v121, v121, v28
    v_mul_f32 v122, v122, v28
    v_mul_f32 v123, v123, v28
    v_mul_f32 v124, v124, v28
    v_mul_f32 v125, v125, v28
    v_mul_f32 v126, v126, v28
    v_mul_f32 v127, v127, v28
    v_mul_f32 v128, v128, v28
    v_mul_f32 v129, v129, v28
    v_mul_f32 v130, v130, v28
    v_mul_f32 v131, v131, v28
    v_mul_f32 v132, v132, v28
    v_mul_f32 v133, v133, v28
    v_mul_f32 v134, v134, v28
    v_mul_f32 v135, v135, v28
    v_cvt_pk_bf16_f32 v135, v134, v135
    v_cvt_pk_bf16_f32 v134, v132, v133
    v_cvt_pk_bf16_f32 v133, v130, v131
    v_cvt_pk_bf16_f32 v132, v128, v129
    v_cvt_pk_bf16_f32 v131, v126, v127
    v_cvt_pk_bf16_f32 v130, v124, v125
    v_cvt_pk_bf16_f32 v129, v122, v123
    v_cvt_pk_bf16_f32 v128, v120, v121
    buffer_store_dwordx4 v[128:131], v11, s[24:27], s57 offen offset:0 sc1
    buffer_store_dwordx4 v[132:135], v11, s[24:27], s57 offen offset:512 sc1
    v_bfe_u32 v26, v1, 2, 3
    v_lshrrev_b32 v27, 5, v1
    v_lshl_add_u32 v27, v27, 4, v26
    v_lshlrev_b32 v27, 8, v27
    v_lshl_add_u32 v27, v26, 5, v27
    v_and_b32 v26, 3, v1
    v_lshl_add_u32 v27, v26, 3, v27
    s_lshl_b32 s56, s23, 6
    v_xor_b32 v27, s56, v27
    v_add_u32 v156, 98304, v27
    v_xor_b32 v157, 32, v156
    v_xor_b32 v158, 64, v156
    v_xor_b32 v159, 96, v156
    v_xor_b32 v160, 128, v156
    v_xor_b32 v161, 160, v156
    v_xor_b32 v162, 192, v156
    v_xor_b32 v163, 224, v156
    s_barrier
LC_ver0:
    ds_read_b64_tr_b16 v[28:29], v156 offset:0
    ds_read_b64_tr_b16 v[30:31], v156 offset:2048
    ds_read_b64_tr_b16 v[32:33], v157 offset:0
    ds_read_b64_tr_b16 v[34:35], v157 offset:2048
    ds_read_b64_tr_b16 v[36:37], v158 offset:0
    ds_read_b64_tr_b16 v[38:39], v158 offset:2048
    ds_read_b64_tr_b16 v[40:41], v159 offset:0
    ds_read_b64_tr_b16 v[42:43], v159 offset:2048
    ds_read_b64_tr_b16 v[44:45], v160 offset:0
    ds_read_b64_tr_b16 v[46:47], v160 offset:2048
    ds_read_b64_tr_b16 v[48:49], v161 offset:0
    ds_read_b64_tr_b16 v[50:51], v161 offset:2048
    ds_read_b64_tr_b16 v[52:53], v162 offset:0
    ds_read_b64_tr_b16 v[54:55], v162 offset:2048
    s_waitcnt vmcnt(5) lgkmcnt(12)
    v_mfma_f32_16x16x32_bf16 v[192:195], v[28:31], v[76:79], 0
    ds_read_b64_tr_b16 v[56:57], v163 offset:0
    ds_read_b64_tr_b16 v[58:59], v163 offset:2048
    s_waitcnt vmcnt(4)
    v_mfma_f32_16x16x32_bf16 v[196:199], v[28:31], v[80:83], 0
    buffer_load_dwordx4 v[92:95], v6, s[8:11], s20 offen offset:2048 sc1
    s_waitcnt lgkmcnt(12)
    v_mfma_f32_16x16x32_bf16 v[204:207], v[32:35], v[80:83], 0
    ds_read_b64_tr_b16 v[28:29], v156 offset:8192
    ds_read_b64_tr_b16 v[30:31], v156 offset:10240
    v_mfma_f32_16x16x32_bf16 v[200:203], v[32:35], v[76:79], 0
    s_waitcnt lgkmcnt(12)
    v_mfma_f32_16x16x32_bf16 v[208:211], v[36:39], v[76:79], 0
    ds_read_b64_tr_b16 v[32:33], v157 offset:8192
    ds_read_b64_tr_b16 v[34:35], v157 offset:10240
    v_mfma_f32_16x16x32_bf16 v[212:215], v[36:39], v[80:83], 0
    buffer_load_dwordx4 v[96:99], v7, s[8:11], s20 offen offset:2048 sc1
    s_waitcnt lgkmcnt(12)
    v_mfma_f32_16x16x32_bf16 v[220:223], v[40:43], v[80:83], 0
    ds_read_b64_tr_b16 v[36:37], v158 offset:8192
    ds_read_b64_tr_b16 v[38:39], v158 offset:10240
    v_mfma_f32_16x16x32_bf16 v[216:219], v[40:43], v[76:79], 0
    s_waitcnt lgkmcnt(12)
    v_mfma_f32_16x16x32_bf16 v[224:227], v[44:47], v[76:79], 0
    ds_read_b64_tr_b16 v[40:41], v159 offset:8192
    ds_read_b64_tr_b16 v[42:43], v159 offset:10240
    v_mfma_f32_16x16x32_bf16 v[228:231], v[44:47], v[80:83], 0
    buffer_load_dwordx4 v[100:103], v6, s[8:11], s20 offen offset:3072 sc1
    s_waitcnt lgkmcnt(12)
    v_mfma_f32_16x16x32_bf16 v[236:239], v[48:51], v[80:83], 0
    ds_read_b64_tr_b16 v[44:45], v160 offset:8192
    ds_read_b64_tr_b16 v[46:47], v160 offset:10240
    v_mfma_f32_16x16x32_bf16 v[232:235], v[48:51], v[76:79], 0
    s_waitcnt lgkmcnt(12)
    v_mfma_f32_16x16x32_bf16 v[240:243], v[52:55], v[76:79], 0
    ds_read_b64_tr_b16 v[48:49], v161 offset:8192
    ds_read_b64_tr_b16 v[50:51], v161 offset:10240
    v_mfma_f32_16x16x32_bf16 v[244:247], v[52:55], v[80:83], 0
    buffer_load_dwordx4 v[104:107], v7, s[8:11], s20 offen offset:3072 sc1
    s_waitcnt lgkmcnt(12)
    v_mfma_f32_16x16x32_bf16 v[252:255], v[56:59], v[80:83], 0
    ds_read_b64_tr_b16 v[52:53], v162 offset:8192
    ds_read_b64_tr_b16 v[54:55], v162 offset:10240
    v_mfma_f32_16x16x32_bf16 v[248:251], v[56:59], v[76:79], 0
    s_waitcnt vmcnt(7) lgkmcnt(12)
    v_mfma_f32_16x16x32_bf16 v[192:195], v[28:31], v[84:87], v[192:195]
    ds_read_b64_tr_b16 v[56:57], v163 offset:8192
    ds_read_b64_tr_b16 v[58:59], v163 offset:10240
    s_waitcnt vmcnt(6)
    v_mfma_f32_16x16x32_bf16 v[196:199], v[28:31], v[88:91], v[196:199]
    s_add_u32 s20, s20, 0x1000
    buffer_load_dwordx4 v[108:111], v6, s[8:11], s20 offen offset:0 sc1
    s_waitcnt lgkmcnt(12)
    v_mfma_f32_16x16x32_bf16 v[204:207], v[32:35], v[88:91], v[204:207]
    s_waitcnt lgkmcnt(0)
    s_barrier
    ds_read_b64_tr_b16 v[28:29], v156 offset:16384
    ds_read_b64_tr_b16 v[30:31], v156 offset:18432
    v_mfma_f32_16x16x32_bf16 v[200:203], v[32:35], v[84:87], v[200:203]
    v_mfma_f32_16x16x32_bf16 v[208:211], v[36:39], v[84:87], v[208:211]
    ds_read_b64_tr_b16 v[32:33], v157 offset:16384
    ds_read_b64_tr_b16 v[34:35], v157 offset:18432
    v_mfma_f32_16x16x32_bf16 v[212:215], v[36:39], v[88:91], v[212:215]
    buffer_load_dwordx4 v[112:115], v7, s[8:11], s20 offen offset:0 sc1
    v_mfma_f32_16x16x32_bf16 v[220:223], v[40:43], v[88:91], v[220:223]
    ds_read_b64_tr_b16 v[36:37], v158 offset:16384
    ds_read_b64_tr_b16 v[38:39], v158 offset:18432
    v_mfma_f32_16x16x32_bf16 v[216:219], v[40:43], v[84:87], v[216:219]
    v_mfma_f32_16x16x32_bf16 v[224:227], v[44:47], v[84:87], v[224:227]
    ds_read_b64_tr_b16 v[40:41], v159 offset:16384
    ds_read_b64_tr_b16 v[42:43], v159 offset:18432
    v_mfma_f32_16x16x32_bf16 v[228:231], v[44:47], v[88:91], v[228:231]
    buffer_load_dwordx4 v[116:119], v6, s[8:11], s20 offen offset:1024 sc1
    v_mfma_f32_16x16x32_bf16 v[236:239], v[48:51], v[88:91], v[236:239]
    ds_read_b64_tr_b16 v[44:45], v160 offset:16384
    ds_read_b64_tr_b16 v[46:47], v160 offset:18432
    v_mfma_f32_16x16x32_bf16 v[232:235], v[48:51], v[84:87], v[232:235]
    v_mfma_f32_16x16x32_bf16 v[240:243], v[52:55], v[84:87], v[240:243]
    ds_read_b64_tr_b16 v[48:49], v161 offset:16384
    ds_read_b64_tr_b16 v[50:51], v161 offset:18432
    v_mfma_f32_16x16x32_bf16 v[244:247], v[52:55], v[88:91], v[244:247]
    buffer_load_dwordx4 v[120:123], v7, s[8:11], s20 offen offset:1024 sc1
    v_mfma_f32_16x16x32_bf16 v[252:255], v[56:59], v[88:91], v[252:255]
    ds_read_b64_tr_b16 v[52:53], v162 offset:16384
    ds_read_b64_tr_b16 v[54:55], v162 offset:18432
    v_mfma_f32_16x16x32_bf16 v[248:251], v[56:59], v[84:87], v[248:251]
    s_waitcnt vmcnt(7) lgkmcnt(12)
    v_mfma_f32_16x16x32_bf16 v[192:195], v[28:31], v[92:95], v[192:195]
    ds_read_b64_tr_b16 v[56:57], v163 offset:16384
    ds_read_b64_tr_b16 v[58:59], v163 offset:18432
    v_and_b32 v22, 31, v1
    s_waitcnt vmcnt(6)
    v_mfma_f32_16x16x32_bf16 v[196:199], v[28:31], v[96:99], v[196:199]
    v_lshlrev_b32 v22, 9, v22
    buffer_load_dwordx4 v[124:127], v6, s[8:11], s20 offen offset:2048 sc1
    s_waitcnt lgkmcnt(12)
    v_mfma_f32_16x16x32_bf16 v[204:207], v[32:35], v[96:99], v[204:207]
    ds_read_b64_tr_b16 v[28:29], v156 offset:24576
    ds_read_b64_tr_b16 v[30:31], v156 offset:26624
    s_lshl_b32 s54, s4, 14
    v_mfma_f32_16x16x32_bf16 v[200:203], v[32:35], v[92:95], v[200:203]
    s_add_u32 s54, s54, 0x2c10000
    s_waitcnt lgkmcnt(12)
    v_mfma_f32_16x16x32_bf16 v[208:211], v[36:39], v[92:95], v[208:211]
    ds_read_b64_tr_b16 v[32:33], v157 offset:24576
    ds_read_b64_tr_b16 v[34:35], v157 offset:26624
    s_add_u32 m0, s37, 147456
    v_and_b32 v26, 3, v1
    v_mfma_f32_16x16x32_bf16 v[212:215], v[36:39], v[96:99], v[212:215]
    v_max_u32 v26, 1, v26
    s_add_u32 s21, s21, 0x20000
    buffer_load_dwordx4 v4, s[12:15], s21 offen offset:0 lds
    s_waitcnt lgkmcnt(12)
    v_mfma_f32_16x16x32_bf16 v[220:223], v[40:43], v[96:99], v[220:223]
    ds_read_b64_tr_b16 v[36:37], v158 offset:24576
    ds_read_b64_tr_b16 v[38:39], v158 offset:26624
    v_mfma_f32_16x16x32_bf16 v[216:219], v[40:43], v[92:95], v[216:219]
    v_lshlrev_b32 v27, 1, v26
    s_waitcnt lgkmcnt(12)
    v_mfma_f32_16x16x32_bf16 v[224:227], v[44:47], v[92:95], v[224:227]
    ds_read_b64_tr_b16 v[40:41], v159 offset:24576
    ds_read_b64_tr_b16 v[42:43], v159 offset:26624
    v_and_b32 v27, 4, v27
    v_mfma_f32_16x16x32_bf16 v[228:231], v[44:47], v[96:99], v[228:231]
    v_xor_b32 v27, 4, v27
    buffer_load_dwordx4 v[128:131], v7, s[8:11], s20 offen offset:2048 sc1
    s_waitcnt lgkmcnt(12)
    v_mfma_f32_16x16x32_bf16 v[236:239], v[48:51], v[96:99], v[236:239]
    ds_read_b64_tr_b16 v[44:45], v160 offset:24576
    ds_read_b64_tr_b16 v[46:47], v160 offset:26624
    v_lshlrev_b32 v26, 3, v26
    v_mfma_f32_16x16x32_bf16 v[232:235], v[48:51], v[92:95], v[232:235]
    v_xor_b32 v26, s53, v26
    s_waitcnt lgkmcnt(12)
    v_mfma_f32_16x16x32_bf16 v[240:243], v[52:55], v[92:95], v[240:243]
    ds_read_b64_tr_b16 v[48:49], v161 offset:24576
    ds_read_b64_tr_b16 v[50:51], v161 offset:26624
    v_mfma_f32_16x16x32_bf16 v[244:247], v[52:55], v[96:99], v[244:247]
    v_lshl_add_u32 v23, v26, 9, v27
    buffer_load_dwordx4 v[132:135], v6, s[8:11], s20 offen offset:3072 sc1
    s_waitcnt lgkmcnt(12)
    v_mfma_f32_16x16x32_bf16 v[252:255], v[56:59], v[96:99], v[252:255]
    ds_read_b64_tr_b16 v[52:53], v162 offset:24576
    ds_read_b64_tr_b16 v[54:55], v162 offset:26624
    s_mov_b32 s62, 0x2c10000
    v_mfma_f32_16x16x32_bf16 v[248:251], v[56:59], v[92:95], v[248:251]
    s_mov_b32 s100, 0
    s_waitcnt vmcnt(9) lgkmcnt(12)
    v_mfma_f32_16x16x32_bf16 v[192:195], v[28:31], v[100:103], v[192:195]
    ds_read_b64_tr_b16 v[56:57], v163 offset:24576
    ds_read_b64_tr_b16 v[58:59], v163 offset:26624
    s_mov_b32 s55, 0
    s_waitcnt vmcnt(8)
    v_mfma_f32_16x16x32_bf16 v[196:199], v[28:31], v[104:107], v[196:199]
    s_mov_b32 s61, 1
    buffer_load_dwordx4 v5, s[12:15], s21 offen offset:1024 lds
    s_waitcnt lgkmcnt(12)
    v_mfma_f32_16x16x32_bf16 v[204:207], v[32:35], v[104:107], v[204:207]
    s_waitcnt lgkmcnt(0)
    s_barrier
    s_cmp_lg_u32 s3, 0
    s_cbranch_scc1 LC_nof10
    s_mov_b64 exec, 1
    buffer_store_dword v19, off, s[24:27], s63 offset:260 sc1
    s_mov_b64 exec, -1
LC_nof10:
    ds_read_b64_tr_b16 v[28:29], v156 offset:32768
    ds_read_b64_tr_b16 v[30:31], v156 offset:34816
    v_mov_b32 v26, 0
    v_mfma_f32_16x16x32_bf16 v[200:203], v[32:35], v[100:103], v[200:203]
    v_mfma_f32_16x16x32_bf16 v[208:211], v[36:39], v[100:103], v[208:211]
    ds_read_b64_tr_b16 v[32:33], v157 offset:32768
    ds_read_b64_tr_b16 v[34:35], v157 offset:34816
    ds_write_b32 v26, v26 offset:0
    v_mfma_f32_16x16x32_bf16 v[212:215], v[36:39], v[104:107], v[212:215]
    ds_write_b32 v26, v26 offset:4
    buffer_load_dwordx4 v[136:139], v7, s[8:11], s20 offen offset:3072 sc1
    v_mfma_f32_16x16x32_bf16 v[220:223], v[40:43], v[104:107], v[220:223]
    ds_read_b64_tr_b16 v[36:37], v158 offset:32768
    ds_read_b64_tr_b16 v[38:39], v158 offset:34816
    v_add_u32 v164, 0xffff8000, v156
    v_mfma_f32_16x16x32_bf16 v[216:219], v[40:43], v[100:103], v[216:219]
    v_add_u32 v165, 0xffff8000, v157
    v_mfma_f32_16x16x32_bf16 v[224:227], v[44:47], v[100:103], v[224:227]
    ds_read_b64_tr_b16 v[40:41], v159 offset:32768
    ds_read_b64_tr_b16 v[42:43], v159 offset:34816
    v_add_u32 v166, 0xffff8000, v158
    v_mfma_f32_16x16x32_bf16 v[228:231], v[44:47], v[104:107], v[228:231]
    s_add_u32 s20, s20, 0x1000
    buffer_load_dwordx4 v[140:143], v6, s[8:11], s20 offen offset:0 sc1
    v_mfma_f32_16x16x32_bf16 v[236:239], v[48:51], v[104:107], v[236:239]
    ds_read_b64_tr_b16 v[44:45], v160 offset:32768
    ds_read_b64_tr_b16 v[46:47], v160 offset:34816
    v_add_u32 v167, 0xffff8000, v159
    v_mfma_f32_16x16x32_bf16 v[232:235], v[48:51], v[100:103], v[232:235]
    v_add_u32 v168, 0xffff8000, v160
    v_mfma_f32_16x16x32_bf16 v[240:243], v[52:55], v[100:103], v[240:243]
    ds_read_b64_tr_b16 v[48:49], v161 offset:32768
    ds_read_b64_tr_b16 v[50:51], v161 offset:34816
    s_add_u32 m0, s37, 65536
    v_add_u32 v169, 0xffff8000, v161
    v_mfma_f32_16x16x32_bf16 v[244:247], v[52:55], v[104:107], v[244:247]
    v_add_u32 v170, 0xffff8000, v162
    s_add_u32 s21, s21, 0x20000
    buffer_load_dwordx4 v4, s[12:15], s21 offen offset:0 lds
    v_mfma_f32_16x16x32_bf16 v[252:255], v[56:59], v[104:107], v[252:255]
    ds_read_b64_tr_b16 v[52:53], v162 offset:32768
    ds_read_b64_tr_b16 v[54:55], v162 offset:34816
    v_add_u32 v171, 0xffff8000, v163
    v_mfma_f32_16x16x32_bf16 v[248:251], v[56:59], v[100:103], v[248:251]
    s_waitcnt vmcnt(11) lgkmcnt(12)
    v_mfma_f32_16x16x32_bf16 v[192:195], v[28:31], v[108:111], v[192:195]
    ds_read_b64_tr_b16 v[56:57], v163 offset:32768
    ds_read_b64_tr_b16 v[58:59], v163 offset:34816
    s_lshl_b32 s56, s4, 3
    s_add_u32 s56, s56, s36
    s_waitcnt vmcnt(10)
    v_mfma_f32_16x16x32_bf16 v[196:199], v[28:31], v[112:115], v[196:199]
    s_lshl_b32 s56, s56, 18
    buffer_load_dwordx4 v[144:147], v7, s[8:11], s20 offen offset:0 sc1
    s_waitcnt lgkmcnt(12)
    v_mfma_f32_16x16x32_bf16 v[204:207], v[32:35], v[112:115], v[204:207]
    ds_read_b64_tr_b16 v[28:29], v156 offset:40960
    ds_read_b64_tr_b16 v[30:31], v156 offset:43008
    s_lshl_b32 s57, s3, 11
    v_mfma_f32_16x16x32_bf16 v[200:203], v[32:35], v[108:111], v[200:203]
    s_add_u32 s56, s56, s57
    s_waitcnt lgkmcnt(12)
    v_mfma_f32_16x16x32_bf16 v[208:211], v[36:39], v[108:111], v[208:211]
    ds_read_b64_tr_b16 v[32:33], v157 offset:40960
    ds_read_b64_tr_b16 v[34:35], v157 offset:43008
    s_add_u32 s56, s56, 0x1c00000
    v_mfma_f32_16x16x32_bf16 v[212:215], v[36:39], v[112:115], v[212:215]
    s_xor_b32 s57, s23, 1
    buffer_load_dwordx4 v5, s[12:15], s21 offen offset:1024 lds
    s_waitcnt lgkmcnt(12)
    v_mfma_f32_16x16x32_bf16 v[220:223], v[40:43], v[112:115], v[220:223]
    ds_read_b64_tr_b16 v[36:37], v158 offset:40960
    ds_read_b64_tr_b16 v[38:39], v158 offset:43008
    s_lshl_b32 s57, s57, 16
    v_mfma_f32_16x16x32_bf16 v[216:219], v[40:43], v[108:111], v[216:219]
    s_add_u32 s57, s57, s56
    s_waitcnt lgkmcnt(12)
    v_mfma_f32_16x16x32_bf16 v[224:227], v[44:47], v[108:111], v[224:227]
    ds_read_b64_tr_b16 v[40:41], v159 offset:40960
    ds_read_b64_tr_b16 v[42:43], v159 offset:43008
    s_add_u32 s48, s57, 16384
    v_mfma_f32_16x16x32_bf16 v[228:231], v[44:47], v[112:115], v[228:231]
    s_xor_b32 s57, s23, 2
    buffer_load_dwordx4 v[148:151], v6, s[8:11], s20 offen offset:1024 sc1
    s_waitcnt lgkmcnt(12)
    v_mfma_f32_16x16x32_bf16 v[236:239], v[48:51], v[112:115], v[236:239]
    ds_read_b64_tr_b16 v[44:45], v160 offset:40960
    ds_read_b64_tr_b16 v[46:47], v160 offset:43008
    s_lshl_b32 s57, s57, 16
    v_mfma_f32_16x16x32_bf16 v[232:235], v[48:51], v[108:111], v[232:235]
    s_add_u32 s57, s57, s56
    s_waitcnt lgkmcnt(12)
    v_mfma_f32_16x16x32_bf16 v[240:243], v[52:55], v[108:111], v[240:243]
    ds_read_b64_tr_b16 v[48:49], v161 offset:40960
    ds_read_b64_tr_b16 v[50:51], v161 offset:43008
    s_add_u32 s49, s57, 32768
    v_mfma_f32_16x16x32_bf16 v[244:247], v[52:55], v[112:115], v[244:247]
    s_xor_b32 s57, s23, 3
    buffer_load_dwordx4 v[152:155], v7, s[8:11], s20 offen offset:1024 sc1
    s_waitcnt lgkmcnt(12)
    v_mfma_f32_16x16x32_bf16 v[252:255], v[56:59], v[112:115], v[252:255]
    ds_read_b64_tr_b16 v[52:53], v162 offset:40960
    ds_read_b64_tr_b16 v[54:55], v162 offset:43008
    s_lshl_b32 s57, s57, 16
    v_mfma_f32_16x16x32_bf16 v[248:251], v[56:59], v[108:111], v[248:251]
    s_add_u32 s57, s57, s56
    s_waitcnt vmcnt(13) lgkmcnt(12)
    v_mfma_f32_16x16x32_bf16 v[192:195], v[28:31], v[116:119], v[192:195]
    ds_read_b64_tr_b16 v[56:57], v163 offset:40960
    ds_read_b64_tr_b16 v[58:59], v163 offset:43008
    s_add_u32 m0, s37, 81920
    s_add_u32 s50, s57, 49152
    s_lshl_b32 s57, s23, 16
    s_waitcnt vmcnt(12)
    v_mfma_f32_16x16x32_bf16 v[196:199], v[28:31], v[120:123], v[196:199]
    s_add_u32 s51, s57, s56
    s_add_u32 s21, s21, 0x20000
    buffer_load_dwordx4 v4, s[12:15], s21 offen offset:0 lds
    s_waitcnt lgkmcnt(12)
    v_mfma_f32_16x16x32_bf16 v[204:207], v[32:35], v[120:123], v[204:207]
    s_waitcnt vmcnt(8) lgkmcnt(0)
    s_barrier
    ds_read_b64_tr_b16 v[28:29], v156 offset:49152
    ds_read_b64_tr_b16 v[30:31], v156 offset:51200
    s_lshl_b32 s56, s4, 19
    v_mfma_f32_16x16x32_bf16 v[200:203], v[32:35], v[116:119], v[200:203]
    s_lshl_b32 s57, s3, 16
    v_mfma_f32_16x16x32_bf16 v[208:211], v[36:39], v[116:119], v[208:211]
    ds_read_b64_tr_b16 v[32:33], v157 offset:49152
    ds_read_b64_tr_b16 v[34:35], v157 offset:51200
    s_add_u32 s56, s56, s57
    v_mfma_f32_16x16x32_bf16 v[212:215], v[36:39], v[120:123], v[212:215]
    s_lshl_b32 s57, s36, 8
    buffer_load_dwordx4 v[60:63], v6, s[8:11], s20 offen offset:2048 sc1
    v_mfma_f32_16x16x32_bf16 v[220:223], v[40:43], v[120:123], v[220:223]
    ds_read_b64_tr_b16 v[36:37], v158 offset:49152
    ds_read_b64_tr_b16 v[38:39], v158 offset:51200
    s_add_u32 s56, s56, s57
    v_mfma_f32_16x16x32_bf16 v[216:219], v[40:43], v[116:119], v[216:219]
    s_lshl_b32 s57, s23, 6
    v_mfma_f32_16x16x32_bf16 v[224:227], v[44:47], v[116:119], v[224:227]
    ds_read_b64_tr_b16 v[40:41], v159 offset:49152
    ds_read_b64_tr_b16 v[42:43], v159 offset:51200
    s_add_u32 s52, s56, s57
    v_mfma_f32_16x16x32_bf16 v[228:231], v[44:47], v[120:123], v[228:231]
    s_add_u32 s39, s52, 32768
    buffer_load_dwordx4 v[64:67], v7, s[8:11], s20 offen offset:2048 sc1
    v_mfma_f32_16x16x32_bf16 v[236:239], v[48:51], v[120:123], v[236:239]
    ds_read_b64_tr_b16 v[44:45], v160 offset:49152
    ds_read_b64_tr_b16 v[46:47], v160 offset:51200
    v_and_b32 v24, 15, v1
    v_mfma_f32_16x16x32_bf16 v[232:235], v[48:51], v[116:119], v[232:235]
    v_lshlrev_b32 v24, 11, v24
    v_mfma_f32_16x16x32_bf16 v[240:243], v[52:55], v[116:119], v[240:243]
    ds_read_b64_tr_b16 v[48:49], v161 offset:49152
    ds_read_b64_tr_b16 v[50:51], v161 offset:51200
    v_bfe_u32 v26, v1, 4, 1
    v_mfma_f32_16x16x32_bf16 v[244:247], v[52:55], v[120:123], v[244:247]
    v_lshl_add_u32 v24, v26, 5, v24
    buffer_load_dwordx4 v5, s[12:15], s21 offen offset:1024 lds
    v_mfma_f32_16x16x32_bf16 v[252:255], v[56:59], v[120:123], v[252:255]
    ds_read_b64_tr_b16 v[52:53], v162 offset:49152
    ds_read_b64_tr_b16 v[54:55], v162 offset:51200
    v_lshrrev_b32 v26, 5, v1
    v_mfma_f32_16x16x32_bf16 v[248:251], v[56:59], v[116:119], v[248:251]
    v_lshl_add_u32 v24, v26, 4, v24
    s_waitcnt lgkmcnt(12)
    v_mfma_f32_16x16x32_bf16 v[192:195], v[28:31], v[124:127], v[192:195]
    ds_read_b64_tr_b16 v[56:57], v163 offset:49152
    ds_read_b64_tr_b16 v[58:59], v163 offset:51200
    v_mfma_f32_16x16x32_bf16 v[196:199], v[28:31], v[128:131], v[196:199]
    buffer_load_dwordx4 v[68:71], v6, s[8:11], s20 offen offset:3072 sc1
    s_waitcnt lgkmcnt(12)
    v_mfma_f32_16x16x32_bf16 v[204:207], v[32:35], v[128:131], v[204:207]
    ds_read_b64_tr_b16 v[28:29], v156 offset:57344
    ds_read_b64_tr_b16 v[30:31], v156 offset:59392
    v_mfma_f32_16x16x32_bf16 v[200:203], v[32:35], v[124:127], v[200:203]
    s_waitcnt lgkmcnt(12)
    v_mfma_f32_16x16x32_bf16 v[208:211], v[36:39], v[124:127], v[208:211]
    ds_read_b64_tr_b16 v[32:33], v157 offset:57344
    ds_read_b64_tr_b16 v[34:35], v157 offset:59392
    v_mfma_f32_16x16x32_bf16 v[212:215], v[36:39], v[128:131], v[212:215]
    buffer_load_dwordx4 v[72:75], v7, s[8:11], s20 offen offset:3072 sc1
    s_waitcnt lgkmcnt(12)
    v_mfma_f32_16x16x32_bf16 v[220:223], v[40:43], v[128:131], v[220:223]
    ds_read_b64_tr_b16 v[36:37], v158 offset:57344
    ds_read_b64_tr_b16 v[38:39], v158 offset:59392
    v_mfma_f32_16x16x32_bf16 v[216:219], v[40:43], v[124:127], v[216:219]
    s_waitcnt lgkmcnt(12)
    v_mfma_f32_16x16x32_bf16 v[224:227], v[44:47], v[124:127], v[224:227]
    ds_read_b64_tr_b16 v[40:41], v159 offset:57344
    ds_read_b64_tr_b16 v[42:43], v159 offset:59392
    v_mfma_f32_16x16x32_bf16 v[228:231], v[44:47], v[128:131], v[228:231]
    s_add_u32 s20, s20, 0x1000
    buffer_load_dwordx4 v[76:79], v6, s[8:11], s20 offen offset:0 sc1
    s_waitcnt lgkmcnt(12)
    v_mfma_f32_16x16x32_bf16 v[236:239], v[48:51], v[128:131], v[236:239]
    ds_read_b64_tr_b16 v[44:45], v160 offset:57344
    ds_read_b64_tr_b16 v[46:47], v160 offset:59392
    v_mfma_f32_16x16x32_bf16 v[232:235], v[48:51], v[124:127], v[232:235]
    s_waitcnt lgkmcnt(12)
    v_mfma_f32_16x16x32_bf16 v[240:243], v[52:55], v[124:127], v[240:243]
    ds_read_b64_tr_b16 v[48:49], v161 offset:57344
    ds_read_b64_tr_b16 v[50:51], v161 offset:59392
    v_mfma_f32_16x16x32_bf16 v[244:247], v[52:55], v[128:131], v[244:247]
    buffer_load_dwordx4 v[80:83], v7, s[8:11], s20 offen offset:0 sc1
    s_waitcnt lgkmcnt(12)
    v_mfma_f32_16x16x32_bf16 v[252:255], v[56:59], v[128:131], v[252:255]
    ds_read_b64_tr_b16 v[52:53], v162 offset:57344
    ds_read_b64_tr_b16 v[54:55], v162 offset:59392
    v_mfma_f32_16x16x32_bf16 v[248:251], v[56:59], v[124:127], v[248:251]
    s_waitcnt lgkmcnt(12)
    v_mfma_f32_16x16x32_bf16 v[192:195], v[28:31], v[132:135], v[192:195]
    ds_read_b64_tr_b16 v[56:57], v163 offset:57344
    ds_read_b64_tr_b16 v[58:59], v163 offset:59392
    s_add_u32 m0, s37, 98304
    s_waitcnt vmcnt(14)
    v_mfma_f32_16x16x32_bf16 v[196:199], v[28:31], v[136:139], v[196:199]
    s_add_u32 s21, s21, 0x20000
    buffer_load_dwordx4 v4, s[12:15], s21 offen offset:0 lds
    s_waitcnt lgkmcnt(12)
    v_mfma_f32_16x16x32_bf16 v[204:207], v[32:35], v[136:139], v[204:207]
    s_waitcnt vmcnt(11) lgkmcnt(0)
    s_barrier
    ds_read_b64_tr_b16 v[28:29], v164 offset:0
    ds_read_b64_tr_b16 v[30:31], v164 offset:2048
    v_mfma_f32_16x16x32_bf16 v[200:203], v[32:35], v[132:135], v[200:203]
    v_mfma_f32_16x16x32_bf16 v[208:211], v[36:39], v[132:135], v[208:211]
    ds_read_b64_tr_b16 v[32:33], v165 offset:0
    ds_read_b64_tr_b16 v[34:35], v165 offset:2048
    v_mfma_f32_16x16x32_bf16 v[212:215], v[36:39], v[136:139], v[212:215]
    buffer_load_dwordx4 v[84:87], v6, s[8:11], s20 offen offset:1024 sc1
    v_mfma_f32_16x16x32_bf16 v[220:223], v[40:43], v[136:139], v[220:223]
    ds_read_b64_tr_b16 v[36:37], v166 offset:0
    ds_read_b64_tr_b16 v[38:39], v166 offset:2048
    v_mfma_f32_16x16x32_bf16 v[216:219], v[40:43], v[132:135], v[216:219]
    v_mfma_f32_16x16x32_bf16 v[224:227], v[44:47], v[132:135], v[224:227]
    ds_read_b64_tr_b16 v[40:41], v167 offset:0
    ds_read_b64_tr_b16 v[42:43], v167 offset:2048
    v_mfma_f32_16x16x32_bf16 v[228:231], v[44:47], v[136:139], v[228:231]
    buffer_load_dwordx4 v[88:91], v7, s[8:11], s20 offen offset:1024 sc1
    v_mfma_f32_16x16x32_bf16 v[236:239], v[48:51], v[136:139], v[236:239]
    ds_read_b64_tr_b16 v[44:45], v168 offset:0
    ds_read_b64_tr_b16 v[46:47], v168 offset:2048
    v_mfma_f32_16x16x32_bf16 v[232:235], v[48:51], v[132:135], v[232:235]
    v_mfma_f32_16x16x32_bf16 v[240:243], v[52:55], v[132:135], v[240:243]
    ds_read_b64_tr_b16 v[48:49], v169 offset:0
    ds_read_b64_tr_b16 v[50:51], v169 offset:2048
    v_mfma_f32_16x16x32_bf16 v[244:247], v[52:55], v[136:139], v[244:247]
    buffer_load_dwordx4 v5, s[12:15], s21 offen offset:1024 lds
    v_mfma_f32_16x16x32_bf16 v[252:255], v[56:59], v[136:139], v[252:255]
    ds_read_b64_tr_b16 v[52:53], v170 offset:0
    ds_read_b64_tr_b16 v[54:55], v170 offset:2048
    v_mfma_f32_16x16x32_bf16 v[248:251], v[56:59], v[132:135], v[248:251]
    s_waitcnt lgkmcnt(12)
    v_mfma_f32_16x16x32_bf16 v[192:195], v[28:31], v[140:143], v[192:195]
    ds_read_b64_tr_b16 v[56:57], v171 offset:0
    ds_read_b64_tr_b16 v[58:59], v171 offset:2048
    v_mfma_f32_16x16x32_bf16 v[196:199], v[28:31], v[144:147], v[196:199]
    buffer_load_dwordx4 v[92:95], v6, s[8:11], s20 offen offset:2048 sc1
    s_waitcnt lgkmcnt(12)
    v_mfma_f32_16x16x32_bf16 v[204:207], v[32:35], v[144:147], v[204:207]
    ds_read_b64_tr_b16 v[28:29], v164 offset:8192
    ds_read_b64_tr_b16 v[30:31], v164 offset:10240
    v_mfma_f32_16x16x32_bf16 v[200:203], v[32:35], v[140:143], v[200:203]
    s_waitcnt lgkmcnt(12)
    v_mfma_f32_16x16x32_bf16 v[208:211], v[36:39], v[140:143], v[208:211]
    ds_read_b64_tr_b16 v[32:33], v165 offset:8192
    ds_read_b64_tr_b16 v[34:35], v165 offset:10240
    s_add_u32 m0, s37, 114688
    v_mfma_f32_16x16x32_bf16 v[212:215], v[36:39], v[144:147], v[212:215]
    s_add_u32 s21, s21, 0x20000
    buffer_load_dwordx4 v4, s[12:15], s21 offen offset:0 lds
    s_waitcnt lgkmcnt(12)
    v_mfma_f32_16x16x32_bf16 v[220:223], v[40:43], v[144:147], v[220:223]
    ds_read_b64_tr_b16 v[36:37], v166 offset:8192
    ds_read_b64_tr_b16 v[38:39], v166 offset:10240
    v_mfma_f32_16x16x32_bf16 v[216:219], v[40:43], v[140:143], v[216:219]
    s_waitcnt lgkmcnt(12)
    v_mfma_f32_16x16x32_bf16 v[224:227], v[44:47], v[140:143], v[224:227]
    ds_read_b64_tr_b16 v[40:41], v167 offset:8192
    ds_read_b64_tr_b16 v[42:43], v167 offset:10240
    v_mfma_f32_16x16x32_bf16 v[228:231], v[44:47], v[144:147], v[228:231]
    buffer_load_dwordx4 v[96:99], v7, s[8:11], s20 offen offset:2048 sc1
    s_waitcnt lgkmcnt(12)
    v_mfma_f32_16x16x32_bf16 v[236:239], v[48:51], v[144:147], v[236:239]
    ds_read_b64_tr_b16 v[44:45], v168 offset:8192
    ds_read_b64_tr_b16 v[46:47], v168 offset:10240
    v_mfma_f32_16x16x32_bf16 v[232:235], v[48:51], v[140:143], v[232:235]
    s_waitcnt lgkmcnt(12)
    v_mfma_f32_16x16x32_bf16 v[240:243], v[52:55], v[140:143], v[240:243]
    ds_read_b64_tr_b16 v[48:49], v169 offset:8192
    ds_read_b64_tr_b16 v[50:51], v169 offset:10240
    v_mfma_f32_16x16x32_bf16 v[244:247], v[52:55], v[144:147], v[244:247]
    buffer_load_dwordx4 v[100:103], v6, s[8:11], s20 offen offset:3072 sc1
    s_waitcnt lgkmcnt(12)
    v_mfma_f32_16x16x32_bf16 v[252:255], v[56:59], v[144:147], v[252:255]
    ds_read_b64_tr_b16 v[52:53], v170 offset:8192
    ds_read_b64_tr_b16 v[54:55], v170 offset:10240
    v_mfma_f32_16x16x32_bf16 v[248:251], v[56:59], v[140:143], v[248:251]
    s_waitcnt vmcnt(17) lgkmcnt(12)
    v_mfma_f32_16x16x32_bf16 v[192:195], v[28:31], v[148:151], v[192:195]
    ds_read_b64_tr_b16 v[56:57], v171 offset:8192
    ds_read_b64_tr_b16 v[58:59], v171 offset:10240
    s_waitcnt vmcnt(16)
    v_mfma_f32_16x16x32_bf16 v[196:199], v[28:31], v[152:155], v[196:199]
    buffer_load_dwordx4 v5, s[12:15], s21 offen offset:1024 lds
    s_waitcnt lgkmcnt(12)
    v_mfma_f32_16x16x32_bf16 v[204:207], v[32:35], v[152:155], v[204:207]
    s_waitcnt vmcnt(13) lgkmcnt(0)
    s_barrier
    ds_read_b64_tr_b16 v[28:29], v164 offset:16384
    ds_read_b64_tr_b16 v[30:31], v164 offset:18432
    v_mfma_f32_16x16x32_bf16 v[200:203], v[32:35], v[148:151], v[200:203]
    v_mfma_f32_16x16x32_bf16 v[208:211], v[36:39], v[148:151], v[208:211]
    ds_read_b64_tr_b16 v[32:33], v165 offset:16384
    ds_read_b64_tr_b16 v[34:35], v165 offset:18432
    v_mfma_f32_16x16x32_bf16 v[212:215], v[36:39], v[152:155], v[212:215]
    buffer_load_dwordx4 v[104:107], v7, s[8:11], s20 offen offset:3072 sc1
    v_mfma_f32_16x16x32_bf16 v[220:223], v[40:43], v[152:155], v[220:223]
    ds_read_b64_tr_b16 v[36:37], v166 offset:16384
    ds_read_b64_tr_b16 v[38:39], v166 offset:18432
    v_mfma_f32_16x16x32_bf16 v[216:219], v[40:43], v[148:151], v[216:219]
    v_mfma_f32_16x16x32_bf16 v[224:227], v[44:47], v[148:151], v[224:227]
    ds_read_b64_tr_b16 v[40:41], v167 offset:16384
    ds_read_b64_tr_b16 v[42:43], v167 offset:18432
    v_mfma_f32_16x16x32_bf16 v[228:231], v[44:47], v[152:155], v[228:231]
    v_mfma_f32_16x16x32_bf16 v[236:239], v[48:51], v[152:155], v[236:239]
    ds_read_b64_tr_b16 v[44:45], v168 offset:16384
    ds_read_b64_tr_b16 v[46:47], v168 offset:18432
    v_mfma_f32_16x16x32_bf16 v[232:235], v[48:51], v[148:151], v[232:235]
    v_mfma_f32_16x16x32_bf16 v[240:243], v[52:55], v[148:151], v[240:243]
    ds_read_b64_tr_b16 v[48:49], v169 offset:16384
    ds_read_b64_tr_b16 v[50:51], v169 offset:18432
    v_mfma_f32_16x16x32_bf16 v[244:247], v[52:55], v[152:155], v[244:247]
    v_mfma_f32_16x16x32_bf16 v[252:255], v[56:59], v[152:155], v[252:255]
    ds_read_b64_tr_b16 v[52:53], v170 offset:16384
    ds_read_b64_tr_b16 v[54:55], v170 offset:18432
    v_mfma_f32_16x16x32_bf16 v[248:251], v[56:59], v[148:151], v[248:251]
    s_waitcnt lgkmcnt(12)
    v_mfma_f32_16x16x32_bf16 v[192:195], v[28:31], v[60:63], v[192:195]
    ds_read_b64_tr_b16 v[56:57], v171 offset:16384
    ds_read_b64_tr_b16 v[58:59], v171 offset:18432
    v_mfma_f32_16x16x32_bf16 v[196:199], v[28:31], v[64:67], v[196:199]
    s_add_u32 s20, s20, 0x1000
    buffer_load_dwordx4 v[108:111], v6, s[8:11], s20 offen offset:0 sc1
    s_waitcnt lgkmcnt(12)
    v_mfma_f32_16x16x32_bf16 v[204:207], v[32:35], v[64:67], v[204:207]
    ds_read_b64_tr_b16 v[28:29], v164 offset:24576
    ds_read_b64_tr_b16 v[30:31], v164 offset:26624
    v_mfma_f32_16x16x32_bf16 v[200:203], v[32:35], v[60:63], v[200:203]
    s_waitcnt lgkmcnt(12)
    v_mfma_f32_16x16x32_bf16 v[208:211], v[36:39], v[60:63], v[208:211]
    ds_read_b64_tr_b16 v[32:33], v165 offset:24576
    ds_read_b64_tr_b16 v[34:35], v165 offset:26624
    s_add_u32 m0, s37, 131072
    v_mfma_f32_16x16x32_bf16 v[212:215], v[36:39], v[64:67], v[212:215]
    s_add_u32 s21, s21, 0x20000
    buffer_load_dwordx4 v4, s[12:15], s21 offen offset:0 lds
    s_waitcnt lgkmcnt(12)
    v_mfma_f32_16x16x32_bf16 v[220:223], v[40:43], v[64:67], v[220:223]
    ds_read_b64_tr_b16 v[36:37], v166 offset:24576
    ds_read_b64_tr_b16 v[38:39], v166 offset:26624
    v_mfma_f32_16x16x32_bf16 v[216:219], v[40:43], v[60:63], v[216:219]
    s_waitcnt lgkmcnt(12)
    v_mfma_f32_16x16x32_bf16 v[224:227], v[44:47], v[60:63], v[224:227]
    ds_read_b64_tr_b16 v[40:41], v167 offset:24576
    ds_read_b64_tr_b16 v[42:43], v167 offset:26624
    v_mfma_f32_16x16x32_bf16 v[228:231], v[44:47], v[64:67], v[228:231]
    buffer_load_dwordx4 v[112:115], v7, s[8:11], s20 offen offset:0 sc1
    s_waitcnt lgkmcnt(12)
    v_mfma_f32_16x16x32_bf16 v[236:239], v[48:51], v[64:67], v[236:239]
    ds_read_b64_tr_b16 v[44:45], v168 offset:24576
    ds_read_b64_tr_b16 v[46:47], v168 offset:26624
    v_mfma_f32_16x16x32_bf16 v[232:235], v[48:51], v[60:63], v[232:235]
    s_waitcnt lgkmcnt(12)
    v_mfma_f32_16x16x32_bf16 v[240:243], v[52:55], v[60:63], v[240:243]
    ds_read_b64_tr_b16 v[48:49], v169 offset:24576
    ds_read_b64_tr_b16 v[50:51], v169 offset:26624
    v_mfma_f32_16x16x32_bf16 v[244:247], v[52:55], v[64:67], v[244:247]
    buffer_load_dwordx4 v[116:119], v6, s[8:11], s20 offen offset:1024 sc1
    s_waitcnt lgkmcnt(12)
    v_mfma_f32_16x16x32_bf16 v[252:255], v[56:59], v[64:67], v[252:255]
    ds_read_b64_tr_b16 v[52:53], v170 offset:24576
    ds_read_b64_tr_b16 v[54:55], v170 offset:26624
    v_mfma_f32_16x16x32_bf16 v[248:251], v[56:59], v[60:63], v[248:251]
    s_waitcnt vmcnt(17) lgkmcnt(12)
    v_mfma_f32_16x16x32_bf16 v[192:195], v[28:31], v[68:71], v[192:195]
    ds_read_b64_tr_b16 v[56:57], v171 offset:24576
    ds_read_b64_tr_b16 v[58:59], v171 offset:26624
    s_waitcnt vmcnt(16)
    v_mfma_f32_16x16x32_bf16 v[196:199], v[28:31], v[72:75], v[196:199]
    buffer_load_dwordx4 v5, s[12:15], s21 offen offset:1024 lds
    s_waitcnt lgkmcnt(12)
    v_mfma_f32_16x16x32_bf16 v[204:207], v[32:35], v[72:75], v[204:207]
    s_waitcnt vmcnt(11) lgkmcnt(0)
    s_barrier
    ds_read_b64_tr_b16 v[28:29], v156 offset:0
    ds_read_b64_tr_b16 v[30:31], v156 offset:2048
    v_mfma_f32_16x16x32_bf16 v[200:203], v[32:35], v[68:71], v[200:203]
    v_mfma_f32_16x16x32_bf16 v[208:211], v[36:39], v[68:71], v[208:211]
    ds_read_b64_tr_b16 v[32:33], v157 offset:0
    ds_read_b64_tr_b16 v[34:35], v157 offset:2048
    v_mfma_f32_16x16x32_bf16 v[212:215], v[36:39], v[72:75], v[212:215]
    buffer_load_dwordx4 v[120:123], v7, s[8:11], s20 offen offset:1024 sc1
    v_mfma_f32_16x16x32_bf16 v[220:223], v[40:43], v[72:75], v[220:223]
    ds_read_b64_tr_b16 v[36:37], v158 offset:0
    ds_read_b64_tr_b16 v[38:39], v158 offset:2048
    v_mfma_f32_16x16x32_bf16 v[216:219], v[40:43], v[68:71], v[216:219]
    v_mfma_f32_16x16x32_bf16 v[224:227], v[44:47], v[68:71], v[224:227]
    ds_read_b64_tr_b16 v[40:41], v159 offset:0
    ds_read_b64_tr_b16 v[42:43], v159 offset:2048
    v_mfma_f32_16x16x32_bf16 v[228:231], v[44:47], v[72:75], v[228:231]
    v_mfma_f32_16x16x32_bf16 v[236:239], v[48:51], v[72:75], v[236:239]
    ds_read_b64_tr_b16 v[44:45], v160 offset:0
    ds_read_b64_tr_b16 v[46:47], v160 offset:2048
    v_mfma_f32_16x16x32_bf16 v[232:235], v[48:51], v[68:71], v[232:235]
    v_mfma_f32_16x16x32_bf16 v[240:243], v[52:55], v[68:71], v[240:243]
    ds_read_b64_tr_b16 v[48:49], v161 offset:0
    ds_read_b64_tr_b16 v[50:51], v161 offset:2048
    v_mfma_f32_16x16x32_bf16 v[244:247], v[52:55], v[72:75], v[244:247]
    v_mfma_f32_16x16x32_bf16 v[252:255], v[56:59], v[72:75], v[252:255]
    ds_read_b64_tr_b16 v[52:53], v162 offset:0
    ds_read_b64_tr_b16 v[54:55], v162 offset:2048
    v_mfma_f32_16x16x32_bf16 v[248:251], v[56:59], v[68:71], v[248:251]
    s_waitcnt lgkmcnt(12)
    v_mfma_f32_16x16x32_bf16 v[192:195], v[28:31], v[76:79], v[192:195]
    ds_read_b64_tr_b16 v[56:57], v163 offset:0
    ds_read_b64_tr_b16 v[58:59], v163 offset:2048
    v_mfma_f32_16x16x32_bf16 v[196:199], v[28:31], v[80:83], v[196:199]
    buffer_load_dwordx4 v[124:127], v6, s[8:11], s20 offen offset:2048 sc1
    s_waitcnt lgkmcnt(12)
    v_mfma_f32_16x16x32_bf16 v[204:207], v[32:35], v[80:83], v[204:207]
    ds_read_b64_tr_b16 v[28:29], v156 offset:8192
    ds_read_b64_tr_b16 v[30:31], v156 offset:10240
    v_mfma_f32_16x16x32_bf16 v[200:203], v[32:35], v[76:79], v[200:203]
    s_waitcnt lgkmcnt(12)
    v_mfma_f32_16x16x32_bf16 v[208:211], v[36:39], v[76:79], v[208:211]
    ds_read_b64_tr_b16 v[32:33], v157 offset:8192
    ds_read_b64_tr_b16 v[34:35], v157 offset:10240
    s_add_u32 m0, s37, 147456
    v_mfma_f32_16x16x32_bf16 v[212:215], v[36:39], v[80:83], v[212:215]
    s_add_u32 s21, s21, 0x20000
    buffer_load_dwordx4 v4, s[12:15], s21 offen offset:0 lds
    s_waitcnt lgkmcnt(12)
    v_mfma_f32_16x16x32_bf16 v[220:223], v[40:43], v[80:83], v[220:223]
    ds_read_b64_tr_b16 v[36:37], v158 offset:8192
    ds_read_b64_tr_b16 v[38:39], v158 offset:10240
    v_mfma_f32_16x16x32_bf16 v[216:219], v[40:43], v[76:79], v[216:219]
    s_waitcnt lgkmcnt(12)
    v_mfma_f32_16x16x32_bf16 v[224:227], v[44:47], v[76:79], v[224:227]
    ds_read_b64_tr_b16 v[40:41], v159 offset:8192
    ds_read_b64_tr_b16 v[42:43], v159 offset:10240
    v_mfma_f32_16x16x32_bf16 v[228:231], v[44:47], v[80:83], v[228:231]
    buffer_load_dwordx4 v[128:131], v7, s[8:11], s20 offen offset:2048 sc1
    s_waitcnt lgkmcnt(12)
    v_mfma_f32_16x16x32_bf16 v[236:239], v[48:51], v[80:83], v[236:239]
    ds_read_b64_tr_b16 v[44:45], v160 offset:8192
    ds_read_b64_tr_b16 v[46:47], v160 offset:10240
    v_mfma_f32_16x16x32_bf16 v[232:235], v[48:51], v[76:79], v[232:235]
    s_waitcnt lgkmcnt(12)
    v_mfma_f32_16x16x32_bf16 v[240:243], v[52:55], v[76:79], v[240:243]
    ds_read_b64_tr_b16 v[48:49], v161 offset:8192
    ds_read_b64_tr_b16 v[50:51], v161 offset:10240
    v_mfma_f32_16x16x32_bf16 v[244:247], v[52:55], v[80:83], v[244:247]
    buffer_load_dwordx4 v[132:135], v6, s[8:11], s20 offen offset:3072 sc1
    s_waitcnt lgkmcnt(12)
    v_mfma_f32_16x16x32_bf16 v[252:255], v[56:59], v[80:83], v[252:255]
    ds_read_b64_tr_b16 v[52:53], v162 offset:8192
    ds_read_b64_tr_b16 v[54:55], v162 offset:10240
    v_mfma_f32_16x16x32_bf16 v[248:251], v[56:59], v[76:79], v[248:251]
    s_waitcnt lgkmcnt(12)
    v_mfma_f32_16x16x32_bf16 v[192:195], v[28:31], v[84:87], v[192:195]
    ds_read_b64_tr_b16 v[56:57], v163 offset:8192
    ds_read_b64_tr_b16 v[58:59], v163 offset:10240
    v_mfma_f32_16x16x32_bf16 v[196:199], v[28:31], v[88:91], v[196:199]
    buffer_load_dwordx4 v5, s[12:15], s21 offen offset:1024 lds
    s_waitcnt lgkmcnt(12)
    v_mfma_f32_16x16x32_bf16 v[204:207], v[32:35], v[88:91], v[204:207]
    s_waitcnt vmcnt(12) lgkmcnt(0)
    s_barrier
    ds_read_b64_tr_b16 v[28:29], v156 offset:16384
    ds_read_b64_tr_b16 v[30:31], v156 offset:18432
    v_mfma_f32_16x16x32_bf16 v[200:203], v[32:35], v[84:87], v[200:203]
    v_mfma_f32_16x16x32_bf16 v[208:211], v[36:39], v[84:87], v[208:211]
    ds_read_b64_tr_b16 v[32:33], v157 offset:16384
    ds_read_b64_tr_b16 v[34:35], v157 offset:18432
    v_mfma_f32_16x16x32_bf16 v[212:215], v[36:39], v[88:91], v[212:215]
    buffer_load_dwordx4 v[136:139], v7, s[8:11], s20 offen offset:3072 sc1
    v_mfma_f32_16x16x32_bf16 v[220:223], v[40:43], v[88:91], v[220:223]
    ds_read_b64_tr_b16 v[36:37], v158 offset:16384
    ds_read_b64_tr_b16 v[38:39], v158 offset:18432
    v_mfma_f32_16x16x32_bf16 v[216:219], v[40:43], v[84:87], v[216:219]
    v_mfma_f32_16x16x32_bf16 v[224:227], v[44:47], v[84:87], v[224:227]
    ds_read_b64_tr_b16 v[40:41], v159 offset:16384
    ds_read_b64_tr_b16 v[42:43], v159 offset:18432
    v_mfma_f32_16x16x32_bf16 v[228:231], v[44:47], v[88:91], v[228:231]
    v_mfma_f32_16x16x32_bf16 v[236:239], v[48:51], v[88:91], v[236:239]
    ds_read_b64_tr_b16 v[44:45], v160 offset:16384
    ds_read_b64_tr_b16 v[46:47], v160 offset:18432
    v_mfma_f32_16x16x32_bf16 v[232:235], v[48:51], v[84:87], v[232:235]
    v_mfma_f32_16x16x32_bf16 v[240:243], v[52:55], v[84:87], v[240:243]
    ds_read_b64_tr_b16 v[48:49], v161 offset:16384
    ds_read_b64_tr_b16 v[50:51], v161 offset:18432
    v_mfma_f32_16x16x32_bf16 v[244:247], v[52:55], v[88:91], v[244:247]
    v_mfma_f32_16x16x32_bf16 v[252:255], v[56:59], v[88:91], v[252:255]
    ds_read_b64_tr_b16 v[52:53], v162 offset:16384
    ds_read_b64_tr_b16 v[54:55], v162 offset:18432
    v_mfma_f32_16x16x32_bf16 v[248:251], v[56:59], v[84:87], v[248:251]
    s_waitcnt lgkmcnt(12)
    v_mfma_f32_16x16x32_bf16 v[192:195], v[28:31], v[92:95], v[192:195]
    ds_read_b64_tr_b16 v[56:57], v163 offset:16384
    ds_read_b64_tr_b16 v[58:59], v163 offset:18432
    v_mfma_f32_16x16x32_bf16 v[196:199], v[28:31], v[96:99], v[196:199]
    s_add_u32 s20, s20, 0x1000
    buffer_load_dwordx4 v[140:143], v6, s[8:11], s20 offen offset:0 sc1
    s_waitcnt lgkmcnt(12)
    v_mfma_f32_16x16x32_bf16 v[204:207], v[32:35], v[96:99], v[204:207]
    ds_read_b64_tr_b16 v[28:29], v156 offset:24576
    ds_read_b64_tr_b16 v[30:31], v156 offset:26624
    v_mfma_f32_16x16x32_bf16 v[200:203], v[32:35], v[92:95], v[200:203]
    s_waitcnt lgkmcnt(12)
    v_mfma_f32_16x16x32_bf16 v[208:211], v[36:39], v[92:95], v[208:211]
    ds_read_b64_tr_b16 v[32:33], v157 offset:24576
    ds_read_b64_tr_b16 v[34:35], v157 offset:26624
    s_add_u32 m0, s37, 65536
    v_mfma_f32_16x16x32_bf16 v[212:215], v[36:39], v[96:99], v[212:215]
    s_add_u32 s21, s21, 0x20000
    buffer_load_dwordx4 v4, s[12:15], s21 offen offset:0 lds
    s_waitcnt lgkmcnt(12)
    v_mfma_f32_16x16x32_bf16 v[220:223], v[40:43], v[96:99], v[220:223]
    ds_read_b64_tr_b16 v[36:37], v158 offset:24576
    ds_read_b64_tr_b16 v[38:39], v158 offset:26624
    v_mfma_f32_16x16x32_bf16 v[216:219], v[40:43], v[92:95], v[216:219]
    s_waitcnt lgkmcnt(12)
    v_mfma_f32_16x16x32_bf16 v[224:227], v[44:47], v[92:95], v[224:227]
    ds_read_b64_tr_b16 v[40:41], v159 offset:24576
    ds_read_b64_tr_b16 v[42:43], v159 offset:26624
    v_mfma_f32_16x16x32_bf16 v[228:231], v[44:47], v[96:99], v[228:231]
    buffer_load_dwordx4 v[144:147], v7, s[8:11], s20 offen offset:0 sc1
    s_waitcnt lgkmcnt(12)
    v_mfma_f32_16x16x32_bf16 v[236:239], v[48:51], v[96:99], v[236:239]
    ds_read_b64_tr_b16 v[44:45], v160 offset:24576
    ds_read_b64_tr_b16 v[46:47], v160 offset:26624
    v_mfma_f32_16x16x32_bf16 v[232:235], v[48:51], v[92:95], v[232:235]
    s_waitcnt lgkmcnt(12)
    v_mfma_f32_16x16x32_bf16 v[240:243], v[52:55], v[92:95], v[240:243]
    ds_read_b64_tr_b16 v[48:49], v161 offset:24576
    ds_read_b64_tr_b16 v[50:51], v161 offset:26624
    v_mfma_f32_16x16x32_bf16 v[244:247], v[52:55], v[96:99], v[244:247]
    buffer_load_dwordx4 v[148:151], v6, s[8:11], s20 offen offset:1024 sc1
    s_waitcnt lgkmcnt(12)
    v_mfma_f32_16x16x32_bf16 v[252:255], v[56:59], v[96:99], v[252:255]
    ds_read_b64_tr_b16 v[52:53], v162 offset:24576
    ds_read_b64_tr_b16 v[54:55], v162 offset:26624
    v_mfma_f32_16x16x32_bf16 v[248:251], v[56:59], v[92:95], v[248:251]
    s_waitcnt lgkmcnt(12)
    v_mfma_f32_16x16x32_bf16 v[192:195], v[28:31], v[100:103], v[192:195]
    ds_read_b64_tr_b16 v[56:57], v163 offset:24576
    ds_read_b64_tr_b16 v[58:59], v163 offset:26624
    s_waitcnt vmcnt(16)
    v_mfma_f32_16x16x32_bf16 v[196:199], v[28:31], v[104:107], v[196:199]
    buffer_load_dwordx4 v5, s[12:15], s21 offen offset:1024 lds
    s_waitcnt lgkmcnt(12)
    v_mfma_f32_16x16x32_bf16 v[204:207], v[32:35], v[104:107], v[204:207]
    s_waitcnt vmcnt(12) lgkmcnt(0)
    s_barrier
    ds_read_b64_tr_b16 v[28:29], v156 offset:32768
    ds_read_b64_tr_b16 v[30:31], v156 offset:34816
    v_mfma_f32_16x16x32_bf16 v[200:203], v[32:35], v[100:103], v[200:203]
    v_mfma_f32_16x16x32_bf16 v[208:211], v[36:39], v[100:103], v[208:211]
    ds_read_b64_tr_b16 v[32:33], v157 offset:32768
    ds_read_b64_tr_b16 v[34:35], v157 offset:34816
    v_mfma_f32_16x16x32_bf16 v[212:215], v[36:39], v[104:107], v[212:215]
    buffer_load_dwordx4 v[152:155], v7, s[8:11], s20 offen offset:1024 sc1
    v_mfma_f32_16x16x32_bf16 v[220:223], v[40:43], v[104:107], v[220:223]
    ds_read_b64_tr_b16 v[36:37], v158 offset:32768
    ds_read_b64_tr_b16 v[38:39], v158 offset:34816
    v_mfma_f32_16x16x32_bf16 v[216:219], v[40:43], v[100:103], v[216:219]
    v_mfma_f32_16x16x32_bf16 v[224:227], v[44:47], v[100:103], v[224:227]
    ds_read_b64_tr_b16 v[40:41], v159 offset:32768
    ds_read_b64_tr_b16 v[42:43], v159 offset:34816
    v_mfma_f32_16x16x32_bf16 v[228:231], v[44:47], v[104:107], v[228:231]
    v_mfma_f32_16x16x32_bf16 v[236:239], v[48:51], v[104:107], v[236:239]
    ds_read_b64_tr_b16 v[44:45], v160 offset:32768
    ds_read_b64_tr_b16 v[46:47], v160 offset:34816
    v_mfma_f32_16x16x32_bf16 v[232:235], v[48:51], v[100:103], v[232:235]
    v_mfma_f32_16x16x32_bf16 v[240:243], v[52:55], v[100:103], v[240:243]
    ds_read_b64_tr_b16 v[48:49], v161 offset:32768
    ds_read_b64_tr_b16 v[50:51], v161 offset:34816
    v_mfma_f32_16x16x32_bf16 v[244:247], v[52:55], v[104:107], v[244:247]
    v_mfma_f32_16x16x32_bf16 v[252:255], v[56:59], v[104:107], v[252:255]
    ds_read_b64_tr_b16 v[52:53], v162 offset:32768
    ds_read_b64_tr_b16 v[54:55], v162 offset:34816
    v_mfma_f32_16x16x32_bf16 v[248:251], v[56:59], v[100:103], v[248:251]
    s_waitcnt lgkmcnt(12)
    v_mfma_f32_16x16x32_bf16 v[192:195], v[28:31], v[108:111], v[192:195]
    ds_read_b64_tr_b16 v[56:57], v163 offset:32768
    ds_read_b64_tr_b16 v[58:59], v163 offset:34816
    v_mfma_f32_16x16x32_bf16 v[196:199], v[28:31], v[112:115], v[196:199]
    buffer_load_dwordx4 v[60:63], v6, s[8:11], s20 offen offset:2048 sc1
    s_waitcnt lgkmcnt(12)
    v_mfma_f32_16x16x32_bf16 v[204:207], v[32:35], v[112:115], v[204:207]
    ds_read_b64_tr_b16 v[28:29], v156 offset:40960
    ds_read_b64_tr_b16 v[30:31], v156 offset:43008
    v_mfma_f32_16x16x32_bf16 v[200:203], v[32:35], v[108:111], v[200:203]
    s_waitcnt lgkmcnt(12)
    v_mfma_f32_16x16x32_bf16 v[208:211], v[36:39], v[108:111], v[208:211]
    ds_read_b64_tr_b16 v[32:33], v157 offset:40960
    ds_read_b64_tr_b16 v[34:35], v157 offset:43008
    s_add_u32 m0, s37, 81920
    v_mfma_f32_16x16x32_bf16 v[212:215], v[36:39], v[112:115], v[212:215]
    s_add_u32 s21, s21, 0x20000
    buffer_load_dwordx4 v4, s[12:15], s21 offen offset:0 lds
    s_waitcnt lgkmcnt(12)
    v_mfma_f32_16x16x32_bf16 v[220:223], v[40:43], v[112:115], v[220:223]
    ds_read_b64_tr_b16 v[36:37], v158 offset:40960
    ds_read_b64_tr_b16 v[38:39], v158 offset:43008
    v_mfma_f32_16x16x32_bf16 v[216:219], v[40:43], v[108:111], v[216:219]
    s_waitcnt lgkmcnt(12)
    v_mfma_f32_16x16x32_bf16 v[224:227], v[44:47], v[108:111], v[224:227]
    ds_read_b64_tr_b16 v[40:41], v159 offset:40960
    ds_read_b64_tr_b16 v[42:43], v159 offset:43008
    v_mfma_f32_16x16x32_bf16 v[228:231], v[44:47], v[112:115], v[228:231]
    buffer_load_dwordx4 v[64:67], v7, s[8:11], s20 offen offset:2048 sc1
    s_waitcnt lgkmcnt(12)
    v_mfma_f32_16x16x32_bf16 v[236:239], v[48:51], v[112:115], v[236:239]
    ds_read_b64_tr_b16 v[44:45], v160 offset:40960
    ds_read_b64_tr_b16 v[46:47], v160 offset:43008
    v_mfma_f32_16x16x32_bf16 v[232:235], v[48:51], v[108:111], v[232:235]
    s_waitcnt lgkmcnt(12)
    v_mfma_f32_16x16x32_bf16 v[240:243], v[52:55], v[108:111], v[240:243]
    ds_read_b64_tr_b16 v[48:49], v161 offset:40960
    ds_read_b64_tr_b16 v[50:51], v161 offset:43008
    v_mfma_f32_16x16x32_bf16 v[244:247], v[52:55], v[112:115], v[244:247]
    buffer_load_dwordx4 v[68:71], v6, s[8:11], s20 offen offset:3072 sc1
    s_waitcnt lgkmcnt(12)
    v_mfma_f32_16x16x32_bf16 v[252:255], v[56:59], v[112:115], v[252:255]
    ds_read_b64_tr_b16 v[52:53], v162 offset:40960
    ds_read_b64_tr_b16 v[54:55], v162 offset:43008
    v_mfma_f32_16x16x32_bf16 v[248:251], v[56:59], v[108:111], v[248:251]
    s_waitcnt lgkmcnt(12)
    v_mfma_f32_16x16x32_bf16 v[192:195], v[28:31], v[116:119], v[192:195]
    ds_read_b64_tr_b16 v[56:57], v163 offset:40960
    ds_read_b64_tr_b16 v[58:59], v163 offset:43008
    s_waitcnt vmcnt(16)
    v_mfma_f32_16x16x32_bf16 v[196:199], v[28:31], v[120:123], v[196:199]
    buffer_load_dwordx4 v5, s[12:15], s21 offen offset:1024 lds
    s_waitcnt lgkmcnt(12)
    v_mfma_f32_16x16x32_bf16 v[204:207], v[32:35], v[120:123], v[204:207]
    s_waitcnt vmcnt(12) lgkmcnt(0)
    s_barrier
    ds_read_b64_tr_b16 v[28:29], v156 offset:49152
    ds_read_b64_tr_b16 v[30:31], v156 offset:51200
    v_mfma_f32_16x16x32_bf16 v[200:203], v[32:35], v[116:119], v[200:203]
    v_mfma_f32_16x16x32_bf16 v[208:211], v[36:39], v[116:119], v[208:211]
    ds_read_b64_tr_b16 v[32:33], v157 offset:49152
    ds_read_b64_tr_b16 v[34:35], v157 offset:51200
    v_mfma_f32_16x16x32_bf16 v[212:215], v[36:39], v[120:123], v[212:215]
    buffer_load_dwordx4 v[72:75], v7, s[8:11], s20 offen offset:3072 sc1
    v_mfma_f32_16x16x32_bf16 v[220:223], v[40:43], v[120:123], v[220:223]
    ds_read_b64_tr_b16 v[36:37], v158 offset:49152
    ds_read_b64_tr_b16 v[38:39], v158 offset:51200
    v_mfma_f32_16x16x32_bf16 v[216:219], v[40:43], v[116:119], v[216:219]
    v_mfma_f32_16x16x32_bf16 v[224:227], v[44:47], v[116:119], v[224:227]
    ds_read_b64_tr_b16 v[40:41], v159 offset:49152
    ds_read_b64_tr_b16 v[42:43], v159 offset:51200
    v_mfma_f32_16x16x32_bf16 v[228:231], v[44:47], v[120:123], v[228:231]
    v_mfma_f32_16x16x32_bf16 v[236:239], v[48:51], v[120:123], v[236:239]
    ds_read_b64_tr_b16 v[44:45], v160 offset:49152
    ds_read_b64_tr_b16 v[46:47], v160 offset:51200
    v_mfma_f32_16x16x32_bf16 v[232:235], v[48:51], v[116:119], v[232:235]
    v_mfma_f32_16x16x32_bf16 v[240:243], v[52:55], v[116:119], v[240:243]
    ds_read_b64_tr_b16 v[48:49], v161 offset:49152
    ds_read_b64_tr_b16 v[50:51], v161 offset:51200
    v_mfma_f32_16x16x32_bf16 v[244:247], v[52:55], v[120:123], v[244:247]
    v_mfma_f32_16x16x32_bf16 v[252:255], v[56:59], v[120:123], v[252:255]
    ds_read_b64_tr_b16 v[52:53], v162 offset:49152
    ds_read_b64_tr_b16 v[54:55], v162 offset:51200
    v_mfma_f32_16x16x32_bf16 v[248:251], v[56:59], v[116:119], v[248:251]
    s_waitcnt lgkmcnt(12)
    v_mfma_f32_16x16x32_bf16 v[192:195], v[28:31], v[124:127], v[192:195]
    ds_read_b64_tr_b16 v[56:57], v163 offset:49152
    ds_read_b64_tr_b16 v[58:59], v163 offset:51200
    v_mfma_f32_16x16x32_bf16 v[196:199], v[28:31], v[128:131], v[196:199]
    s_add_u32 s20, s20, 0x1000
    buffer_load_dwordx4 v[76:79], v6, s[8:11], s20 offen offset:0 sc1
    s_waitcnt lgkmcnt(12)
    v_mfma_f32_16x16x32_bf16 v[204:207], v[32:35], v[128:131], v[204:207]
    ds_read_b64_tr_b16 v[28:29], v156 offset:57344
    ds_read_b64_tr_b16 v[30:31], v156 offset:59392
    v_mfma_f32_16x16x32_bf16 v[200:203], v[32:35], v[124:127], v[200:203]
    buffer_load_dword v16, v22, s[24:27], s54 offen offset:260 sc1
    s_waitcnt lgkmcnt(12)
    v_mfma_f32_16x16x32_bf16 v[208:211], v[36:39], v[124:127], v[208:211]
    ds_read_b64_tr_b16 v[32:33], v157 offset:57344
    ds_read_b64_tr_b16 v[34:35], v157 offset:59392
    s_add_u32 m0, s37, 98304
    v_mfma_f32_16x16x32_bf16 v[212:215], v[36:39], v[128:131], v[212:215]
    s_add_u32 s21, s21, 0x20000
    buffer_load_dwordx4 v4, s[12:15], s21 offen offset:0 lds
    s_waitcnt lgkmcnt(12)
    v_mfma_f32_16x16x32_bf16 v[220:223], v[40:43], v[128:131], v[220:223]
    ds_read_b64_tr_b16 v[36:37], v158 offset:57344
    ds_read_b64_tr_b16 v[38:39], v158 offset:59392
    v_mfma_f32_16x16x32_bf16 v[216:219], v[40:43], v[124:127], v[216:219]
    s_waitcnt lgkmcnt(12)
    v_mfma_f32_16x16x32_bf16 v[224:227], v[44:47], v[124:127], v[224:227]
    ds_read_b64_tr_b16 v[40:41], v159 offset:57344
    ds_read_b64_tr_b16 v[42:43], v159 offset:59392
    v_mfma_f32_16x16x32_bf16 v[228:231], v[44:47], v[128:131], v[228:231]
    buffer_load_dwordx4 v[80:83], v7, s[8:11], s20 offen offset:0 sc1
    s_waitcnt lgkmcnt(12)
    v_mfma_f32_16x16x32_bf16 v[236:239], v[48:51], v[128:131], v[236:239]
    ds_read_b64_tr_b16 v[44:45], v160 offset:57344
    ds_read_b64_tr_b16 v[46:47], v160 offset:59392
    v_mfma_f32_16x16x32_bf16 v[232:235], v[48:51], v[124:127], v[232:235]
    s_waitcnt lgkmcnt(12)
    v_mfma_f32_16x16x32_bf16 v[240:243], v[52:55], v[124:127], v[240:243]
    ds_read_b64_tr_b16 v[48:49], v161 offset:57344
    ds_read_b64_tr_b16 v[50:51], v161 offset:59392
    v_mfma_f32_16x16x32_bf16 v[244:247], v[52:55], v[128:131], v[244:247]
    buffer_load_dwordx4 v[84:87], v6, s[8:11], s20 offen offset:1024 sc1
    s_waitcnt lgkmcnt(12)
    v_mfma_f32_16x16x32_bf16 v[252:255], v[56:59], v[128:131], v[252:255]
    ds_read_b64_tr_b16 v[52:53], v162 offset:57344
    ds_read_b64_tr_b16 v[54:55], v162 offset:59392
    v_mfma_f32_16x16x32_bf16 v[248:251], v[56:59], v[124:127], v[248:251]
    s_waitcnt lgkmcnt(12)
    v_mfma_f32_16x16x32_bf16 v[192:195], v[28:31], v[132:135], v[192:195]
    ds_read_b64_tr_b16 v[56:57], v163 offset:57344
    ds_read_b64_tr_b16 v[58:59], v163 offset:59392
    s_waitcnt vmcnt(17)
    v_mfma_f32_16x16x32_bf16 v[196:199], v[28:31], v[136:139], v[196:199]
    buffer_load_dwordx4 v5, s[12:15], s21 offen offset:1024 lds
    s_waitcnt lgkmcnt(12)
    v_mfma_f32_16x16x32_bf16 v[204:207], v[32:35], v[136:139], v[204:207]
    s_waitcnt vmcnt(13) lgkmcnt(0)
    s_barrier
    ds_read_b64_tr_b16 v[28:29], v164 offset:0
    ds_read_b64_tr_b16 v[30:31], v164 offset:2048
    v_mfma_f32_16x16x32_bf16 v[200:203], v[32:35], v[132:135], v[200:203]
    v_mfma_f32_16x16x32_bf16 v[208:211], v[36:39], v[132:135], v[208:211]
    ds_read_b64_tr_b16 v[32:33], v165 offset:0
    ds_read_b64_tr_b16 v[34:35], v165 offset:2048
    v_mfma_f32_16x16x32_bf16 v[212:215], v[36:39], v[136:139], v[212:215]
    buffer_load_dwordx4 v[88:91], v7, s[8:11], s20 offen offset:1024 sc1
    v_mfma_f32_16x16x32_bf16 v[220:223], v[40:43], v[136:139], v[220:223]
    ds_read_b64_tr_b16 v[36:37], v166 offset:0
    ds_read_b64_tr_b16 v[38:39], v166 offset:2048
    v_mfma_f32_16x16x32_bf16 v[216:219], v[40:43], v[132:135], v[216:219]
    v_mfma_f32_16x16x32_bf16 v[224:227], v[44:47], v[132:135], v[224:227]
    ds_read_b64_tr_b16 v[40:41], v167 offset:0
    ds_read_b64_tr_b16 v[42:43], v167 offset:2048
    v_mfma_f32_16x16x32_bf16 v[228:231], v[44:47], v[136:139], v[228:231]
    v_mfma_f32_16x16x32_bf16 v[236:239], v[48:51], v[136:139], v[236:239]
    ds_read_b64_tr_b16 v[44:45], v168 offset:0
    ds_read_b64_tr_b16 v[46:47], v168 offset:2048
    v_mfma_f32_16x16x32_bf16 v[232:235], v[48:51], v[132:135], v[232:235]
    v_mfma_f32_16x16x32_bf16 v[240:243], v[52:55], v[132:135], v[240:243]
    ds_read_b64_tr_b16 v[48:49], v169 offset:0
    ds_read_b64_tr_b16 v[50:51], v169 offset:2048
    v_mfma_f32_16x16x32_bf16 v[244:247], v[52:55], v[136:139], v[244:247]
    v_mfma_f32_16x16x32_bf16 v[252:255], v[56:59], v[136:139], v[252:255]
    ds_read_b64_tr_b16 v[52:53], v170 offset:0
    ds_read_b64_tr_b16 v[54:55], v170 offset:2048
    v_mfma_f32_16x16x32_bf16 v[248:251], v[56:59], v[132:135], v[248:251]
    s_waitcnt lgkmcnt(12)
    v_mfma_f32_16x16x32_bf16 v[192:195], v[28:31], v[140:143], v[192:195]
    ds_read_b64_tr_b16 v[56:57], v171 offset:0
    ds_read_b64_tr_b16 v[58:59], v171 offset:2048
    v_mfma_f32_16x16x32_bf16 v[196:199], v[28:31], v[144:147], v[196:199]
    buffer_load_dwordx4 v[92:95], v6, s[8:11], s20 offen offset:2048 sc1
    s_waitcnt lgkmcnt(12)
    v_mfma_f32_16x16x32_bf16 v[204:207], v[32:35], v[144:147], v[204:207]
    ds_read_b64_tr_b16 v[28:29], v164 offset:8192
    ds_read_b64_tr_b16 v[30:31], v164 offset:10240
    v_mfma_f32_16x16x32_bf16 v[200:203], v[32:35], v[140:143], v[200:203]
    s_waitcnt lgkmcnt(12)
    v_mfma_f32_16x16x32_bf16 v[208:211], v[36:39], v[140:143], v[208:211]
    ds_read_b64_tr_b16 v[32:33], v165 offset:8192
    ds_read_b64_tr_b16 v[34:35], v165 offset:10240
    s_add_u32 m0, s37, 114688
    v_mfma_f32_16x16x32_bf16 v[212:215], v[36:39], v[144:147], v[212:215]
    s_add_u32 s21, s21, 0x20000
    buffer_load_dwordx4 v4, s[12:15], s21 offen offset:0 lds
    s_waitcnt lgkmcnt(12)
    v_mfma_f32_16x16x32_bf16 v[220:223], v[40:43], v[144:147], v[220:223]
    ds_read_b64_tr_b16 v[36:37], v166 offset:8192
    ds_read_b64_tr_b16 v[38:39], v166 offset:10240
    v_mfma_f32_16x16x32_bf16 v[216:219], v[40:43], v[140:143], v[216:219]
    s_waitcnt lgkmcnt(12)
    v_mfma_f32_16x16x32_bf16 v[224:227], v[44:47], v[140:143], v[224:227]
    ds_read_b64_tr_b16 v[40:41], v167 offset:8192
    ds_read_b64_tr_b16 v[42:43], v167 offset:10240
    v_mfma_f32_16x16x32_bf16 v[228:231], v[44:47], v[144:147], v[228:231]
    buffer_load_dwordx4 v[96:99], v7, s[8:11], s20 offen offset:2048 sc1
    s_waitcnt lgkmcnt(12)
    v_mfma_f32_16x16x32_bf16 v[236:239], v[48:51], v[144:147], v[236:239]
    ds_read_b64_tr_b16 v[44:45], v168 offset:8192
    ds_read_b64_tr_b16 v[46:47], v168 offset:10240
    v_mfma_f32_16x16x32_bf16 v[232:235], v[48:51], v[140:143], v[232:235]
    s_waitcnt lgkmcnt(12)
    v_mfma_f32_16x16x32_bf16 v[240:243], v[52:55], v[140:143], v[240:243]
    ds_read_b64_tr_b16 v[48:49], v169 offset:8192
    ds_read_b64_tr_b16 v[50:51], v169 offset:10240
    v_mfma_f32_16x16x32_bf16 v[244:247], v[52:55], v[144:147], v[244:247]
    buffer_load_dwordx4 v[100:103], v6, s[8:11], s20 offen offset:3072 sc1
    s_waitcnt lgkmcnt(12)
    v_mfma_f32_16x16x32_bf16 v[252:255], v[56:59], v[144:147], v[252:255]
    ds_read_b64_tr_b16 v[52:53], v170 offset:8192
    ds_read_b64_tr_b16 v[54:55], v170 offset:10240
    v_mfma_f32_16x16x32_bf16 v[248:251], v[56:59], v[140:143], v[248:251]
    s_waitcnt lgkmcnt(12)
    v_mfma_f32_16x16x32_bf16 v[192:195], v[28:31], v[148:151], v[192:195]
    ds_read_b64_tr_b16 v[56:57], v171 offset:8192
    ds_read_b64_tr_b16 v[58:59], v171 offset:10240
    s_waitcnt vmcnt(17)
    v_mfma_f32_16x16x32_bf16 v[196:199], v[28:31], v[152:155], v[196:199]
    buffer_load_dwordx4 v5, s[12:15], s21 offen offset:1024 lds
    s_waitcnt lgkmcnt(12)
    v_mfma_f32_16x16x32_bf16 v[204:207], v[32:35], v[152:155], v[204:207]
    s_waitcnt vmcnt(13) lgkmcnt(0)
    s_barrier
    ds_read_b64_tr_b16 v[28:29], v164 offset:16384
    ds_read_b64_tr_b16 v[30:31], v164 offset:18432
    v_mfma_f32_16x16x32_bf16 v[200:203], v[32:35], v[148:151], v[200:203]
    v_mfma_f32_16x16x32_bf16 v[208:211], v[36:39], v[148:151], v[208:211]
    ds_read_b64_tr_b16 v[32:33], v165 offset:16384
    ds_read_b64_tr_b16 v[34:35], v165 offset:18432
    v_mfma_f32_16x16x32_bf16 v[212:215], v[36:39], v[152:155], v[212:215]
    buffer_load_dwordx4 v[104:107], v7, s[8:11], s20 offen offset:3072 sc1
    v_mfma_f32_16x16x32_bf16 v[220:223], v[40:43], v[152:155], v[220:223]
    ds_read_b64_tr_b16 v[36:37], v166 offset:16384
    ds_read_b64_tr_b16 v[38:39], v166 offset:18432
    v_mfma_f32_16x16x32_bf16 v[216:219], v[40:43], v[148:151], v[216:219]
    v_mfma_f32_16x16x32_bf16 v[224:227], v[44:47], v[148:151], v[224:227]
    ds_read_b64_tr_b16 v[40:41], v167 offset:16384
    ds_read_b64_tr_b16 v[42:43], v167 offset:18432
    v_mfma_f32_16x16x32_bf16 v[228:231], v[44:47], v[152:155], v[228:231]
    v_mfma_f32_16x16x32_bf16 v[236:239], v[48:51], v[152:155], v[236:239]
    ds_read_b64_tr_b16 v[44:45], v168 offset:16384
    ds_read_b64_tr_b16 v[46:47], v168 offset:18432
    v_mfma_f32_16x16x32_bf16 v[232:235], v[48:51], v[148:151], v[232:235]
    v_mfma_f32_16x16x32_bf16 v[240:243], v[52:55], v[148:151], v[240:243]
    ds_read_b64_tr_b16 v[48:49], v169 offset:16384
    ds_read_b64_tr_b16 v[50:51], v169 offset:18432
    v_mfma_f32_16x16x32_bf16 v[244:247], v[52:55], v[152:155], v[244:247]
    v_mfma_f32_16x16x32_bf16 v[252:255], v[56:59], v[152:155], v[252:255]
    ds_read_b64_tr_b16 v[52:53], v170 offset:16384
    ds_read_b64_tr_b16 v[54:55], v170 offset:18432
    v_mfma_f32_16x16x32_bf16 v[248:251], v[56:59], v[148:151], v[248:251]
    s_waitcnt lgkmcnt(12)
    v_mfma_f32_16x16x32_bf16 v[192:195], v[28:31], v[60:63], v[192:195]
    ds_read_b64_tr_b16 v[56:57], v171 offset:16384
    ds_read_b64_tr_b16 v[58:59], v171 offset:18432
    v_mfma_f32_16x16x32_bf16 v[196:199], v[28:31], v[64:67], v[196:199]
    s_waitcnt vmcnt(11)
    v_cmp_ne_u32 vcc, 1, v16
    s_nop 1
    s_cmp_eq_u64 vcc, 0
    s_cbranch_scc0 LC_slowO0
LC_goO0:
    v_and_b32 v26, 7, v1
    v_bfe_u32 v27, v1, 3, 1
    v_lshlrev_b32 v27, 9, v27
    v_lshl_add_u32 v26, v26, 2, v27
    s_lshl_b32 s56, s3, 11
    s_add_u32 s56, s56, s54
    buffer_load_dword v172, v26, s[24:27], s56 offen offset:0 sc1
    buffer_load_dword v173, v26, s[24:27], s56 offen offset:1024 sc1
    s_add_u32 s20, s20, 0x1000
    buffer_load_dwordx4 v[108:111], v6, s[8:11], s20 offen offset:0 sc1
    s_waitcnt lgkmcnt(12)
    v_mfma_f32_16x16x32_bf16 v[204:207], v[32:35], v[64:67], v[204:207]
    ds_read_b64_tr_b16 v[28:29], v164 offset:24576
    ds_read_b64_tr_b16 v[30:31], v164 offset:26624
    v_mfma_f32_16x16x32_bf16 v[200:203], v[32:35], v[60:63], v[200:203]
    s_waitcnt lgkmcnt(12)
    v_mfma_f32_16x16x32_bf16 v[208:211], v[36:39], v[60:63], v[208:211]
    ds_read_b64_tr_b16 v[32:33], v165 offset:24576
    ds_read_b64_tr_b16 v[34:35], v165 offset:26624
    s_add_u32 m0, s37, 131072
    v_mfma_f32_16x16x32_bf16 v[212:215], v[36:39], v[64:67], v[212:215]
    buffer_load_dwordx4 v4, s[32:35], s22 offen offset:0 lds
    s_waitcnt lgkmcnt(12)
    v_mfma_f32_16x16x32_bf16 v[220:223], v[40:43], v[64:67], v[220:223]
    ds_read_b64_tr_b16 v[36:37], v166 offset:24576
    ds_read_b64_tr_b16 v[38:39], v166 offset:26624
    v_mfma_f32_16x16x32_bf16 v[216:219], v[40:43], v[60:63], v[216:219]
    s_waitcnt lgkmcnt(12)
    v_mfma_f32_16x16x32_bf16 v[224:227], v[44:47], v[60:63], v[224:227]
    ds_read_b64_tr_b16 v[40:41], v167 offset:24576
    ds_read_b64_tr_b16 v[42:43], v167 offset:26624
    v_mfma_f32_16x16x32_bf16 v[228:231], v[44:47], v[64:67], v[228:231]
    buffer_load_dwordx4 v[112:115], v7, s[8:11], s20 offen offset:0 sc1
    s_waitcnt lgkmcnt(12)
    v_mfma_f32_16x16x32_bf16 v[236:239], v[48:51], v[64:67], v[236:239]
    ds_read_b64_tr_b16 v[44:45], v168 offset:24576
    ds_read_b64_tr_b16 v[46:47], v168 offset:26624
    v_mfma_f32_16x16x32_bf16 v[232:235], v[48:51], v[60:63], v[232:235]
    s_waitcnt lgkmcnt(12)
    v_mfma_f32_16x16x32_bf16 v[240:243], v[52:55], v[60:63], v[240:243]
    ds_read_b64_tr_b16 v[48:49], v169 offset:24576
    ds_read_b64_tr_b16 v[50:51], v169 offset:26624
    v_mfma_f32_16x16x32_bf16 v[244:247], v[52:55], v[64:67], v[244:247]
    buffer_load_dwordx4 v[116:119], v6, s[8:11], s20 offen offset:1024 sc1
    s_waitcnt lgkmcnt(12)
    v_mfma_f32_16x16x32_bf16 v[252:255], v[56:59], v[64:67], v[252:255]
    ds_read_b64_tr_b16 v[52:53], v170 offset:24576
    ds_read_b64_tr_b16 v[54:55], v170 offset:26624
    v_mfma_f32_16x16x32_bf16 v[248:251], v[56:59], v[60:63], v[248:251]
    s_waitcnt lgkmcnt(12)
    v_mfma_f32_16x16x32_bf16 v[192:195], v[28:31], v[68:71], v[192:195]
    ds_read_b64_tr_b16 v[56:57], v171 offset:24576
    ds_read_b64_tr_b16 v[58:59], v171 offset:26624
    v_mfma_f32_16x16x32_bf16 v[196:199], v[28:31], v[72:75], v[196:199]
    buffer_load_dwordx4 v5, s[32:35], s22 offen offset:1024 lds
    s_add_u32 s22, s22, 131072
    s_waitcnt lgkmcnt(12)
    v_mfma_f32_16x16x32_bf16 v[204:207], v[32:35], v[72:75], v[204:207]
    s_waitcnt vmcnt(14) lgkmcnt(0)
    s_barrier
    ds_read_b64_tr_b16 v[28:29], v158 offset:0
    ds_read_b64_tr_b16 v[30:31], v158 offset:2048
    v_mfma_f32_16x16x32_bf16 v[200:203], v[32:35], v[68:71], v[200:203]
    v_mfma_f32_16x16x32_bf16 v[208:211], v[36:39], v[68:71], v[208:211]
    ds_read_b64_tr_b16 v[32:33], v159 offset:0
    ds_read_b64_tr_b16 v[34:35], v159 offset:2048
    v_mfma_f32_16x16x32_bf16 v[212:215], v[36:39], v[72:75], v[212:215]
    buffer_load_dwordx4 v[120:123], v7, s[8:11], s20 offen offset:1024 sc1
    v_mfma_f32_16x16x32_bf16 v[220:223], v[40:43], v[72:75], v[220:223]
    ds_read_b64_tr_b16 v[36:37], v160 offset:0
    ds_read_b64_tr_b16 v[38:39], v160 offset:2048
    v_mfma_f32_16x16x32_bf16 v[216:219], v[40:43], v[68:71], v[216:219]
    v_mfma_f32_16x16x32_bf16 v[224:227], v[44:47], v[68:71], v[224:227]
    ds_read_b64_tr_b16 v[40:41], v161 offset:0
    ds_read_b64_tr_b16 v[42:43], v161 offset:2048
    v_mfma_f32_16x16x32_bf16 v[228:231], v[44:47], v[72:75], v[228:231]
    v_mfma_f32_16x16x32_bf16 v[236:239], v[48:51], v[72:75], v[236:239]
    ds_read_b64_tr_b16 v[44:45], v162 offset:0
    ds_read_b64_tr_b16 v[46:47], v162 offset:2048
    v_mfma_f32_16x16x32_bf16 v[232:235], v[48:51], v[68:71], v[232:235]
    v_mfma_f32_16x16x32_bf16 v[240:243], v[52:55], v[68:71], v[240:243]
    ds_read_b64_tr_b16 v[48:49], v163 offset:0
    ds_read_b64_tr_b16 v[50:51], v163 offset:2048
    v_mfma_f32_16x16x32_bf16 v[244:247], v[52:55], v[72:75], v[244:247]
    v_mfma_f32_16x16x32_bf16 v[252:255], v[56:59], v[72:75], v[252:255]
    ds_read_b64_tr_b16 v[52:53], v158 offset:8192
    ds_read_b64_tr_b16 v[54:55], v158 offset:10240
    v_mfma_f32_16x16x32_bf16 v[248:251], v[56:59], v[68:71], v[248:251]
    s_waitcnt lgkmcnt(12)
    v_mfma_f32_16x16x32_bf16 v[208:211], v[28:31], v[76:79], v[208:211]
    ds_read_b64_tr_b16 v[56:57], v159 offset:8192
    ds_read_b64_tr_b16 v[58:59], v159 offset:10240
    v_mfma_f32_16x16x32_bf16 v[212:215], v[28:31], v[80:83], v[212:215]
    buffer_load_dwordx4 v[124:127], v6, s[8:11], s20 offen offset:2048 sc1
    s_waitcnt lgkmcnt(12)
    v_mfma_f32_16x16x32_bf16 v[220:223], v[32:35], v[80:83], v[220:223]
    ds_read_b64_tr_b16 v[28:29], v160 offset:8192
    ds_read_b64_tr_b16 v[30:31], v160 offset:10240
    v_mfma_f32_16x16x32_bf16 v[216:219], v[32:35], v[76:79], v[216:219]
    s_waitcnt lgkmcnt(12)
    v_mfma_f32_16x16x32_bf16 v[224:227], v[36:39], v[76:79], v[224:227]
    ds_read_b64_tr_b16 v[32:33], v161 offset:8192
    ds_read_b64_tr_b16 v[34:35], v161 offset:10240
    s_add_u32 m0, s37, 147456
    v_mfma_f32_16x16x32_bf16 v[228:231], v[36:39], v[80:83], v[228:231]
    buffer_load_dwordx4 v4, s[32:35], s22 offen offset:0 lds
    s_waitcnt lgkmcnt(12)
    v_mfma_f32_16x16x32_bf16 v[236:239], v[40:43], v[80:83], v[236:239]
    ds_read_b64_tr_b16 v[36:37], v162 offset:8192
    ds_read_b64_tr_b16 v[38:39], v162 offset:10240
    v_mfma_f32_16x16x32_bf16 v[232:235], v[40:43], v[76:79], v[232:235]
    s_waitcnt lgkmcnt(12)
    v_mfma_f32_16x16x32_bf16 v[240:243], v[44:47], v[76:79], v[240:243]
    ds_read_b64_tr_b16 v[40:41], v163 offset:8192
    ds_read_b64_tr_b16 v[42:43], v163 offset:10240
    v_mfma_f32_16x16x32_bf16 v[244:247], v[44:47], v[80:83], v[244:247]
    buffer_load_dwordx4 v[128:131], v7, s[8:11], s20 offen offset:2048 sc1
    s_waitcnt lgkmcnt(12)
    v_mfma_f32_16x16x32_bf16 v[252:255], v[48:51], v[80:83], v[252:255]
    s_waitcnt vmcnt(12) lgkmcnt(0)
    s_barrier
    ds_read_b64_tr_b16 v[44:45], v158 offset:16384
    ds_read_b64_tr_b16 v[46:47], v158 offset:18432
    v_mfma_f32_16x16x32_bf16 v[248:251], v[48:51], v[76:79], v[248:251]
    v_mfma_f32_16x16x32_bf16 v[208:211], v[52:55], v[84:87], v[208:211]
    ds_read_b64_tr_b16 v[48:49], v159 offset:16384
    ds_read_b64_tr_b16 v[50:51], v159 offset:18432
    v_mfma_f32_16x16x32_bf16 v[212:215], v[52:55], v[88:91], v[212:215]
    buffer_load_dwordx4 v[132:135], v6, s[8:11], s20 offen offset:3072 sc1
    v_mfma_f32_16x16x32_bf16 v[220:223], v[56:59], v[88:91], v[220:223]
    ds_read_b64_tr_b16 v[52:53], v160 offset:16384
    ds_read_b64_tr_b16 v[54:55], v160 offset:18432
    v_mfma_f32_16x16x32_bf16 v[216:219], v[56:59], v[84:87], v[216:219]
    v_mfma_f32_16x16x32_bf16 v[224:227], v[28:31], v[84:87], v[224:227]
    ds_read_b64_tr_b16 v[56:57], v161 offset:16384
    ds_read_b64_tr_b16 v[58:59], v161 offset:18432
    s_waitcnt vmcnt(10)
    v_mfma_f32_16x16x32_bf16 v[228:231], v[28:31], v[88:91], v[228:231]
    v_max_f32 v174, 0x21800000, v172
    buffer_load_dwordx4 v5, s[32:35], s22 offen offset:1024 lds
    s_add_u32 s22, s22, 131072
    v_mfma_f32_16x16x32_bf16 v[236:239], v[32:35], v[88:91], v[236:239]
    ds_read_b64_tr_b16 v[28:29], v162 offset:16384
    ds_read_b64_tr_b16 v[30:31], v162 offset:18432
    v_mfma_f32_16x16x32_bf16 v[232:235], v[32:35], v[84:87], v[232:235]
    v_sub_f32 v172, 1.0, v172
    v_mfma_f32_16x16x32_bf16 v[240:243], v[36:39], v[84:87], v[240:243]
    ds_read_b64_tr_b16 v[32:33], v163 offset:16384
    ds_read_b64_tr_b16 v[34:35], v163 offset:18432
    v_mfma_f32_16x16x32_bf16 v[244:247], v[36:39], v[88:91], v[244:247]
    v_cvt_pk_bf16_f32 v172, v172, v172
    buffer_load_dwordx4 v[136:139], v7, s[8:11], s20 offen offset:3072 sc1
    v_mfma_f32_16x16x32_bf16 v[252:255], v[40:43], v[88:91], v[252:255]
    ds_read_b64_tr_b16 v[36:37], v160 offset:24576
    ds_read_b64_tr_b16 v[38:39], v160 offset:26624
    v_mfma_f32_16x16x32_bf16 v[248:251], v[40:43], v[84:87], v[248:251]
    v_and_b32 v172, 0xffff0000, v172
    s_waitcnt lgkmcnt(12)
    v_mfma_f32_16x16x32_bf16 v[208:211], v[44:47], v[92:95], v[208:211]
    ds_read_b64_tr_b16 v[40:41], v161 offset:24576
    ds_read_b64_tr_b16 v[42:43], v161 offset:26624
    v_mfma_f32_16x16x32_bf16 v[212:215], v[44:47], v[96:99], v[212:215]
    v_rcp_f32 v26, v174
    s_nop 0
    s_add_u32 s20, s20, 0x1000
    buffer_load_dwordx4 v[140:143], v6, s[8:11], s20 offen offset:0 sc1
    s_waitcnt lgkmcnt(12)
    v_mfma_f32_16x16x32_bf16 v[220:223], v[48:51], v[96:99], v[220:223]
    ds_read_b64_tr_b16 v[44:45], v162 offset:24576
    ds_read_b64_tr_b16 v[46:47], v162 offset:26624
    v_mfma_f32_16x16x32_bf16 v[216:219], v[48:51], v[92:95], v[216:219]
    v_mul_f32 v172, v172, v26
    s_waitcnt lgkmcnt(12)
    v_mfma_f32_16x16x32_bf16 v[224:227], v[52:55], v[92:95], v[224:227]
    ds_read_b64_tr_b16 v[48:49], v163 offset:24576
    ds_read_b64_tr_b16 v[50:51], v163 offset:26624
    s_add_u32 m0, s37, 65536
    v_max_f32 v175, 0x21800000, v173
    v_mfma_f32_16x16x32_bf16 v[228:231], v[52:55], v[96:99], v[228:231]
    buffer_load_dwordx4 v4, s[32:35], s22 offen offset:0 lds
    s_waitcnt lgkmcnt(12)
    v_mfma_f32_16x16x32_bf16 v[236:239], v[56:59], v[96:99], v[236:239]
    ds_read_b64_tr_b16 v[52:53], v158 offset:24576
    ds_read_b64_tr_b16 v[54:55], v158 offset:26624
    v_sub_f32 v173, 1.0, v173
    v_mfma_f32_16x16x32_bf16 v[232:235], v[56:59], v[92:95], v[232:235]
    s_waitcnt lgkmcnt(12)
    v_mfma_f32_16x16x32_bf16 v[240:243], v[28:31], v[92:95], v[240:243]
    ds_read_b64_tr_b16 v[56:57], v159 offset:24576
    ds_read_b64_tr_b16 v[58:59], v159 offset:26624
    v_cvt_pk_bf16_f32 v173, v173, v173
    v_mfma_f32_16x16x32_bf16 v[244:247], v[28:31], v[96:99], v[244:247]
    buffer_load_dwordx4 v[144:147], v7, s[8:11], s20 offen offset:0 sc1
    s_waitcnt lgkmcnt(12)
    v_mfma_f32_16x16x32_bf16 v[252:255], v[32:35], v[96:99], v[252:255]
    s_waitcnt vmcnt(10) lgkmcnt(0)
    s_barrier
    ds_read_b64_tr_b16 v[28:29], v160 offset:32768
    ds_read_b64_tr_b16 v[30:31], v160 offset:34816
    v_and_b32 v173, 0xffff0000, v173
    v_mfma_f32_16x16x32_bf16 v[248:251], v[32:35], v[92:95], v[248:251]
    v_mfma_f32_16x16x32_bf16 v[224:227], v[36:39], v[100:103], v[224:227]
    ds_read_b64_tr_b16 v[32:33], v161 offset:32768
    ds_read_b64_tr_b16 v[34:35], v161 offset:34816
    v_rcp_f32 v26, v175
    s_nop 0
    v_mfma_f32_16x16x32_bf16 v[228:231], v[36:39], v[104:107], v[228:231]
    buffer_load_dwordx4 v5, s[32:35], s22 offen offset:1024 lds
    s_add_u32 s22, s22, 131072
    v_mfma_f32_16x16x32_bf16 v[236:239], v[40:43], v[104:107], v[236:239]
    ds_read_b64_tr_b16 v[36:37], v162 offset:32768
    ds_read_b64_tr_b16 v[38:39], v162 offset:34816
    v_mul_f32 v173, v173, v26
    v_mfma_f32_16x16x32_bf16 v[232:235], v[40:43], v[100:103], v[232:235]
    v_mfma_f32_16x16x32_bf16 v[240:243], v[44:47], v[100:103], v[240:243]
    ds_read_b64_tr_b16 v[40:41], v163 offset:32768
    ds_read_b64_tr_b16 v[42:43], v163 offset:34816
    v_mfma_f32_16x16x32_bf16 v[244:247], v[44:47], v[104:107], v[244:247]
    buffer_load_dwordx4 v[148:151], v6, s[8:11], s20 offen offset:1024 sc1
    v_mfma_f32_16x16x32_bf16 v[252:255], v[48:51], v[104:107], v[252:255]
    v_mul_f32 v228, v228, v173
    v_mul_f32 v229, v229, v173
    v_mul_f32 v230, v230, v173
    v_mul_f32 v231, v231, v173
    ds_read_b64_tr_b16 v[44:45], v160 offset:40960
    ds_read_b64_tr_b16 v[46:47], v160 offset:43008
    v_mfma_f32_16x16x32_bf16 v[248:251], v[48:51], v[100:103], v[248:251]
    v_mul_f32 v224, v224, v172
    v_mul_f32 v225, v225, v172
    v_mul_f32 v226, v226, v172
    v_mul_f32 v227, v227, v172
    v_mfma_f32_16x16x32_bf16 v[208:211], v[52:55], v[100:103], v[208:211]
    v_mul_f32 v232, v232, v172
    v_mul_f32 v233, v233, v172
    v_mul_f32 v234, v234, v172
    v_mul_f32 v235, v235, v172
    ds_read_b64_tr_b16 v[48:49], v161 offset:40960
    ds_read_b64_tr_b16 v[50:51], v161 offset:43008
    v_mfma_f32_16x16x32_bf16 v[212:215], v[52:55], v[104:107], v[212:215]
    v_mul_f32 v236, v236, v173
    v_mul_f32 v237, v237, v173
    v_mul_f32 v238, v238, v173
    v_mul_f32 v239, v239, v173
    buffer_load_dwordx4 v[152:155], v7, s[8:11], s20 offen offset:1024 sc1
    v_mfma_f32_16x16x32_bf16 v[220:223], v[56:59], v[104:107], v[220:223]
    v_mul_f32 v244, v244, v173
    v_mul_f32 v245, v245, v173
    v_mul_f32 v246, v246, v173
    v_mul_f32 v247, v247, v173
    ds_read_b64_tr_b16 v[52:53], v162 offset:40960
    ds_read_b64_tr_b16 v[54:55], v162 offset:43008
    v_mfma_f32_16x16x32_bf16 v[216:219], v[56:59], v[100:103], v[216:219]
    v_mul_f32 v240, v240, v172
    v_mul_f32 v241, v241, v172
    v_mul_f32 v242, v242, v172
    v_mul_f32 v243, v243, v172
    s_setprio 2
    s_waitcnt lgkmcnt(12)
    v_mfma_f32_16x16x32_bf16 v[224:227], v[28:31], v[108:111], v[224:227]
    v_mul_f32 v248, v248, v172
    v_mul_f32 v249, v249, v172
    v_mul_f32 v250, v250, v172
    v_mul_f32 v251, v251, v172
    ds_read_b64_tr_b16 v[56:57], v163 offset:40960
    ds_read_b64_tr_b16 v[58:59], v163 offset:43008
    s_add_u32 m0, s37, 81920
    v_mfma_f32_16x16x32_bf16 v[228:231], v[28:31], v[112:115], v[228:231]
    v_mul_f32 v252, v252, v173
    v_mul_f32 v253, v253, v173
    v_mul_f32 v254, v254, v173
    v_mul_f32 v255, v255, v173
    buffer_load_dwordx4 v4, s[32:35], s22 offen offset:0 lds
    s_waitcnt lgkmcnt(12)
    v_mfma_f32_16x16x32_bf16 v[236:239], v[32:35], v[112:115], v[236:239]
    v_mul_f32 v212, v212, v173
    v_mul_f32 v213, v213, v173
    v_mul_f32 v214, v214, v173
    v_mul_f32 v215, v215, v173
    s_waitcnt vmcnt(8)
    s_barrier
    ds_read_b64_tr_b16 v[28:29], v160 offset:49152
    ds_read_b64_tr_b16 v[30:31], v160 offset:51200
    v_mfma_f32_16x16x32_bf16 v[232:235], v[32:35], v[108:111], v[232:235]
    v_mul_f32 v208, v208, v172
    v_mul_f32 v209, v209, v172
    v_mul_f32 v210, v210, v172
    v_mul_f32 v211, v211, v172
    buffer_load_dwordx4 v[60:63], v6, s[8:11], s20 offen offset:2048 sc1
    s_waitcnt lgkmcnt(12)
    v_mfma_f32_16x16x32_bf16 v[240:243], v[36:39], v[108:111], v[240:243]
    v_mul_f32 v216, v216, v172
    v_mul_f32 v217, v217, v172
    v_mul_f32 v218, v218, v172
    v_mul_f32 v219, v219, v172
    ds_read_b64_tr_b16 v[32:33], v161 offset:49152
    ds_read_b64_tr_b16 v[34:35], v161 offset:51200
    v_mfma_f32_16x16x32_bf16 v[244:247], v[36:39], v[112:115], v[244:247]
    v_mul_f32 v220, v220, v173
    v_mul_f32 v221, v221, v173
    v_mul_f32 v222, v222, v173
    v_mul_f32 v223, v223, v173
    buffer_load_dwordx4 v[64:67], v7, s[8:11], s20 offen offset:2048 sc1
    s_waitcnt lgkmcnt(12)
    v_mfma_f32_16x16x32_bf16 v[252:255], v[40:43], v[112:115], v[252:255]
    v_mul_f32 v196, v196, v173
    v_mul_f32 v197, v197, v173
    v_mul_f32 v198, v198, v173
    v_mul_f32 v199, v199, v173
    ds_read_b64_tr_b16 v[36:37], v162 offset:49152
    ds_read_b64_tr_b16 v[38:39], v162 offset:51200
    v_mfma_f32_16x16x32_bf16 v[248:251], v[40:43], v[108:111], v[248:251]
    v_mul_f32 v192, v192, v172
    v_mul_f32 v193, v193, v172
    v_mul_f32 v194, v194, v172
    v_mul_f32 v195, v195, v172
    buffer_load_dwordx4 v[68:71], v6, s[8:11], s20 offen offset:3072 sc1
    s_waitcnt lgkmcnt(12)
    v_mfma_f32_16x16x32_bf16 v[224:227], v[44:47], v[116:119], v[224:227]
    v_mul_f32 v200, v200, v172
    v_mul_f32 v201, v201, v172
    v_mul_f32 v202, v202, v172
    v_mul_f32 v203, v203, v172
    ds_read_b64_tr_b16 v[40:41], v163 offset:49152
    ds_read_b64_tr_b16 v[42:43], v163 offset:51200
    v_mfma_f32_16x16x32_bf16 v[228:231], v[44:47], v[120:123], v[228:231]
    v_mul_f32 v204, v204, v173
    v_mul_f32 v205, v205, v173
    v_mul_f32 v206, v206, v173
    v_mul_f32 v207, v207, v173
    buffer_load_dwordx4 v[72:75], v7, s[8:11], s20 offen offset:3072 sc1
    s_waitcnt lgkmcnt(12)
    v_mfma_f32_16x16x32_bf16 v[236:239], v[48:51], v[120:123], v[236:239]
    ds_read_b64_tr_b16 v[44:45], v160 offset:57344
    ds_read_b64_tr_b16 v[46:47], v160 offset:59392
    v_mfma_f32_16x16x32_bf16 v[232:235], v[48:51], v[116:119], v[232:235]
    buffer_load_dwordx4 v5, s[32:35], s22 offen offset:1024 lds
    s_add_u32 s22, s22, 131072
    s_waitcnt lgkmcnt(12)
    v_mfma_f32_16x16x32_bf16 v[240:243], v[52:55], v[116:119], v[240:243]
    ds_read_b64_tr_b16 v[48:49], v161 offset:57344
    ds_read_b64_tr_b16 v[50:51], v161 offset:59392
    v_mfma_f32_16x16x32_bf16 v[244:247], v[52:55], v[120:123], v[244:247]
    s_waitcnt lgkmcnt(12)
    v_mfma_f32_16x16x32_bf16 v[252:255], v[56:59], v[120:123], v[252:255]
    ds_read_b64_tr_b16 v[52:53], v162 offset:57344
    ds_read_b64_tr_b16 v[54:55], v162 offset:59392
    v_mfma_f32_16x16x32_bf16 v[248:251], v[56:59], v[116:119], v[248:251]
    s_waitcnt lgkmcnt(12)
    v_mfma_f32_16x16x32_bf16 v[224:227], v[28:31], v[124:127], v[224:227]
    ds_read_b64_tr_b16 v[56:57], v163 offset:57344
    ds_read_b64_tr_b16 v[58:59], v163 offset:59392
    v_mfma_f32_16x16x32_bf16 v[228:231], v[28:31], v[128:131], v[228:231]
    s_waitcnt lgkmcnt(12)
    v_mfma_f32_16x16x32_bf16 v[236:239], v[32:35], v[128:131], v[236:239]
    s_waitcnt vmcnt(8)
    s_barrier
    ds_read_b64_tr_b16 v[28:29], v168 offset:0
    ds_read_b64_tr_b16 v[30:31], v168 offset:2048
    v_mfma_f32_16x16x32_bf16 v[232:235], v[32:35], v[124:127], v[232:235]
    s_waitcnt lgkmcnt(12)
    v_mfma_f32_16x16x32_bf16 v[240:243], v[36:39], v[124:127], v[240:243]
    ds_read_b64_tr_b16 v[32:33], v169 offset:0
    ds_read_b64_tr_b16 v[34:35], v169 offset:2048
    v_mfma_f32_16x16x32_bf16 v[244:247], v[36:39], v[128:131], v[244:247]
    s_waitcnt lgkmcnt(12)
    v_mfma_f32_16x16x32_bf16 v[252:255], v[40:43], v[128:131], v[252:255]
    ds_read_b64_tr_b16 v[36:37], v170 offset:0
    ds_read_b64_tr_b16 v[38:39], v170 offset:2048
    v_mfma_f32_16x16x32_bf16 v[248:251], v[40:43], v[124:127], v[248:251]
    s_waitcnt lgkmcnt(12)
    v_mfma_f32_16x16x32_bf16 v[224:227], v[44:47], v[132:135], v[224:227]
    ds_read_b64_tr_b16 v[40:41], v171 offset:0
    ds_read_b64_tr_b16 v[42:43], v171 offset:2048
    v_mfma_f32_16x16x32_bf16 v[228:231], v[44:47], v[136:139], v[228:231]
    s_waitcnt lgkmcnt(12)
    v_mfma_f32_16x16x32_bf16 v[236:239], v[48:51], v[136:139], v[236:239]
    ds_read_b64_tr_b16 v[44:45], v168 offset:8192
    ds_read_b64_tr_b16 v[46:47], v168 offset:10240
    v_mfma_f32_16x16x32_bf16 v[232:235], v[48:51], v[132:135], v[232:235]
    s_waitcnt lgkmcnt(12)
    v_mfma_f32_16x16x32_bf16 v[240:243], v[52:55], v[132:135], v[240:243]
    ds_read_b64_tr_b16 v[48:49], v169 offset:8192
    ds_read_b64_tr_b16 v[50:51], v169 offset:10240
    v_mfma_f32_16x16x32_bf16 v[244:247], v[52:55], v[136:139], v[244:247]
    s_waitcnt lgkmcnt(12)
    v_mfma_f32_16x16x32_bf16 v[252:255], v[56:59], v[136:139], v[252:255]
    ds_read_b64_tr_b16 v[52:53], v170 offset:8192
    ds_read_b64_tr_b16 v[54:55], v170 offset:10240
    v_mfma_f32_16x16x32_bf16 v[248:251], v[56:59], v[132:135], v[248:251]
    s_waitcnt lgkmcnt(12)
    v_mfma_f32_16x16x32_bf16 v[224:227], v[28:31], v[140:143], v[224:227]
    ds_read_b64_tr_b16 v[56:57], v171 offset:8192
    ds_read_b64_tr_b16 v[58:59], v171 offset:10240
    v_mfma_f32_16x16x32_bf16 v[228:231], v[28:31], v[144:147], v[228:231]
    s_waitcnt lgkmcnt(12)
    v_mfma_f32_16x16x32_bf16 v[236:239], v[32:35], v[144:147], v[236:239]
    s_waitcnt vmcnt(0)
    s_barrier
    ds_read_b64_tr_b16 v[28:29], v168 offset:16384
    ds_read_b64_tr_b16 v[30:31], v168 offset:18432
    v_mfma_f32_16x16x32_bf16 v[232:235], v[32:35], v[140:143], v[232:235]
    s_waitcnt lgkmcnt(12)
    v_mfma_f32_16x16x32_bf16 v[240:243], v[36:39], v[140:143], v[240:243]
    ds_read_b64_tr_b16 v[32:33], v169 offset:16384
    ds_read_b64_tr_b16 v[34:35], v169 offset:18432
    v_mfma_f32_16x16x32_bf16 v[244:247], v[36:39], v[144:147], v[244:247]
    s_waitcnt lgkmcnt(12)
    v_mfma_f32_16x16x32_bf16 v[252:255], v[40:43], v[144:147], v[252:255]
    ds_read_b64_tr_b16 v[36:37], v170 offset:16384
    ds_read_b64_tr_b16 v[38:39], v170 offset:18432
    v_mfma_f32_16x16x32_bf16 v[248:251], v[40:43], v[140:143], v[248:251]
    s_waitcnt lgkmcnt(12)
    v_mfma_f32_16x16x32_bf16 v[224:227], v[44:47], v[148:151], v[224:227]
    ds_read_b64_tr_b16 v[40:41], v171 offset:16384
    ds_read_b64_tr_b16 v[42:43], v171 offset:18432
    v_mfma_f32_16x16x32_bf16 v[228:231], v[44:47], v[152:155], v[228:231]
    s_waitcnt lgkmcnt(12)
    v_mfma_f32_16x16x32_bf16 v[236:239], v[48:51], v[152:155], v[236:239]
    ds_read_b64_tr_b16 v[44:45], v168 offset:24576
    ds_read_b64_tr_b16 v[46:47], v168 offset:26624
    v_mfma_f32_16x16x32_bf16 v[232:235], v[48:51], v[148:151], v[232:235]
    s_waitcnt lgkmcnt(12)
    v_mfma_f32_16x16x32_bf16 v[240:243], v[52:55], v[148:151], v[240:243]
    ds_read_b64_tr_b16 v[48:49], v169 offset:24576
    ds_read_b64_tr_b16 v[50:51], v169 offset:26624
    v_mfma_f32_16x16x32_bf16 v[244:247], v[52:55], v[152:155], v[244:247]
    s_waitcnt lgkmcnt(12)
    v_mfma_f32_16x16x32_bf16 v[252:255], v[56:59], v[152:155], v[252:255]
    ds_read_b64_tr_b16 v[52:53], v170 offset:24576
    ds_read_b64_tr_b16 v[54:55], v170 offset:26624
    v_mfma_f32_16x16x32_bf16 v[248:251], v[56:59], v[148:151], v[248:251]
    s_waitcnt lgkmcnt(12)
    v_mfma_f32_16x16x32_bf16 v[224:227], v[28:31], v[60:63], v[224:227]
    ds_read_b64_tr_b16 v[56:57], v171 offset:24576
    ds_read_b64_tr_b16 v[58:59], v171 offset:26624
    v_mfma_f32_16x16x32_bf16 v[228:231], v[28:31], v[64:67], v[228:231]
    s_waitcnt lgkmcnt(12)
    v_mfma_f32_16x16x32_bf16 v[236:239], v[32:35], v[64:67], v[236:239]
    ds_read_b64_tr_b16 v[28:29], v158 offset:32768
    ds_read_b64_tr_b16 v[30:31], v158 offset:34816
    v_mfma_f32_16x16x32_bf16 v[232:235], v[32:35], v[60:63], v[232:235]
    s_waitcnt lgkmcnt(12)
    v_mfma_f32_16x16x32_bf16 v[240:243], v[36:39], v[60:63], v[240:243]
    ds_read_b64_tr_b16 v[32:33], v159 offset:32768
    ds_read_b64_tr_b16 v[34:35], v159 offset:34816
    v_mfma_f32_16x16x32_bf16 v[244:247], v[36:39], v[64:67], v[244:247]
    s_waitcnt lgkmcnt(12)
    v_mfma_f32_16x16x32_bf16 v[252:255], v[40:43], v[64:67], v[252:255]
    ds_read_b64_tr_b16 v[36:37], v158 offset:40960
    ds_read_b64_tr_b16 v[38:39], v158 offset:43008
    v_mfma_f32_16x16x32_bf16 v[248:251], v[40:43], v[60:63], v[248:251]
    s_waitcnt lgkmcnt(12)
    v_mfma_f32_16x16x32_bf16 v[224:227], v[44:47], v[68:71], v[224:227]
    ds_read_b64_tr_b16 v[40:41], v159 offset:40960
    ds_read_b64_tr_b16 v[42:43], v159 offset:43008
    v_mfma_f32_16x16x32_bf16 v[228:231], v[44:47], v[72:75], v[228:231]
    s_waitcnt lgkmcnt(12)
    v_mfma_f32_16x16x32_bf16 v[236:239], v[48:51], v[72:75], v[236:239]
    ds_read_b64_tr_b16 v[44:45], v158 offset:49152
    ds_read_b64_tr_b16 v[46:47], v158 offset:51200
    v_mfma_f32_16x16x32_bf16 v[232:235], v[48:51], v[68:71], v[232:235]
    s_waitcnt lgkmcnt(12)
    v_mfma_f32_16x16x32_bf16 v[240:243], v[52:55], v[68:71], v[240:243]
    ds_read_b64_tr_b16 v[48:49], v159 offset:49152
    ds_read_b64_tr_b16 v[50:51], v159 offset:51200
    v_mfma_f32_16x16x32_bf16 v[244:247], v[52:55], v[72:75], v[244:247]
    s_waitcnt lgkmcnt(12)
    v_mfma_f32_16x16x32_bf16 v[252:255], v[56:59], v[72:75], v[252:255]
    ds_read_b64_tr_b16 v[52:53], v158 offset:57344
    ds_read_b64_tr_b16 v[54:55], v158 offset:59392
    v_mfma_f32_16x16x32_bf16 v[248:251], v[56:59], v[68:71], v[248:251]
    s_waitcnt lgkmcnt(12)
    v_mfma_f32_16x16x32_bf16 v[208:211], v[28:31], v[108:111], v[208:211]
    ds_read_b64_tr_b16 v[56:57], v159 offset:57344
    ds_read_b64_tr_b16 v[58:59], v159 offset:59392
    v_mfma_f32_16x16x32_bf16 v[212:215], v[28:31], v[112:115], v[212:215]
    s_waitcnt lgkmcnt(12)
    v_mfma_f32_16x16x32_bf16 v[220:223], v[32:35], v[112:115], v[220:223]
    ds_read_b64_tr_b16 v[28:29], v166 offset:0
    ds_read_b64_tr_b16 v[30:31], v166 offset:2048
    v_cvt_pk_bf16_f32 v224, v224, v225
    v_cvt_pk_bf16_f32 v225, v226, v227
    v_mfma_f32_16x16x32_bf16 v[216:219], v[32:35], v[108:111], v[216:219]
    v_cvt_pk_bf16_f32 v226, v228, v229
    v_cvt_pk_bf16_f32 v227, v230, v231
    s_waitcnt lgkmcnt(12)
    v_mfma_f32_16x16x32_bf16 v[208:211], v[36:39], v[116:119], v[208:211]
    ds_read_b64_tr_b16 v[32:33], v167 offset:0
    ds_read_b64_tr_b16 v[34:35], v167 offset:2048
    buffer_store_dwordx4 v[224:227], v2, s[24:27], s49 offen offset:0 sc1
    v_mfma_f32_16x16x32_bf16 v[212:215], v[36:39], v[120:123], v[212:215]
    s_waitcnt lgkmcnt(12)
    v_mfma_f32_16x16x32_bf16 v[220:223], v[40:43], v[120:123], v[220:223]
    ds_read_b64_tr_b16 v[36:37], v166 offset:8192
    ds_read_b64_tr_b16 v[38:39], v166 offset:10240
    v_cvt_pk_bf16_f32 v228, v232, v233
    v_cvt_pk_bf16_f32 v229, v234, v235
    v_mfma_f32_16x16x32_bf16 v[216:219], v[40:43], v[116:119], v[216:219]
    v_cvt_pk_bf16_f32 v230, v236, v237
    v_cvt_pk_bf16_f32 v231, v238, v239
    s_waitcnt lgkmcnt(12)
    v_mfma_f32_16x16x32_bf16 v[208:211], v[44:47], v[124:127], v[208:211]
    ds_read_b64_tr_b16 v[40:41], v167 offset:8192
    ds_read_b64_tr_b16 v[42:43], v167 offset:10240
    buffer_store_dwordx4 v[228:231], v2, s[24:27], s49 offen offset:1024 sc1
    v_mfma_f32_16x16x32_bf16 v[212:215], v[44:47], v[128:131], v[212:215]
    s_waitcnt lgkmcnt(12)
    v_mfma_f32_16x16x32_bf16 v[220:223], v[48:51], v[128:131], v[220:223]
    ds_read_b64_tr_b16 v[44:45], v166 offset:16384
    ds_read_b64_tr_b16 v[46:47], v166 offset:18432
    v_cvt_pk_bf16_f32 v240, v240, v241
    v_cvt_pk_bf16_f32 v241, v242, v243
    v_mfma_f32_16x16x32_bf16 v[216:219], v[48:51], v[124:127], v[216:219]
    v_cvt_pk_bf16_f32 v242, v244, v245
    v_cvt_pk_bf16_f32 v243, v246, v247
    s_waitcnt lgkmcnt(12)
    v_mfma_f32_16x16x32_bf16 v[208:211], v[52:55], v[132:135], v[208:211]
    ds_read_b64_tr_b16 v[48:49], v167 offset:16384
    ds_read_b64_tr_b16 v[50:51], v167 offset:18432
    buffer_store_dwordx4 v[240:243], v2, s[24:27], s50 offen offset:0 sc1
    v_mfma_f32_16x16x32_bf16 v[212:215], v[52:55], v[136:139], v[212:215]
    s_waitcnt lgkmcnt(12)
    v_mfma_f32_16x16x32_bf16 v[220:223], v[56:59], v[136:139], v[220:223]
    ds_read_b64_tr_b16 v[52:53], v166 offset:24576
    ds_read_b64_tr_b16 v[54:55], v166 offset:26624
    v_cvt_pk_bf16_f32 v244, v248, v249
    v_cvt_pk_bf16_f32 v245, v250, v251
    v_mfma_f32_16x16x32_bf16 v[216:219], v[56:59], v[132:135], v[216:219]
    v_cvt_pk_bf16_f32 v246, v252, v253
    v_cvt_pk_bf16_f32 v247, v254, v255
    s_waitcnt lgkmcnt(12)
    v_mfma_f32_16x16x32_bf16 v[208:211], v[28:31], v[140:143], v[208:211]
    ds_read_b64_tr_b16 v[56:57], v167 offset:24576
    ds_read_b64_tr_b16 v[58:59], v167 offset:26624
    buffer_store_dwordx4 v[244:247], v2, s[24:27], s50 offen offset:1024 sc1
    v_mfma_f32_16x16x32_bf16 v[212:215], v[28:31], v[144:147], v[212:215]
    s_setprio 1
    s_waitcnt lgkmcnt(12)
    v_mfma_f32_16x16x32_bf16 v[220:223], v[32:35], v[144:147], v[220:223]
    ds_read_b64_tr_b16 v[28:29], v156 offset:32768
    ds_read_b64_tr_b16 v[30:31], v156 offset:34816
    v_mfma_f32_16x16x32_bf16 v[216:219], v[32:35], v[140:143], v[216:219]
    s_waitcnt lgkmcnt(12)
    v_mfma_f32_16x16x32_bf16 v[208:211], v[36:39], v[148:151], v[208:211]
    ds_read_b64_tr_b16 v[32:33], v157 offset:32768
    ds_read_b64_tr_b16 v[34:35], v157 offset:34816
    v_mfma_f32_16x16x32_bf16 v[212:215], v[36:39], v[152:155], v[212:215]
    s_waitcnt lgkmcnt(12)
    v_mfma_f32_16x16x32_bf16 v[220:223], v[40:43], v[152:155], v[220:223]
    ds_read_b64_tr_b16 v[36:37], v156 offset:40960
    ds_read_b64_tr_b16 v[38:39], v156 offset:43008
    v_mfma_f32_16x16x32_bf16 v[216:219], v[40:43], v[148:151], v[216:219]
    s_getreg_b32 s101, hwreg(HW_REG_IB_STS)
    s_and_b32 s101, s101, 0xc0000f
    s_or_b32 s101, s101, s100
    s_cmp_le_u32 s101, 0
    s_cbranch_scc1 LG_s24
LG_r24:
    s_waitcnt lgkmcnt(12)
    v_mfma_f32_16x16x32_bf16 v[208:211], v[44:47], v[60:63], v[208:211]
    ds_read_b64_tr_b16 v[40:41], v157 offset:40960
    ds_read_b64_tr_b16 v[42:43], v157 offset:43008
    v_mfma_f32_16x16x32_bf16 v[212:215], v[44:47], v[64:67], v[212:215]
    s_waitcnt lgkmcnt(12)
    v_mfma_f32_16x16x32_bf16 v[220:223], v[48:51], v[64:67], v[220:223]
    ds_read_b64_tr_b16 v[44:45], v156 offset:49152
    ds_read_b64_tr_b16 v[46:47], v156 offset:51200
    v_mfma_f32_16x16x32_bf16 v[216:219], v[48:51], v[60:63], v[216:219]
    s_waitcnt lgkmcnt(12)
    v_mfma_f32_16x16x32_bf16 v[208:211], v[52:55], v[68:71], v[208:211]
    ds_read_b64_tr_b16 v[48:49], v157 offset:49152
    ds_read_b64_tr_b16 v[50:51], v157 offset:51200
    v_mfma_f32_16x16x32_bf16 v[212:215], v[52:55], v[72:75], v[212:215]
    s_waitcnt lgkmcnt(12)
    v_mfma_f32_16x16x32_bf16 v[220:223], v[56:59], v[72:75], v[220:223]
    ds_read_b64_tr_b16 v[52:53], v156 offset:57344
    ds_read_b64_tr_b16 v[54:55], v156 offset:59392
    v_mfma_f32_16x16x32_bf16 v[216:219], v[56:59], v[68:71], v[216:219]
    s_getreg_b32 s101, hwreg(HW_REG_IB_STS)
    s_and_b32 s101, s101, 0xc0000f
    s_or_b32 s101, s101, s100
    s_cmp_le_u32 s101, 0
    s_cbranch_scc1 LG_s25
LG_r25:
    s_waitcnt lgkmcnt(12)
    v_mfma_f32_16x16x32_bf16 v[192:195], v[28:31], v[108:111], v[192:195]
    ds_read_b64_tr_b16 v[56:57], v157 offset:57344
    ds_read_b64_tr_b16 v[58:59], v157 offset:59392
    v_mfma_f32_16x16x32_bf16 v[196:199], v[28:31], v[112:115], v[196:199]
    s_waitcnt lgkmcnt(12)
    v_mfma_f32_16x16x32_bf16 v[204:207], v[32:35], v[112:115], v[204:207]
    ds_read_b64_tr_b16 v[28:29], v164 offset:0
    ds_read_b64_tr_b16 v[30:31], v164 offset:2048
    v_cvt_pk_bf16_f32 v208, v208, v209
    v_cvt_pk_bf16_f32 v209, v210, v211
    v_mfma_f32_16x16x32_bf16 v[200:203], v[32:35], v[108:111], v[200:203]
    v_cvt_pk_bf16_f32 v210, v212, v213
    v_cvt_pk_bf16_f32 v211, v214, v215
    s_waitcnt lgkmcnt(12)
    v_mfma_f32_16x16x32_bf16 v[192:195], v[36:39], v[116:119], v[192:195]
    ds_read_b64_tr_b16 v[32:33], v165 offset:0
    ds_read_b64_tr_b16 v[34:35], v165 offset:2048
    buffer_store_dwordx4 v[208:211], v2, s[24:27], s48 offen offset:0 sc1
    v_mfma_f32_16x16x32_bf16 v[196:199], v[36:39], v[120:123], v[196:199]
    s_waitcnt lgkmcnt(12)
    v_mfma_f32_16x16x32_bf16 v[204:207], v[40:43], v[120:123], v[204:207]
    ds_read_b64_tr_b16 v[36:37], v164 offset:8192
    ds_read_b64_tr_b16 v[38:39], v164 offset:10240
    v_cvt_pk_bf16_f32 v212, v216, v217
    v_cvt_pk_bf16_f32 v213, v218, v219
    v_mfma_f32_16x16x32_bf16 v[200:203], v[40:43], v[116:119], v[200:203]
    v_cvt_pk_bf16_f32 v214, v220, v221
    v_cvt_pk_bf16_f32 v215, v222, v223
    s_getreg_b32 s101, hwreg(HW_REG_IB_STS)
    s_and_b32 s101, s101, 0xc0000f
    s_or_b32 s101, s101, s100
    s_cmp_le_u32 s101, 1
    s_cbranch_scc1 LG_s26
LG_r26:
    s_waitcnt lgkmcnt(12)
    v_mfma_f32_16x16x32_bf16 v[192:195], v[44:47], v[124:127], v[192:195]
    ds_read_b64_tr_b16 v[40:41], v165 offset:8192
    ds_read_b64_tr_b16 v[42:43], v165 offset:10240
    buffer_store_dwordx4 v[212:215], v2, s[24:27], s48 offen offset:1024 sc1
    v_mfma_f32_16x16x32_bf16 v[196:199], v[44:47], v[128:131], v[196:199]
    s_setprio 0
    s_waitcnt lgkmcnt(12)
    v_mfma_f32_16x16x32_bf16 v[204:207], v[48:51], v[128:131], v[204:207]
    ds_read_b64_tr_b16 v[44:45], v164 offset:16384
    ds_read_b64_tr_b16 v[46:47], v164 offset:18432
    v_mfma_f32_16x16x32_bf16 v[200:203], v[48:51], v[124:127], v[200:203]
    s_waitcnt lgkmcnt(12)
    v_mfma_f32_16x16x32_bf16 v[192:195], v[52:55], v[132:135], v[192:195]
    ds_read_b64_tr_b16 v[48:49], v165 offset:16384
    ds_read_b64_tr_b16 v[50:51], v165 offset:18432
    v_mfma_f32_16x16x32_bf16 v[196:199], v[52:55], v[136:139], v[196:199]
    s_waitcnt lgkmcnt(12)
    v_mfma_f32_16x16x32_bf16 v[204:207], v[56:59], v[136:139], v[204:207]
    ds_read_b64_tr_b16 v[52:53], v164 offset:24576
    ds_read_b64_tr_b16 v[54:55], v164 offset:26624
    v_mfma_f32_16x16x32_bf16 v[200:203], v[56:59], v[132:135], v[200:203]
    s_getreg_b32 s101, hwreg(HW_REG_IB_STS)
    s_and_b32 s101, s101, 0xc0000f
    s_or_b32 s101, s101, s100
    s_cmp_le_u32 s101, 2
    s_cbranch_scc1 LG_s27
LG_r27:
    s_waitcnt lgkmcnt(12)
    v_mfma_f32_16x16x32_bf16 v[192:195], v[28:31], v[140:143], v[192:195]
    ds_read_b64_tr_b16 v[56:57], v165 offset:24576
    ds_read_b64_tr_b16 v[58:59], v165 offset:26624
    v_mfma_f32_16x16x32_bf16 v[196:199], v[28:31], v[144:147], v[196:199]
    s_waitcnt lgkmcnt(12)
    v_mfma_f32_16x16x32_bf16 v[204:207], v[32:35], v[144:147], v[204:207]
    ds_read_b64_tr_b16 v[28:29], v156 offset:0
    ds_read_b64_tr_b16 v[30:31], v156 offset:2048
    v_mfma_f32_16x16x32_bf16 v[200:203], v[32:35], v[140:143], v[200:203]
    s_getreg_b32 s101, hwreg(HW_REG_IB_STS)
    s_and_b32 s101, s101, 0xc0000f
    s_or_b32 s101, s101, s55
    s_cmp_le_u32 s101, 0
    s_cbranch_scc1 LG_s28
LG_r28:
    buffer_load_dword v16, v23, s[24:27], s62 offen offset:384 sc1
    s_waitcnt lgkmcnt(12)
    v_mfma_f32_16x16x32_bf16 v[192:195], v[36:39], v[148:151], v[192:195]
    ds_read_b64_tr_b16 v[32:33], v157 offset:0
    ds_read_b64_tr_b16 v[34:35], v157 offset:2048
    v_mfma_f32_16x16x32_bf16 v[196:199], v[36:39], v[152:155], v[196:199]
    s_waitcnt lgkmcnt(12)
    v_mfma_f32_16x16x32_bf16 v[204:207], v[40:43], v[152:155], v[204:207]
    ds_read_b64_tr_b16 v[36:37], v156 offset:8192
    ds_read_b64_tr_b16 v[38:39], v156 offset:10240
    v_mfma_f32_16x16x32_bf16 v[200:203], v[40:43], v[148:151], v[200:203]
    s_getreg_b32 s101, hwreg(HW_REG_IB_STS)
    s_and_b32 s101, s101, 0xc0000f
    s_or_b32 s101, s101, s100
    s_cmp_le_u32 s101, 3
    s_cbranch_scc1 LG_s29
LG_r29:
    s_waitcnt lgkmcnt(12)
    v_mfma_f32_16x16x32_bf16 v[192:195], v[44:47], v[60:63], v[192:195]
    ds_read_b64_tr_b16 v[40:41], v157 offset:8192
    ds_read_b64_tr_b16 v[42:43], v157 offset:10240
    v_mfma_f32_16x16x32_bf16 v[196:199], v[44:47], v[64:67], v[196:199]
    s_waitcnt lgkmcnt(12)
    v_mfma_f32_16x16x32_bf16 v[204:207], v[48:51], v[64:67], v[204:207]
    ds_read_b64_tr_b16 v[44:45], v156 offset:16384
    ds_read_b64_tr_b16 v[46:47], v156 offset:18432
    v_mfma_f32_16x16x32_bf16 v[200:203], v[48:51], v[60:63], v[200:203]
    s_getreg_b32 s101, hwreg(HW_REG_IB_STS)
    s_and_b32 s101, s101, 0xc0000f
    s_or_b32 s101, s101, s55
    s_cmp_le_u32 s101, 1
    s_cbranch_scc1 LG_s30
LG_r30:
    s_waitcnt lgkmcnt(12)
    v_mfma_f32_16x16x32_bf16 v[192:195], v[52:55], v[68:71], v[192:195]
    ds_read_b64_tr_b16 v[48:49], v157 offset:16384
    ds_read_b64_tr_b16 v[50:51], v157 offset:18432
    v_mfma_f32_16x16x32_bf16 v[196:199], v[52:55], v[72:75], v[196:199]
    s_waitcnt lgkmcnt(12)
    v_mfma_f32_16x16x32_bf16 v[204:207], v[56:59], v[72:75], v[204:207]
    ds_read_b64_tr_b16 v[52:53], v156 offset:24576
    ds_read_b64_tr_b16 v[54:55], v156 offset:26624
    v_mfma_f32_16x16x32_bf16 v[200:203], v[56:59], v[68:71], v[200:203]
    s_getreg_b32 s101, hwreg(HW_REG_IB_STS)
    s_and_b32 s101, s101, 0xc0000f
    s_or_b32 s101, s101, s100
    s_cmp_le_u32 s101, 3
    s_cbranch_scc1 LG_s31
LG_r31:
    s_waitcnt lgkmcnt(12)
    v_mfma_f32_16x16x32_bf16 v[176:179], v[28:31], v[76:79], 0
    ds_read_b64_tr_b16 v[56:57], v157 offset:24576
    ds_read_b64_tr_b16 v[58:59], v157 offset:26624
    v_mfma_f32_16x16x32_bf16 v[180:183], v[28:31], v[80:83], 0
    s_waitcnt vmcnt(0)
    s_cmp_eq_u32 s100, 0
    s_cbranch_scc1 LG_s32
LG_r32:
    s_cmp_eq_u32 s55, 0
    s_cbranch_scc1 LG_s33
LG_r33:
    v_cmp_eq_u32 vcc, 1, v16
    s_nop 1
    s_mov_b32 s57, vcc_lo
    s_andn2_b32 s57, s57, s61
    s_and_b32 s57, s57, 15
    s_or_b32 s61, s61, s57
    s_bitcmp1_b32 s57, 1
    s_cbranch_scc0 LC_rn10e
    s_add_u32 s56, s51, 16384
    buffer_load_dwordx4 v[216:219], v2, s[24:27], s56 offen offset:0 sc1
    buffer_load_dwordx4 v[220:223], v2, s[24:27], s56 offen offset:1024 sc1
LC_rn10e:
    s_bitcmp1_b32 s57, 2
    s_cbranch_scc0 LC_rn20e
    s_add_u32 s56, s51, 32768
    buffer_load_dwordx4 v[232:235], v2, s[24:27], s56 offen offset:0 sc1
    buffer_load_dwordx4 v[236:239], v2, s[24:27], s56 offen offset:1024 sc1
LC_rn20e:
    s_bitcmp1_b32 s57, 3
    s_cbranch_scc0 LC_rn30e
    s_add_u32 s56, s51, 49152
    buffer_load_dwordx4 v[248:251], v2, s[24:27], s56 offen offset:0 sc1
    buffer_load_dwordx4 v[252:255], v2, s[24:27], s56 offen offset:1024 sc1
LC_rn30e:
    s_waitcnt lgkmcnt(12)
    v_mfma_f32_16x16x32_bf16 v[188:191], v[32:35], v[80:83], 0
    v_mfma_f32_16x16x32_bf16 v[184:187], v[32:35], v[76:79], 0
    s_waitcnt lgkmcnt(10)
    v_mfma_f32_16x16x32_bf16 v[176:179], v[36:39], v[84:87], v[176:179]
    v_mfma_f32_16x16x32_bf16 v[180:183], v[36:39], v[88:91], v[180:183]
    s_waitcnt lgkmcnt(8)
    v_mfma_f32_16x16x32_bf16 v[188:191], v[40:43], v[88:91], v[188:191]
    v_mfma_f32_16x16x32_bf16 v[184:187], v[40:43], v[84:87], v[184:187]
    s_waitcnt lgkmcnt(6)
    v_mfma_f32_16x16x32_bf16 v[176:179], v[44:47], v[92:95], v[176:179]
    v_mfma_f32_16x16x32_bf16 v[180:183], v[44:47], v[96:99], v[180:183]
    s_waitcnt lgkmcnt(4)
    v_mfma_f32_16x16x32_bf16 v[188:191], v[48:51], v[96:99], v[188:191]
    v_mfma_f32_16x16x32_bf16 v[184:187], v[48:51], v[92:95], v[184:187]
    s_waitcnt lgkmcnt(2)
    v_mfma_f32_16x16x32_bf16 v[176:179], v[52:55], v[100:103], v[176:179]
    v_mfma_f32_16x16x32_bf16 v[180:183], v[52:55], v[104:107], v[180:183]
    s_waitcnt lgkmcnt(0)
    v_mfma_f32_16x16x32_bf16 v[188:191], v[56:59], v[104:107], v[188:191]
    v_mfma_f32_16x16x32_bf16 v[184:187], v[56:59], v[100:103], v[184:187]
    buffer_load_dword v16, v23, s[24:27], s62 offen offset:384 sc1
LC_done:
    s_mov_b32 s59, 0x8000
    v_mov_b32 v30, 0x3f80
    v_mov_b32 v31, 0x3f800000
    s_nop 4
    v_fmac_f32 v192, v172, v176
    v_fmac_f32 v193, v172, v177
    v_fmac_f32 v194, v172, v178
    v_fmac_f32 v195, v172, v179
    v_fmac_f32 v196, v173, v180
    v_fmac_f32 v197, v173, v181
    v_fmac_f32 v198, v173, v182
    v_fmac_f32 v199, v173, v183
    v_fmac_f32 v200, v172, v184
    v_fmac_f32 v201, v172, v185
    v_fmac_f32 v202, v172, v186
    v_fmac_f32 v203, v172, v187
    v_fmac_f32 v204, v173, v188
    v_fmac_f32 v205, v173, v189
    v_fmac_f32 v206, v173, v190
    v_fmac_f32 v207, v173, v191
LC_rl:
    s_waitcnt vmcnt(0)
    v_cmp_eq_u32 vcc, 1, v16
    s_sub_u32 s59, s59, 1
    s_cselect_b32 s57, 15, 0
    s_or_b32 s57, s57, vcc_lo
    s_andn2_b32 s57, s57, s61
    s_and_b32 s57, s57, 15
    s_or_b32 s61, s61, s57
    s_bitcmp1_b32 s57, 1
    s_cbranch_scc0 LC_rn1x
    s_add_u32 s56, s51, 16384
    buffer_load_dwordx4 v[216:219], v2, s[24:27], s56 offen offset:0 sc1
    buffer_load_dwordx4 v[220:223], v2, s[24:27], s56 offen offset:1024 sc1
LC_rn1x:
    s_bitcmp1_b32 s57, 2
    s_cbranch_scc0 LC_rn2x
    s_add_u32 s56, s51, 32768
    buffer_load_dwordx4 v[232:235], v2, s[24:27], s56 offen offset:0 sc1
    buffer_load_dwordx4 v[236:239], v2, s[24:27], s56 offen offset:1024 sc1
LC_rn2x:
    s_bitcmp1_b32 s57, 3
    s_cbranch_scc0 LC_rn3x
    s_add_u32 s56, s51, 49152
    buffer_load_dwordx4 v[248:251], v2, s[24:27], s56 offen offset:0 sc1
    buffer_load_dwordx4 v[252:255], v2, s[24:27], s56 offen offset:1024 sc1
LC_rn3x:
    s_cmp_eq_u32 s61, 15
    s_cbranch_scc1 LC_rd
    s_sleep 1
    buffer_load_dword v16, v23, s[24:27], s62 offen offset:384 sc1
    s_branch LC_rl
LC_rd:
    s_waitcnt vmcnt(0)
    v_dot2_f32_bf16 v192, v232, v30, v192
    v_dot2_f32_bf16 v193, v232, v31, v193
    v_dot2_f32_bf16 v194, v233, v30, v194
    v_dot2_f32_bf16 v195, v233, v31, v195
    v_dot2_f32_bf16 v196, v234, v30, v196
    v_dot2_f32_bf16 v197, v234, v31, v197
    v_dot2_f32_bf16 v198, v235, v30, v198
    v_dot2_f32_bf16 v199, v235, v31, v199
    v_dot2_f32_bf16 v200, v236, v30, v200
    v_dot2_f32_bf16 v201, v236, v31, v201
    v_dot2_f32_bf16 v202, v237, v30, v202
    v_dot2_f32_bf16 v203, v237, v31, v203
    v_dot2_f32_bf16 v204, v238, v30, v204
    v_dot2_f32_bf16 v205, v238, v31, v205
    v_dot2_f32_bf16 v206, v239, v30, v206
    v_dot2_f32_bf16 v207, v239, v31, v207
    v_dot2_f32_bf16 v192, v248, v30, v192
    v_dot2_f32_bf16 v193, v248, v31, v193
    v_dot2_f32_bf16 v194, v249, v30, v194
    v_dot2_f32_bf16 v195, v249, v31, v195
    v_dot2_f32_bf16 v196, v250, v30, v196
    v_dot2_f32_bf16 v197, v250, v31, v197
    v_dot2_f32_bf16 v198, v251, v30, v198
    v_dot2_f32_bf16 v199, v251, v31, v199
    v_dot2_f32_bf16 v200, v252, v30, v200
    v_dot2_f32_bf16 v201, v252, v31, v201
    v_dot2_f32_bf16 v202, v253, v30, v202
    v_dot2_f32_bf16 v203, v253, v31, v203
    v_dot2_f32_bf16 v204, v254, v30, v204
    v_dot2_f32_bf16 v205, v254, v31, v205
    v_dot2_f32_bf16 v206, v255, v30, v206
    v_dot2_f32_bf16 v207, v255, v31, v207
    v_dot2_f32_bf16 v192, v216, v30, v192
    v_dot2_f32_bf16 v193, v216, v31, v193
    v_dot2_f32_bf16 v194, v217, v30, v194
    v_dot2_f32_bf16 v195, v217, v31, v195
    v_dot2_f32_bf16 v196, v218, v30, v196
    v_dot2_f32_bf16 v197, v218, v31, v197
    v_dot2_f32_bf16 v198, v219, v30, v198
    v_dot2_f32_bf16 v199, v219, v31, v199
    v_dot2_f32_bf16 v200, v220, v30, v200
    v_dot2_f32_bf16 v201, v220, v31, v201
    v_dot2_f32_bf16 v202, v221, v30, v202
    v_dot2_f32_bf16 v203, v221, v31, v203
    v_dot2_f32_bf16 v204, v222, v30, v204
    v_dot2_f32_bf16 v205, v222, v31, v205
    v_dot2_f32_bf16 v206, v223, v30, v206
    v_dot2_f32_bf16 v207, v223, v31, v207
    s_nop 2
    v_mul_f32 v192, v174, v192
    v_mul_f32 v200, v174, v200
    v_mul_f32 v193, v174, v193
    v_mul_f32 v201, v174, v201
    v_mul_f32 v194, v174, v194
    v_mul_f32 v202, v174, v202
    v_mul_f32 v195, v174, v195
    v_mul_f32 v203, v174, v203
    v_cvt_pk_bf16_f32 v176, v192, v193
    v_cvt_pk_bf16_f32 v177, v194, v195
    v_cvt_pk_bf16_f32 v178, v200, v201
    v_cvt_pk_bf16_f32 v179, v202, v203
    s_nop 1
    v_permlane16_swap_b32 v176, v178
    v_permlane16_swap_b32 v177, v179
    buffer_store_dwordx4 v[176:179], v24, s[16:19], s52 offen nt
    v_mul_f32 v196, v175, v196
    v_mul_f32 v204, v175, v204
    v_mul_f32 v197, v175, v197
    v_mul_f32 v205, v175, v205
    v_mul_f32 v198, v175, v198
    v_mul_f32 v206, v175, v206
    v_mul_f32 v199, v175, v199
    v_mul_f32 v207, v175, v207
    v_cvt_pk_bf16_f32 v180, v196, v197
    v_cvt_pk_bf16_f32 v181, v198, v199
    v_cvt_pk_bf16_f32 v182, v204, v205
    v_cvt_pk_bf16_f32 v183, v206, v207
    s_nop 1
    v_permlane16_swap_b32 v180, v182
    v_permlane16_swap_b32 v181, v183
    buffer_store_dwordx4 v[180:183], v24, s[16:19], s39 offen nt
LC_fin:
L_end:
    s_endpgm
LA_h1_0:
    s_cmp_lg_u32 s49, 7
    s_cbranch_scc1 LA_n7_0
    s_cmp_lg_u32 s3, 0
    s_cbranch_scc1 LA_loop0
    v_mov_b32 v28, 0
    v_mov_b32 v29, 0
    v_mov_b32 v30, 0
    v_mov_b32 v31, 0
    v_mov_b32 v26, 163832
    ds_write_b32 v26, v28
    s_lshl_b32 s56, s53, 9
    s_add_u32 s56, s56, 0x2c10000
    s_mov_b32 exec_hi, 0
    buffer_store_dwordx4 v[28:31], v2, s[24:27], s56 offen sc1
    s_mov_b64 exec, -1
    s_branch LA_loop0
LA_n7_0:
    s_cmp_lg_u32 s49, 6
    s_cbranch_scc1 LA_n6_0
    s_cmp_lg_u32 s3, 0
    s_cbranch_scc1 LA_loop0
    s_lshr_b32 s56, s2, 3
    s_mul_i32 s56, s56, 3
    s_lshr_b32 s56, s56, 5
    s_cmp_lg_u32 s56, 0
    s_cbranch_scc1 LA_loop0
    v_mov_b32 v26, 1
    s_and_b32 s56, s53, 1
    s_lshl_b32 s56, s56, 7
    s_mov_b64 exec, 1
    buffer_atomic_add v26, off, s[28:31], s56 sc1
    s_mov_b64 exec, -1
    s_branch LA_loop0
LA_n6_0:
    s_cmp_lg_u32 s49, 5
    s_cbranch_scc1 LA_n5_0
    s_cmp_lg_u32 s3, 0
    s_cbranch_scc1 LA_loop0
    s_lshr_b32 s56, s2, 3
    s_mul_i32 s56, s56, 3
    s_lshr_b32 s56, s56, 5
    s_cmp_lg_u32 s56, 1
    s_cbranch_scc1 LA_loop0
    v_mov_b32 v26, 1
    s_and_b32 s56, s53, 1
    s_lshl_b32 s56, s56, 7
    s_mov_b64 exec, 1
    buffer_atomic_add v26, off, s[28:31], s56 sc1
    s_mov_b64 exec, -1
    s_branch LA_loop0
LA_n5_0:
    s_cmp_lg_u32 s49, 4
    s_cbranch_scc1 LA_n4_0
    s_cmp_lg_u32 s3, 0
    s_cbranch_scc1 LA_loop0
    s_lshr_b32 s56, s2, 3
    s_mul_i32 s56, s56, 3
    s_lshr_b32 s56, s56, 5
    s_cmp_lg_u32 s56, 2
    s_cbranch_scc1 LA_loop0
    v_mov_b32 v26, 1
    s_and_b32 s56, s53, 1
    s_lshl_b32 s56, s56, 7
    s_mov_b64 exec, 1
    buffer_atomic_add v26, off, s[28:31], s56 sc1
    s_mov_b64 exec, -1
    s_branch LA_loop0
LA_n4_0:
    s_cmp_lg_u32 s49, 2
    s_cbranch_scc1 LA_n2_0
    v_and_b32 v37, 1, v1
    v_lshlrev_b32 v37, 7, v37
    buffer_load_dword v19, v37, s[28:31], 0 offen sc1
    s_branch LA_loop0
LA_n2_0:
    s_cmp_lg_u32 s49, 3
    s_cbranch_scc1 LA_n3_0
    s_cmp_lg_u32 s3, 0
    s_cbranch_scc1 LA_loop0
    s_getpc_b64 s[56:57]
LA_pc:
    s_sub_u32 s56, s56, LA_pc-gated_mix__sliding_block__swiglu_ffn__prompt_kernel
    s_subb_u32 s57, s57, 0
    s_lshr_b32 s58, s2, 3
    s_lshl_b32 s58, s58, 12
    v_and_b32 v26, 31, v1
    v_lshlrev_b32 v26, 7, v26
    v_add_u32 v26, s58, v26
    v_min_u32 v26, LZ_end-gated_mix__sliding_block__swiglu_ffn__prompt_kernel-4, v26
    v_mov_b32 v27, s57
    v_add_co_u32 v26, vcc, s56, v26
    s_nop 1
    v_addc_co_u32 v27, vcc, 0, v27, vcc
    global_load_dword v18, v[26:27], off
    s_branch LA_loop0
LA_n3_0:
    s_branch LA_loop0
LA_slow0:
    s_mov_b32 s59, 0x8000
LA_spin0:
    v_and_b32 v37, 1, v1
    v_lshlrev_b32 v37, 7, v37
    buffer_load_dword v19, v37, s[28:31], 0 offen sc1
    s_waitcnt vmcnt(0)
    v_cmp_gt_u32 vcc, 128, v19
    s_nop 1
    s_cmp_eq_u64 vcc, 0
    s_cbranch_scc1 LA_spin0_ok
    s_sub_u32 s59, s59, 1
    s_cbranch_scc1 LA_spin0_ok
    s_sleep 2
    s_branch LA_spin0
LA_spin0_ok:
    s_branch LB_go0
LA_h1_1:
    s_cmp_lg_u32 s49, 2
    s_cbranch_scc1 LA_n2_1
    v_and_b32 v37, 1, v1
    v_lshlrev_b32 v37, 7, v37
    buffer_load_dword v19, v37, s[28:31], 0 offen sc1
    s_branch LA_loop1
LA_n2_1:
    s_branch LA_loop1
LA_slow1:
    s_mov_b32 s59, 0x8000
LA_spin1:
    v_and_b32 v37, 1, v1
    v_lshlrev_b32 v37, 7, v37
    buffer_load_dword v19, v37, s[28:31], 0 offen sc1
    s_waitcnt vmcnt(0)
    v_cmp_gt_u32 vcc, 128, v19
    s_nop 1
    s_cmp_eq_u64 vcc, 0
    s_cbranch_scc1 LA_spin1_ok
    s_sub_u32 s59, s59, 1
    s_cbranch_scc1 LA_spin1_ok
    s_sleep 2
    s_branch LA_spin1
LA_spin1_ok:
    s_branch LB_go1
LB_exact:
    s_nop 15
    s_waitcnt lgkmcnt(0)
    ds_read_b128 v[40:43], v8 offset:0
    ds_read_b128 v[44:47], v8 offset:512
    ds_read_b128 v[48:51], v8 offset:32768
    ds_read_b128 v[52:55], v8 offset:33280
    ds_read_b128 v[56:59], v8 offset:4096
    ds_read_b128 v[60:63], v8 offset:4608
    ds_read_b128 v[64:67], v8 offset:8192
    ds_read_b128 v[68:71], v8 offset:8704
    ds_read_b128 v[96:99], v8 offset:12288
    ds_read_b128 v[100:103], v8 offset:12800
    ds_read_b128 v[104:107], v8 offset:16384
    ds_read_b128 v[108:111], v8 offset:16896
    s_waitcnt lgkmcnt(10)
    s_cmp_le_u32 s58, 0
    s_cbranch_scc1 LB_v0
    v_mov_b32 v112, 0xf1800000
    v_mov_b32 v113, 0xf1800000
    v_mov_b32 v114, 0xf1800000
    v_mov_b32 v115, 0xf1800000
    v_mov_b32 v116, 0xf1800000
    v_mov_b32 v117, 0xf1800000
    v_mov_b32 v118, 0xf1800000
    v_mov_b32 v119, 0xf1800000
    v_mov_b32 v120, 0xf1800000
    v_mov_b32 v121, 0xf1800000
    v_mov_b32 v122, 0xf1800000
    v_mov_b32 v123, 0xf1800000
    v_mov_b32 v124, 0xf1800000
    v_mov_b32 v125, 0xf1800000
    v_mov_b32 v126, 0xf1800000
    v_mov_b32 v127, 0xf1800000
    s_branch LB_w0
LB_v0:
    v_mfma_f32_32x32x16_bf16 v[112:127], v[40:43], v[32:35], 0
    v_mfma_f32_32x32x16_bf16 v[112:127], v[44:47], v[36:39], v[112:127]
LB_w0:
    ds_read_b128 v[40:43], v8 offset:20480
    ds_read_b128 v[44:47], v8 offset:20992
    s_waitcnt lgkmcnt(10)
    v_mfma_f32_32x32x16_bf16 v[240:255], v[48:51], v[32:35], 0
    v_mfma_f32_32x32x16_bf16 v[240:255], v[52:55], v[36:39], v[240:255]
    ds_read_b128 v[48:51], v8 offset:24576
    ds_read_b128 v[52:55], v8 offset:25088
    s_waitcnt lgkmcnt(10)
    s_cmp_le_u32 s58, 1
    s_cbranch_scc1 LB_v1
    v_mov_b32 v128, 0xf1800000
    v_mov_b32 v129, 0xf1800000
    v_mov_b32 v130, 0xf1800000
    v_mov_b32 v131, 0xf1800000
    v_mov_b32 v132, 0xf1800000
    v_mov_b32 v133, 0xf1800000
    v_mov_b32 v134, 0xf1800000
    v_mov_b32 v135, 0xf1800000
    v_mov_b32 v136, 0xf1800000
    v_mov_b32 v137, 0xf1800000
    v_mov_b32 v138, 0xf1800000
    v_mov_b32 v139, 0xf1800000
    v_mov_b32 v140, 0xf1800000
    v_mov_b32 v141, 0xf1800000
    v_mov_b32 v142, 0xf1800000
    v_mov_b32 v143, 0xf1800000
    s_branch LB_w1
LB_v1:
    v_mfma_f32_32x32x16_bf16 v[128:143], v[56:59], v[32:35], 0
    v_mfma_f32_32x32x16_bf16 v[128:143], v[60:63], v[36:39], v[128:143]
LB_w1:
    ds_read_b128 v[56:59], v8 offset:28672
    ds_read_b128 v[60:63], v8 offset:29184
    s_waitcnt lgkmcnt(10)
    s_cmp_le_u32 s58, 2
    s_cbranch_scc1 LB_v2
    v_mov_b32 v144, 0xf1800000
    v_mov_b32 v145, 0xf1800000
    v_mov_b32 v146, 0xf1800000
    v_mov_b32 v147, 0xf1800000
    v_mov_b32 v148, 0xf1800000
    v_mov_b32 v149, 0xf1800000
    v_mov_b32 v150, 0xf1800000
    v_mov_b32 v151, 0xf1800000
    v_mov_b32 v152, 0xf1800000
    v_mov_b32 v153, 0xf1800000
    v_mov_b32 v154, 0xf1800000
    v_mov_b32 v155, 0xf1800000
    v_mov_b32 v156, 0xf1800000
    v_mov_b32 v157, 0xf1800000
    v_mov_b32 v158, 0xf1800000
    v_mov_b32 v159, 0xf1800000
    s_branch LB_w2
LB_v2:
    v_mfma_f32_32x32x16_bf16 v[144:159], v[64:67], v[32:35], 0
    v_mfma_f32_32x32x16_bf16 v[144:159], v[68:71], v[36:39], v[144:159]
LB_w2:
    ds_read_b128 v[64:67], v9 offset:2048
    ds_read_b128 v[68:71], v9 offset:3072
    s_waitcnt lgkmcnt(10)
    s_cmp_le_u32 s58, 3
    s_cbranch_scc1 LB_v3
    v_mov_b32 v160, 0xf1800000
    v_mov_b32 v161, 0xf1800000
    v_mov_b32 v162, 0xf1800000
    v_mov_b32 v163, 0xf1800000
    v_mov_b32 v164, 0xf1800000
    v_mov_b32 v165, 0xf1800000
    v_mov_b32 v166, 0xf1800000
    v_mov_b32 v167, 0xf1800000
    v_mov_b32 v168, 0xf1800000
    v_mov_b32 v169, 0xf1800000
    v_mov_b32 v170, 0xf1800000
    v_mov_b32 v171, 0xf1800000
    v_mov_b32 v172, 0xf1800000
    v_mov_b32 v173, 0xf1800000
    v_mov_b32 v174, 0xf1800000
    v_mov_b32 v175, 0xf1800000
    s_branch LB_w3
LB_v3:
    v_mfma_f32_32x32x16_bf16 v[160:175], v[96:99], v[32:35], 0
    v_mfma_f32_32x32x16_bf16 v[160:175], v[100:103], v[36:39], v[160:175]
LB_w3:
    ds_read_b128 v[96:99], v9 offset:34816
    ds_read_b128 v[100:103], v9 offset:35840
    s_waitcnt lgkmcnt(10)
    s_cmp_le_u32 s58, 4
    s_cbranch_scc1 LB_v4
    v_mov_b32 v176, 0xf1800000
    v_mov_b32 v177, 0xf1800000
    v_mov_b32 v178, 0xf1800000
    v_mov_b32 v179, 0xf1800000
    v_mov_b32 v180, 0xf1800000
    v_mov_b32 v181, 0xf1800000
    v_mov_b32 v182, 0xf1800000
    v_mov_b32 v183, 0xf1800000
    v_mov_b32 v184, 0xf1800000
    v_mov_b32 v185, 0xf1800000
    v_mov_b32 v186, 0xf1800000
    v_mov_b32 v187, 0xf1800000
    v_mov_b32 v188, 0xf1800000
    v_mov_b32 v189, 0xf1800000
    v_mov_b32 v190, 0xf1800000
    v_mov_b32 v191, 0xf1800000
    s_branch LB_w4
LB_v4:
    v_mfma_f32_32x32x16_bf16 v[176:191], v[104:107], v[32:35], 0
    v_mfma_f32_32x32x16_bf16 v[176:191], v[108:111], v[36:39], v[176:191]
LB_w4:
    ds_read_b128 v[104:107], v9 offset:6144
    ds_read_b128 v[108:111], v9 offset:7168
    s_waitcnt lgkmcnt(10)
    s_cmp_le_u32 s58, 5
    s_cbranch_scc1 LB_v5
    v_mov_b32 v192, 0xf1800000
    v_mov_b32 v193, 0xf1800000
    v_mov_b32 v194, 0xf1800000
    v_mov_b32 v195, 0xf1800000
    v_mov_b32 v196, 0xf1800000
    v_mov_b32 v197, 0xf1800000
    v_mov_b32 v198, 0xf1800000
    v_mov_b32 v199, 0xf1800000
    v_mov_b32 v200, 0xf1800000
    v_mov_b32 v201, 0xf1800000
    v_mov_b32 v202, 0xf1800000
    v_mov_b32 v203, 0xf1800000
    v_mov_b32 v204, 0xf1800000
    v_mov_b32 v205, 0xf1800000
    v_mov_b32 v206, 0xf1800000
    v_mov_b32 v207, 0xf1800000
    s_branch LB_w5
LB_v5:
    v_mfma_f32_32x32x16_bf16 v[192:207], v[40:43], v[32:35], 0
    v_mfma_f32_32x32x16_bf16 v[192:207], v[44:47], v[36:39], v[192:207]
LB_w5:
    ds_read_b128 v[40:43], v9 offset:10240
    ds_read_b128 v[44:47], v9 offset:11264
    s_waitcnt lgkmcnt(10)
    s_cmp_le_u32 s58, 6
    s_cbranch_scc1 LB_v6
    v_mov_b32 v208, 0xf1800000
    v_mov_b32 v209, 0xf1800000
    v_mov_b32 v210, 0xf1800000
    v_mov_b32 v211, 0xf1800000
    v_mov_b32 v212, 0xf1800000
    v_mov_b32 v213, 0xf1800000
    v_mov_b32 v214, 0xf1800000
    v_mov_b32 v215, 0xf1800000
    v_mov_b32 v216, 0xf1800000
    v_mov_b32 v217, 0xf1800000
    v_mov_b32 v218, 0xf1800000
    v_mov_b32 v219, 0xf1800000
    v_mov_b32 v220, 0xf1800000
    v_mov_b32 v221, 0xf1800000
    v_mov_b32 v222, 0xf1800000
    v_mov_b32 v223, 0xf1800000
    s_branch LB_w6
LB_v6:
    v_mfma_f32_32x32x16_bf16 v[208:223], v[48:51], v[32:35], 0
    v_mfma_f32_32x32x16_bf16 v[208:223], v[52:55], v[36:39], v[208:223]
LB_w6:
    ds_read_b128 v[48:51], v9 offset:14336
    ds_read_b128 v[52:55], v9 offset:15360
    s_waitcnt lgkmcnt(10)
    s_cmp_le_u32 s58, 7
    s_cbranch_scc1 LB_v7
    v_mov_b32 v224, 0xf1800000
    v_mov_b32 v225, 0xf1800000
    v_mov_b32 v226, 0xf1800000
    v_mov_b32 v227, 0xf1800000
    v_mov_b32 v228, 0xf1800000
    v_mov_b32 v229, 0xf1800000
    v_mov_b32 v230, 0xf1800000
    v_mov_b32 v231, 0xf1800000
    v_mov_b32 v232, 0xf1800000
    v_mov_b32 v233, 0xf1800000
    v_mov_b32 v234, 0xf1800000
    v_mov_b32 v235, 0xf1800000
    v_mov_b32 v236, 0xf1800000
    v_mov_b32 v237, 0xf1800000
    v_mov_b32 v238, 0xf1800000
    v_mov_b32 v239, 0xf1800000
    s_branch LB_w7
LB_v7:
    v_mfma_f32_32x32x16_bf16 v[224:239], v[56:59], v[32:35], 0
    v_mfma_f32_32x32x16_bf16 v[224:239], v[60:63], v[36:39], v[224:239]
LB_w7:
    ds_read_b128 v[56:59], v9 offset:18432
    ds_read_b128 v[60:63], v9 offset:19456
    s_nop 15
    s_bfm_b32 exec_lo, 0, 0
    s_bfm_b32 exec_hi, 4, 0
    v_mov_b32 v240, v112
    s_bfm_b32 exec_lo, 1, 0
    s_bfm_b32 exec_hi, 5, 0
    v_mov_b32 v241, v113
    s_bfm_b32 exec_lo, 2, 0
    s_bfm_b32 exec_hi, 6, 0
    v_mov_b32 v242, v114
    s_bfm_b32 exec_lo, 3, 0
    s_bfm_b32 exec_hi, 7, 0
    v_mov_b32 v243, v115
    s_bfm_b32 exec_lo, 8, 0
    s_bfm_b32 exec_hi, 12, 0
    v_mov_b32 v244, v116
    s_bfm_b32 exec_lo, 9, 0
    s_bfm_b32 exec_hi, 13, 0
    v_mov_b32 v245, v117
    s_bfm_b32 exec_lo, 10, 0
    s_bfm_b32 exec_hi, 14, 0
    v_mov_b32 v246, v118
    s_bfm_b32 exec_lo, 11, 0
    s_bfm_b32 exec_hi, 15, 0
    v_mov_b32 v247, v119
    s_bfm_b32 exec_lo, 16, 0
    s_bfm_b32 exec_hi, 20, 0
    v_mov_b32 v248, v120
    s_bfm_b32 exec_lo, 17, 0
    s_bfm_b32 exec_hi, 21, 0
    v_mov_b32 v249, v121
    s_bfm_b32 exec_lo, 18, 0
    s_bfm_b32 exec_hi, 22, 0
    v_mov_b32 v250, v122
    s_bfm_b32 exec_lo, 19, 0
    s_bfm_b32 exec_hi, 23, 0
    v_mov_b32 v251, v123
    s_bfm_b32 exec_lo, 24, 0
    s_bfm_b32 exec_hi, 28, 0
    v_mov_b32 v252, v124
    s_bfm_b32 exec_lo, 25, 0
    s_bfm_b32 exec_hi, 29, 0
    v_mov_b32 v253, v125
    s_bfm_b32 exec_lo, 26, 0
    s_bfm_b32 exec_hi, 30, 0
    v_mov_b32 v254, v126
    s_bfm_b32 exec_lo, 27, 0
    s_bfm_b32 exec_hi, 31, 0
    v_mov_b32 v255, v127
    s_mov_b64 exec, -1
    v_mov_b32 v112, 0
    v_mov_b32 v113, 0
    v_mov_b32 v114, 0
    v_mov_b32 v115, 0
    v_mov_b32 v116, 0
    v_mov_b32 v117, 0
    v_mov_b32 v118, 0
    v_mov_b32 v119, 0
    v_mov_b32 v120, 0
    v_mov_b32 v121, 0
    v_mov_b32 v122, 0
    v_mov_b32 v123, 0
    v_mov_b32 v124, 0
    v_mov_b32 v125, 0
    v_mov_b32 v126, 0
    v_mov_b32 v127, 0
    v_max_f32 v26, v240, v241
    v_max_f32 v27, v242, v243
    v_max3_f32 v26, v26, v244, v245
    v_max3_f32 v27, v27, v246, v247
    v_max3_f32 v26, v26, v248, v249
    v_max3_f32 v27, v27, v250, v251
    v_max3_f32 v26, v26, v252, v253
    v_max3_f32 v27, v27, v254, v255
    v_max3_f32 v26, v26, v128, v129
    v_max3_f32 v27, v27, v130, v131
    v_max3_f32 v26, v26, v132, v133
    v_max3_f32 v27, v27, v134, v135
    v_max3_f32 v26, v26, v136, v137
    v_max3_f32 v27, v27, v138, v139
    v_max3_f32 v26, v26, v140, v141
    v_max3_f32 v27, v27, v142, v143
    v_max3_f32 v26, v26, v144, v145
    v_max3_f32 v27, v27, v146, v147
    v_max3_f32 v26, v26, v148, v149
    v_max3_f32 v27, v27, v150, v151
    v_max3_f32 v26, v26, v152, v153
    v_max3_f32 v27, v27, v154, v155
    v_max3_f32 v26, v26, v156, v157
    v_max3_f32 v27, v27, v158, v159
    v_max3_f32 v26, v26, v160, v161
    v_max3_f32 v27, v27, v162, v163
    v_max3_f32 v26, v26, v164, v165
    v_max3_f32 v27, v27, v166, v167
    v_max3_f32 v26, v26, v168, v169
    v_max3_f32 v27, v27, v170, v171
    v_max3_f32 v26, v26, v172, v173
    v_max3_f32 v27, v27, v174, v175
    v_max3_f32 v26, v26, v176, v177
    v_max3_f32 v27, v27, v178, v179
    v_max3_f32 v26, v26, v180, v181
    v_max3_f32 v27, v27, v182, v183
    v_max3_f32 v26, v26, v184, v185
    v_max3_f32 v27, v27, v186, v187
    v_max3_f32 v26, v26, v188, v189
    v_max3_f32 v27, v27, v190, v191
    v_max3_f32 v26, v26, v192, v193
    v_max3_f32 v27, v27, v194, v195
    v_max3_f32 v26, v26, v196, v197
    v_max3_f32 v27, v27, v198, v199
    v_max3_f32 v26, v26, v200, v201
    v_max3_f32 v27, v27, v202, v203
    v_max3_f32 v26, v26, v204, v205
    v_max3_f32 v27, v27, v206, v207
    v_max3_f32 v26, v26, v208, v209
    v_max3_f32 v27, v27, v210, v211
    v_max3_f32 v26, v26, v212, v213
    v_max3_f32 v27, v27, v214, v215
    v_max3_f32 v26, v26, v216, v217
    v_max3_f32 v27, v27, v218, v219
    v_max3_f32 v26, v26, v220, v221
    v_max3_f32 v27, v27, v222, v223
    v_max3_f32 v26, v26, v224, v225
    v_max3_f32 v27, v27, v226, v227
    v_max3_f32 v26, v26, v228, v229
    v_max3_f32 v27, v27, v230, v231
    v_max3_f32 v26, v26, v232, v233
    v_max3_f32 v27, v27, v234, v235
    v_max3_f32 v26, v26, v236, v237
    v_max3_f32 v27, v27, v238, v239
    v_max_f32 v26, v26, v27
    v_mov_b32 v27, v26
    s_nop 1
    v_permlane32_swap_b32 v26, v27
    v_max_f32 v26, v26, v27
    v_mul_f32 v26, -1.0, v26
    v_mov_b32 v27, v26
    v_pk_add_f32 v[240:241], v[240:241], v[26:27]
    v_pk_add_f32 v[242:243], v[242:243], v[26:27]
    v_pk_add_f32 v[244:245], v[244:245], v[26:27]
    v_pk_add_f32 v[246:247], v[246:247], v[26:27]
    v_pk_add_f32 v[248:249], v[248:249], v[26:27]
    v_pk_add_f32 v[250:251], v[250:251], v[26:27]
    v_pk_add_f32 v[252:253], v[252:253], v[26:27]
    v_pk_add_f32 v[254:255], v[254:255], v[26:27]
    v_exp_f32 v240, v240
    v_exp_f32 v241, v241
    v_exp_f32 v242, v242
    v_exp_f32 v243, v243
    v_exp_f32 v244, v244
    v_exp_f32 v245, v245
    v_exp_f32 v246, v246
    v_exp_f32 v247, v247
    v_exp_f32 v248, v248
    v_exp_f32 v249, v249
    v_exp_f32 v250, v250
    v_exp_f32 v251, v251
    v_exp_f32 v252, v252
    v_exp_f32 v253, v253
    v_exp_f32 v254, v254
    v_exp_f32 v255, v255
    v_pk_add_f32 v[28:29], v[240:241], v[244:245]
    v_pk_add_f32 v[30:31], v[242:243], v[246:247]
    v_pk_add_f32 v[28:29], v[28:29], v[248:249]
    v_pk_add_f32 v[30:31], v[30:31], v[250:251]
    v_pk_add_f32 v[28:29], v[28:29], v[252:253]
    v_pk_add_f32 v[30:31], v[30:31], v[254:255]
    s_bfm_b32 exec_lo, 0, 0
    s_bfm_b32 exec_hi, 4, 0
    v_swap_b32 v240, v112
    s_bfm_b32 exec_lo, 1, 0
    s_bfm_b32 exec_hi, 5, 0
    v_swap_b32 v241, v113
    s_bfm_b32 exec_lo, 2, 0
    s_bfm_b32 exec_hi, 6, 0
    v_swap_b32 v242, v114
    s_bfm_b32 exec_lo, 3, 0
    s_bfm_b32 exec_hi, 7, 0
    v_swap_b32 v243, v115
    s_bfm_b32 exec_lo, 8, 0
    s_bfm_b32 exec_hi, 12, 0
    v_swap_b32 v244, v116
    s_bfm_b32 exec_lo, 9, 0
    s_bfm_b32 exec_hi, 13, 0
    v_swap_b32 v245, v117
    s_bfm_b32 exec_lo, 10, 0
    s_bfm_b32 exec_hi, 14, 0
    v_swap_b32 v246, v118
    s_bfm_b32 exec_lo, 11, 0
    s_bfm_b32 exec_hi, 15, 0
    v_swap_b32 v247, v119
    s_bfm_b32 exec_lo, 16, 0
    s_bfm_b32 exec_hi, 20, 0
    v_swap_b32 v248, v120
    s_bfm_b32 exec_lo, 17, 0
    s_bfm_b32 exec_hi, 21, 0
    v_swap_b32 v249, v121
    s_bfm_b32 exec_lo, 18, 0
    s_bfm_b32 exec_hi, 22, 0
    v_swap_b32 v250, v122
    s_bfm_b32 exec_lo, 19, 0
    s_bfm_b32 exec_hi, 23, 0
    v_swap_b32 v251, v123
    s_bfm_b32 exec_lo, 24, 0
    s_bfm_b32 exec_hi, 28, 0
    v_swap_b32 v252, v124
    s_bfm_b32 exec_lo, 25, 0
    s_bfm_b32 exec_hi, 29, 0
    v_swap_b32 v253, v125
    s_bfm_b32 exec_lo, 26, 0
    s_bfm_b32 exec_hi, 30, 0
    v_swap_b32 v254, v126
    s_bfm_b32 exec_lo, 27, 0
    s_bfm_b32 exec_hi, 31, 0
    v_swap_b32 v255, v127
    s_mov_b64 exec, -1
    v_cvt_pk_bf16_f32 v112, v112, v113
    v_cvt_pk_bf16_f32 v113, v114, v115
    v_cvt_pk_bf16_f32 v114, v116, v117
    v_cvt_pk_bf16_f32 v115, v118, v119
    v_cvt_pk_bf16_f32 v116, v120, v121
    v_cvt_pk_bf16_f32 v117, v122, v123
    v_cvt_pk_bf16_f32 v118, v124, v125
    v_cvt_pk_bf16_f32 v119, v126, v127
    v_cvt_pk_bf16_f32 v255, v254, v255
    v_cvt_pk_bf16_f32 v254, v252, v253
    v_cvt_pk_bf16_f32 v253, v250, v251
    v_cvt_pk_bf16_f32 v252, v248, v249
    v_cvt_pk_bf16_f32 v251, v246, v247
    v_cvt_pk_bf16_f32 v250, v244, v245
    v_cvt_pk_bf16_f32 v249, v242, v243
    v_cvt_pk_bf16_f32 v248, v240, v241
    v_pk_add_f32 v[128:129], v[128:129], v[26:27]
    v_pk_add_f32 v[130:131], v[130:131], v[26:27]
    v_pk_add_f32 v[132:133], v[132:133], v[26:27]
    v_pk_add_f32 v[134:135], v[134:135], v[26:27]
    v_pk_add_f32 v[136:137], v[136:137], v[26:27]
    v_pk_add_f32 v[138:139], v[138:139], v[26:27]
    v_pk_add_f32 v[140:141], v[140:141], v[26:27]
    v_pk_add_f32 v[142:143], v[142:143], v[26:27]
    v_exp_f32 v128, v128
    v_exp_f32 v129, v129
    v_exp_f32 v130, v130
    v_exp_f32 v131, v131
    v_exp_f32 v132, v132
    v_exp_f32 v133, v133
    v_exp_f32 v134, v134
    v_exp_f32 v135, v135
    v_exp_f32 v136, v136
    v_exp_f32 v137, v137
    v_exp_f32 v138, v138
    v_exp_f32 v139, v139
    v_exp_f32 v140, v140
    v_exp_f32 v141, v141
    v_exp_f32 v142, v142
    v_exp_f32 v143, v143
    v_pk_add_f32 v[28:29], v[28:29], v[128:129]
    v_pk_add_f32 v[30:31], v[30:31], v[130:131]
    v_pk_add_f32 v[28:29], v[28:29], v[132:133]
    v_pk_add_f32 v[30:31], v[30:31], v[134:135]
    v_pk_add_f32 v[28:29], v[28:29], v[136:137]
    v_pk_add_f32 v[30:31], v[30:31], v[138:139]
    v_pk_add_f32 v[28:29], v[28:29], v[140:141]
    v_pk_add_f32 v[30:31], v[30:31], v[142:143]
    v_cvt_pk_bf16_f32 v143, v142, v143
    v_cvt_pk_bf16_f32 v142, v140, v141
    v_cvt_pk_bf16_f32 v141, v138, v139
    v_cvt_pk_bf16_f32 v140, v136, v137
    v_cvt_pk_bf16_f32 v139, v134, v135
    v_cvt_pk_bf16_f32 v138, v132, v133
    v_cvt_pk_bf16_f32 v137, v130, v131
    v_cvt_pk_bf16_f32 v136, v128, v129
    v_pk_add_f32 v[144:145], v[144:145], v[26:27]
    v_pk_add_f32 v[146:147], v[146:147], v[26:27]
    v_pk_add_f32 v[148:149], v[148:149], v[26:27]
    v_pk_add_f32 v[150:151], v[150:151], v[26:27]
    v_pk_add_f32 v[152:153], v[152:153], v[26:27]
    v_pk_add_f32 v[154:155], v[154:155], v[26:27]
    v_pk_add_f32 v[156:157], v[156:157], v[26:27]
    v_pk_add_f32 v[158:159], v[158:159], v[26:27]
    v_exp_f32 v144, v144
    v_exp_f32 v145, v145
    v_exp_f32 v146, v146
    v_exp_f32 v147, v147
    v_exp_f32 v148, v148
    v_exp_f32 v149, v149
    v_exp_f32 v150, v150
    v_exp_f32 v151, v151
    v_exp_f32 v152, v152
    v_exp_f32 v153, v153
    v_exp_f32 v154, v154
    v_exp_f32 v155, v155
    v_exp_f32 v156, v156
    v_exp_f32 v157, v157
    v_exp_f32 v158, v158
    v_exp_f32 v159, v159
    v_pk_add_f32 v[28:29], v[28:29], v[144:145]
    v_pk_add_f32 v[30:31], v[30:31], v[146:147]
    v_pk_add_f32 v[28:29], v[28:29], v[148:149]
    v_pk_add_f32 v[30:31], v[30:31], v[150:151]
    v_pk_add_f32 v[28:29], v[28:29], v[152:153]
    v_pk_add_f32 v[30:31], v[30:31], v[154:155]
    v_pk_add_f32 v[28:29], v[28:29], v[156:157]
    v_pk_add_f32 v[30:31], v[30:31], v[158:159]
    v_cvt_pk_bf16_f32 v159, v158, v159
    v_cvt_pk_bf16_f32 v158, v156, v157
    v_cvt_pk_bf16_f32 v157, v154, v155
    v_cvt_pk_bf16_f32 v156, v152, v153
    v_cvt_pk_bf16_f32 v155, v150, v151
    v_cvt_pk_bf16_f32 v154, v148, v149
    v_cvt_pk_bf16_f32 v153, v146, v147
    v_cvt_pk_bf16_f32 v152, v144, v145
    v_pk_add_f32 v[160:161], v[160:161], v[26:27]
    v_pk_add_f32 v[162:163], v[162:163], v[26:27]
    v_pk_add_f32 v[164:165], v[164:165], v[26:27]
    v_pk_add_f32 v[166:167], v[166:167], v[26:27]
    v_pk_add_f32 v[168:169], v[168:169], v[26:27]
    v_pk_add_f32 v[170:171], v[170:171], v[26:27]
    v_pk_add_f32 v[172:173], v[172:173], v[26:27]
    v_pk_add_f32 v[174:175], v[174:175], v[26:27]
    v_exp_f32 v160, v160
    v_exp_f32 v161, v161
    v_exp_f32 v162, v162
    v_exp_f32 v163, v163
    v_exp_f32 v164, v164
    v_exp_f32 v165, v165
    v_exp_f32 v166, v166
    v_exp_f32 v167, v167
    v_exp_f32 v168, v168
    v_exp_f32 v169, v169
    v_exp_f32 v170, v170
    v_exp_f32 v171, v171
    v_exp_f32 v172, v172
    v_exp_f32 v173, v173
    v_exp_f32 v174, v174
    v_exp_f32 v175, v175
    v_pk_add_f32 v[28:29], v[28:29], v[160:161]
    v_pk_add_f32 v[30:31], v[30:31], v[162:163]
    v_pk_add_f32 v[28:29], v[28:29], v[164:165]
    v_pk_add_f32 v[30:31], v[30:31], v[166:167]
    v_pk_add_f32 v[28:29], v[28:29], v[168:169]
    v_pk_add_f32 v[30:31], v[30:31], v[170:171]
    v_pk_add_f32 v[28:29], v[28:29], v[172:173]
    v_pk_add_f32 v[30:31], v[30:31], v[174:175]
    v_cvt_pk_bf16_f32 v175, v174, v175
    v_cvt_pk_bf16_f32 v174, v172, v173
    v_cvt_pk_bf16_f32 v173, v170, v171
    v_cvt_pk_bf16_f32 v172, v168, v169
    v_cvt_pk_bf16_f32 v171, v166, v167
    v_cvt_pk_bf16_f32 v170, v164, v165
    v_cvt_pk_bf16_f32 v169, v162, v163
    v_cvt_pk_bf16_f32 v168, v160, v161
    v_pk_add_f32 v[176:177], v[176:177], v[26:27]
    v_pk_add_f32 v[178:179], v[178:179], v[26:27]
    v_pk_add_f32 v[180:181], v[180:181], v[26:27]
    v_pk_add_f32 v[182:183], v[182:183], v[26:27]
    v_pk_add_f32 v[184:185], v[184:185], v[26:27]
    v_pk_add_f32 v[186:187], v[186:187], v[26:27]
    v_pk_add_f32 v[188:189], v[188:189], v[26:27]
    v_pk_add_f32 v[190:191], v[190:191], v[26:27]
    v_exp_f32 v176, v176
    v_exp_f32 v177, v177
    v_exp_f32 v178, v178
    v_exp_f32 v179, v179
    v_exp_f32 v180, v180
    v_exp_f32 v181, v181
    v_exp_f32 v182, v182
    v_exp_f32 v183, v183
    v_exp_f32 v184, v184
    v_exp_f32 v185, v185
    v_exp_f32 v186, v186
    v_exp_f32 v187, v187
    v_exp_f32 v188, v188
    v_exp_f32 v189, v189
    v_exp_f32 v190, v190
    v_exp_f32 v191, v191
    v_pk_add_f32 v[28:29], v[28:29], v[176:177]
    v_pk_add_f32 v[30:31], v[30:31], v[178:179]
    v_pk_add_f32 v[28:29], v[28:29], v[180:181]
    v_pk_add_f32 v[30:31], v[30:31], v[182:183]
    v_pk_add_f32 v[28:29], v[28:29], v[184:185]
    v_pk_add_f32 v[30:31], v[30:31], v[186:187]
    v_pk_add_f32 v[28:29], v[28:29], v[188:189]
    v_pk_add_f32 v[30:31], v[30:31], v[190:191]
    v_cvt_pk_bf16_f32 v191, v190, v191
    v_cvt_pk_bf16_f32 v190, v188, v189
    v_cvt_pk_bf16_f32 v189, v186, v187
    v_cvt_pk_bf16_f32 v188, v184, v185
    v_cvt_pk_bf16_f32 v187, v182, v183
    v_cvt_pk_bf16_f32 v186, v180, v181
    v_cvt_pk_bf16_f32 v185, v178, v179
    v_cvt_pk_bf16_f32 v184, v176, v177
    v_pk_add_f32 v[192:193], v[192:193], v[26:27]
    v_pk_add_f32 v[194:195], v[194:195], v[26:27]
    v_pk_add_f32 v[196:197], v[196:197], v[26:27]
    v_pk_add_f32 v[198:199], v[198:199], v[26:27]
    v_pk_add_f32 v[200:201], v[200:201], v[26:27]
    v_pk_add_f32 v[202:203], v[202:203], v[26:27]
    v_pk_add_f32 v[204:205], v[204:205], v[26:27]
    v_pk_add_f32 v[206:207], v[206:207], v[26:27]
    v_exp_f32 v192, v192
    v_exp_f32 v193, v193
    v_exp_f32 v194, v194
    v_exp_f32 v195, v195
    v_exp_f32 v196, v196
    v_exp_f32 v197, v197
    v_exp_f32 v198, v198
    v_exp_f32 v199, v199
    v_exp_f32 v200, v200
    v_exp_f32 v201, v201
    v_exp_f32 v202, v202
    v_exp_f32 v203, v203
    v_exp_f32 v204, v204
    v_exp_f32 v205, v205
    v_exp_f32 v206, v206
    v_exp_f32 v207, v207
    v_pk_add_f32 v[28:29], v[28:29], v[192:193]
    v_pk_add_f32 v[30:31], v[30:31], v[194:195]
    v_pk_add_f32 v[28:29], v[28:29], v[196:197]
    v_pk_add_f32 v[30:31], v[30:31], v[198:199]
    v_pk_add_f32 v[28:29], v[28:29], v[200:201]
    v_pk_add_f32 v[30:31], v[30:31], v[202:203]
    v_pk_add_f32 v[28:29], v[28:29], v[204:205]
    v_pk_add_f32 v[30:31], v[30:31], v[206:207]
    v_cvt_pk_bf16_f32 v207, v206, v207
    v_cvt_pk_bf16_f32 v206, v204, v205
    v_cvt_pk_bf16_f32 v205, v202, v203
    v_cvt_pk_bf16_f32 v204, v200, v201
    v_cvt_pk_bf16_f32 v203, v198, v199
    v_cvt_pk_bf16_f32 v202, v196, v197
    v_cvt_pk_bf16_f32 v201, v194, v195
    v_cvt_pk_bf16_f32 v200, v192, v193
    v_pk_add_f32 v[208:209], v[208:209], v[26:27]
    v_pk_add_f32 v[210:211], v[210:211], v[26:27]
    v_pk_add_f32 v[212:213], v[212:213], v[26:27]
    v_pk_add_f32 v[214:215], v[214:215], v[26:27]
    v_pk_add_f32 v[216:217], v[216:217], v[26:27]
    v_pk_add_f32 v[218:219], v[218:219], v[26:27]
    v_pk_add_f32 v[220:221], v[220:221], v[26:27]
    v_pk_add_f32 v[222:223], v[222:223], v[26:27]
    v_exp_f32 v208, v208
    v_exp_f32 v209, v209
    v_exp_f32 v210, v210
    v_exp_f32 v211, v211
    v_exp_f32 v212, v212
    v_exp_f32 v213, v213
    v_exp_f32 v214, v214
    v_exp_f32 v215, v215
    v_exp_f32 v216, v216
    v_exp_f32 v217, v217
    v_exp_f32 v218, v218
    v_exp_f32 v219, v219
    v_exp_f32 v220, v220
    v_exp_f32 v221, v221
    v_exp_f32 v222, v222
    v_exp_f32 v223, v223
    v_pk_add_f32 v[28:29], v[28:29], v[208:209]
    v_pk_add_f32 v[30:31], v[30:31], v[210:211]
    v_pk_add_f32 v[28:29], v[28:29], v[212:213]
    v_pk_add_f32 v[30:31], v[30:31], v[214:215]
    v_pk_add_f32 v[28:29], v[28:29], v[216:217]
    v_pk_add_f32 v[30:31], v[30:31], v[218:219]
    v_pk_add_f32 v[28:29], v[28:29], v[220:221]
    v_pk_add_f32 v[30:31], v[30:31], v[222:223]
    v_cvt_pk_bf16_f32 v223, v222, v223
    v_cvt_pk_bf16_f32 v222, v220, v221
    v_cvt_pk_bf16_f32 v221, v218, v219
    v_cvt_pk_bf16_f32 v220, v216, v217
    v_cvt_pk_bf16_f32 v219, v214, v215
    v_cvt_pk_bf16_f32 v218, v212, v213
    v_cvt_pk_bf16_f32 v217, v210, v211
    v_cvt_pk_bf16_f32 v216, v208, v209
    v_pk_add_f32 v[224:225], v[224:225], v[26:27]
    v_pk_add_f32 v[226:227], v[226:227], v[26:27]
    v_pk_add_f32 v[228:229], v[228:229], v[26:27]
    v_pk_add_f32 v[230:231], v[230:231], v[26:27]
    v_pk_add_f32 v[232:233], v[232:233], v[26:27]
    v_pk_add_f32 v[234:235], v[234:235], v[26:27]
    v_pk_add_f32 v[236:237], v[236:237], v[26:27]
    v_pk_add_f32 v[238:239], v[238:239], v[26:27]
    v_exp_f32 v224, v224
    v_exp_f32 v225, v225
    v_exp_f32 v226, v226
    v_exp_f32 v227, v227
    v_exp_f32 v228, v228
    v_exp_f32 v229, v229
    v_exp_f32 v230, v230
    v_exp_f32 v231, v231
    v_exp_f32 v232, v232
    v_exp_f32 v233, v233
    v_exp_f32 v234, v234
    v_exp_f32 v235, v235
    v_exp_f32 v236, v236
    v_exp_f32 v237, v237
    v_exp_f32 v238, v238
    v_exp_f32 v239, v239
    v_pk_add_f32 v[28:29], v[28:29], v[224:225]
    v_pk_add_f32 v[30:31], v[30:31], v[226:227]
    v_pk_add_f32 v[28:29], v[28:29], v[228:229]
    v_pk_add_f32 v[30:31], v[30:31], v[230:231]
    v_pk_add_f32 v[28:29], v[28:29], v[232:233]
    v_pk_add_f32 v[30:31], v[30:31], v[234:235]
    v_pk_add_f32 v[28:29], v[28:29], v[236:237]
    v_pk_add_f32 v[30:31], v[30:31], v[238:239]
    v_cvt_pk_bf16_f32 v239, v238, v239
    v_cvt_pk_bf16_f32 v238, v236, v237
    v_cvt_pk_bf16_f32 v237, v234, v235
    v_cvt_pk_bf16_f32 v236, v232, v233
    v_cvt_pk_bf16_f32 v235, v230, v231
    v_cvt_pk_bf16_f32 v234, v228, v229
    v_cvt_pk_bf16_f32 v233, v226, v227
    v_cvt_pk_bf16_f32 v232, v224, v225
    s_nop 1
    s_waitcnt lgkmcnt(11)
    v_mfma_f32_32x32x16_bf16 v[120:135], v[64:67], v[112:115], 0
    s_waitcnt lgkmcnt(10)
    v_mfma_f32_32x32x16_bf16 v[120:135], v[68:71], v[116:119], v[120:135]
    ds_read_b128 v[64:67], v9 offset:22528
    ds_read_b128 v[68:71], v9 offset:23552
    s_waitcnt lgkmcnt(11)
    v_mfma_f32_32x32x16_bf16 v[120:135], v[96:99], v[248:251], v[120:135]
    s_waitcnt lgkmcnt(10)
    v_mfma_f32_32x32x16_bf16 v[120:135], v[100:103], v[252:255], v[120:135]
    ds_read_b128 v[96:99], v9 offset:26624
    ds_read_b128 v[100:103], v9 offset:27648
    s_waitcnt lgkmcnt(11)
    v_mfma_f32_32x32x16_bf16 v[120:135], v[104:107], v[136:139], v[120:135]
    s_waitcnt lgkmcnt(10)
    v_mfma_f32_32x32x16_bf16 v[120:135], v[108:111], v[140:143], v[120:135]
    ds_read_b128 v[104:107], v9 offset:30720
    ds_read_b128 v[108:111], v9 offset:31744
    s_waitcnt lgkmcnt(11)
    v_mfma_f32_32x32x16_bf16 v[120:135], v[40:43], v[152:155], v[120:135]
    s_waitcnt lgkmcnt(10)
    v_mfma_f32_32x32x16_bf16 v[120:135], v[44:47], v[156:159], v[120:135]
    s_waitcnt lgkmcnt(9)
    v_mfma_f32_32x32x16_bf16 v[120:135], v[48:51], v[168:171], v[120:135]
    s_waitcnt lgkmcnt(8)
    v_mfma_f32_32x32x16_bf16 v[120:135], v[52:55], v[172:175], v[120:135]
    s_waitcnt lgkmcnt(7)
    v_mfma_f32_32x32x16_bf16 v[120:135], v[56:59], v[184:187], v[120:135]
    s_waitcnt lgkmcnt(6)
    v_mfma_f32_32x32x16_bf16 v[120:135], v[60:63], v[188:191], v[120:135]
    s_waitcnt lgkmcnt(5)
    v_mfma_f32_32x32x16_bf16 v[120:135], v[64:67], v[200:203], v[120:135]
    s_waitcnt lgkmcnt(4)
    v_mfma_f32_32x32x16_bf16 v[120:135], v[68:71], v[204:207], v[120:135]
    s_waitcnt lgkmcnt(3)
    v_mfma_f32_32x32x16_bf16 v[120:135], v[96:99], v[216:219], v[120:135]
    s_waitcnt lgkmcnt(2)
    v_mfma_f32_32x32x16_bf16 v[120:135], v[100:103], v[220:223], v[120:135]
    s_waitcnt lgkmcnt(1)
    v_mfma_f32_32x32x16_bf16 v[120:135], v[104:107], v[232:235], v[120:135]
    s_waitcnt lgkmcnt(0)
    v_mfma_f32_32x32x16_bf16 v[120:135], v[108:111], v[236:239], v[120:135]
    v_pk_add_f32 v[28:29], v[28:29], v[30:31]
    v_add_f32 v28, v28, v29
    v_mov_b32 v29, v28
    s_nop 1
    v_permlane32_swap_b32 v28, v29
    v_add_f32 v28, v28, v29
    s_nop 7
    s_branch LB_norm
LB_nb:
    v_mov_b32 v240, 0xf1800000
    v_mov_b32 v241, 0xf1800000
    v_mov_b32 v242, 0xf1800000
    v_mov_b32 v243, 0xf1800000
    v_mov_b32 v244, 0xf1800000
    v_mov_b32 v245, 0xf1800000
    v_mov_b32 v246, 0xf1800000
    v_mov_b32 v247, 0xf1800000
    v_mov_b32 v248, 0xf1800000
    v_mov_b32 v249, 0xf1800000
    v_mov_b32 v250, 0xf1800000
    v_mov_b32 v251, 0xf1800000
    v_mov_b32 v252, 0xf1800000
    v_mov_b32 v253, 0xf1800000
    v_mov_b32 v254, 0xf1800000
    v_mov_b32 v255, 0xf1800000
    s_sub_u32 s58, 8, s3
    s_branch LB_nbr
LC_slowO0:
    s_mov_b32 s59, 0x8000
LC_spinO0:
    buffer_load_dword v16, v22, s[24:27], s54 offen offset:260 sc1
    s_waitcnt vmcnt(0)
    v_cmp_ne_u32 vcc, 1, v16
    s_nop 1
    s_cmp_eq_u64 vcc, 0
    s_cbranch_scc1 LC_spinO0_ok
    s_sub_u32 s59, s59, 1
    s_cbranch_scc1 LC_spinO0_ok
    s_sleep 2
    s_branch LC_spinO0
LC_spinO0_ok:
    s_branch LC_goO0
LC_slowH:
    s_mov_b32 s59, 0x8000
LC_spinH:
    buffer_load_dword v16, v18, s[24:27], s60 offen offset:256 sc1
    s_waitcnt vmcnt(0)
    v_cmp_ne_u32 vcc, 1, v16
    s_nop 1
    s_cmp_eq_u64 vcc, 0
    s_cbranch_scc1 LC_spinH_ok
    s_sub_u32 s59, s59, 1
    s_cbranch_scc1 LC_spinH_ok
    s_sleep 2
    s_branch LC_spinH
LC_spinH_ok:
    s_branch LC_goH
LG_s0:
    v_mov_b32 v20, 163832
    s_mov_b32 s100, 0x10000
    s_mov_b64 exec, 1
    s_waitcnt vmcnt(0)
    ds_add_rtn_u32 v21, v20, v19
    s_waitcnt lgkmcnt(0)
    v_readfirstlane_b32 s101, v21
    s_nop 1
    s_cmp_lg_u32 s101, 7
    s_cbranch_scc1 LG_x0
    s_add_u32 s101, s63, 0
    buffer_store_dword v19, off, s[24:27], s101 offset:128 sc1
LG_x0:
    s_mov_b64 exec, -1
    s_branch LG_r0
LG_s1:
    v_mov_b32 v20, 163832
    s_mov_b32 s100, 0x10000
    s_mov_b64 exec, 1
    s_waitcnt vmcnt(1)
    ds_add_rtn_u32 v21, v20, v19
    s_waitcnt lgkmcnt(0)
    v_readfirstlane_b32 s101, v21
    s_nop 1
    s_cmp_lg_u32 s101, 7
    s_cbranch_scc1 LG_x1
    s_add_u32 s101, s63, 0
    buffer_store_dword v19, off, s[24:27], s101 offset:128 sc1
LG_x1:
    s_mov_b64 exec, -1
    s_branch LG_r1
LG_s2:
    v_mov_b32 v20, 163832
    s_mov_b32 s100, 0x10000
    s_mov_b64 exec, 1
    s_waitcnt vmcnt(2)
    ds_add_rtn_u32 v21, v20, v19
    s_waitcnt lgkmcnt(0)
    v_readfirstlane_b32 s101, v21
    s_nop 1
    s_cmp_lg_u32 s101, 7
    s_cbranch_scc1 LG_x2
    s_add_u32 s101, s63, 0
    buffer_store_dword v19, off, s[24:27], s101 offset:128 sc1
LG_x2:
    s_mov_b64 exec, -1
    s_branch LG_r2
LG_s3:
    v_mov_b32 v20, 163832
    s_mov_b32 s100, 0x10000
    s_mov_b64 exec, 1
    s_waitcnt vmcnt(2)
    ds_add_rtn_u32 v21, v20, v19
    s_waitcnt lgkmcnt(0)
    v_readfirstlane_b32 s101, v21
    s_nop 1
    s_cmp_lg_u32 s101, 7
    s_cbranch_scc1 LG_x3
    s_add_u32 s101, s63, 0
    buffer_store_dword v19, off, s[24:27], s101 offset:128 sc1
LG_x3:
    s_mov_b64 exec, -1
    s_branch LG_r3
LG_s4:
    v_mov_b32 v20, 163832
    s_mov_b32 s100, 0x10000
    s_mov_b64 exec, 1
    s_waitcnt vmcnt(2)
    ds_add_rtn_u32 v21, v20, v19
    s_waitcnt lgkmcnt(0)
    v_readfirstlane_b32 s101, v21
    s_nop 1
    s_cmp_lg_u32 s101, 7
    s_cbranch_scc1 LG_x4
    s_add_u32 s101, s63, 0
    buffer_store_dword v19, off, s[24:27], s101 offset:128 sc1
LG_x4:
    s_mov_b64 exec, -1
    s_branch LG_r4
LG_s5:
    v_mov_b32 v20, 163832
    s_mov_b32 s100, 0x10000
    s_mov_b64 exec, 1
    s_waitcnt vmcnt(2)
    ds_add_rtn_u32 v21, v20, v19
    s_waitcnt lgkmcnt(0)
    v_readfirstlane_b32 s101, v21
    s_nop 1
    s_cmp_lg_u32 s101, 7
    s_cbranch_scc1 LG_x5
    s_add_u32 s101, s63, 0
    buffer_store_dword v19, off, s[24:27], s101 offset:128 sc1
LG_x5:
    s_mov_b64 exec, -1
    s_branch LG_r5
LG_s6:
    v_mov_b32 v20, 163832
    s_mov_b32 s100, 0x10000
    s_mov_b64 exec, 1
    s_waitcnt vmcnt(15)
    ds_add_rtn_u32 v21, v20, v19
    s_waitcnt lgkmcnt(0)
    v_readfirstlane_b32 s101, v21
    s_nop 1
    s_cmp_lg_u32 s101, 7
    s_cbranch_scc1 LG_x6
    s_add_u32 s101, s63, 0
    buffer_store_dword v19, off, s[24:27], s101 offset:128 sc1
LG_x6:
    s_mov_b64 exec, -1
    s_branch LG_r6
LG_s7:
    v_mov_b32 v20, 163832
    s_mov_b32 s100, 0x10000
    s_mov_b64 exec, 1
    s_waitcnt vmcnt(0)
    ds_add_rtn_u32 v21, v20, v19
    s_waitcnt lgkmcnt(0)
    v_readfirstlane_b32 s101, v21
    s_nop 1
    s_cmp_lg_u32 s101, 7
    s_cbranch_scc1 LG_x7
    s_add_u32 s101, s63, 0
    buffer_store_dword v19, off, s[24:27], s101 offset:128 sc1
LG_x7:
    s_mov_b64 exec, -1
    s_branch LG_r7
LG_s8:
    v_mov_b32 v20, 163832
    s_mov_b32 s100, 0x10000
    s_mov_b64 exec, 1
    s_waitcnt vmcnt(1)
    ds_add_rtn_u32 v21, v20, v19
    s_waitcnt lgkmcnt(0)
    v_readfirstlane_b32 s101, v21
    s_nop 1
    s_cmp_lg_u32 s101, 7
    s_cbranch_scc1 LG_x8
    s_add_u32 s101, s63, 0
    buffer_store_dword v19, off, s[24:27], s101 offset:128 sc1
LG_x8:
    s_mov_b64 exec, -1
    s_branch LG_r8
LG_s9:
    v_mov_b32 v20, 163832
    s_mov_b32 s100, 0x10000
    s_mov_b64 exec, 1
    s_waitcnt vmcnt(2)
    ds_add_rtn_u32 v21, v20, v19
    s_waitcnt lgkmcnt(0)
    v_readfirstlane_b32 s101, v21
    s_nop 1
    s_cmp_lg_u32 s101, 7
    s_cbranch_scc1 LG_x9
    s_add_u32 s101, s63, 0
    buffer_store_dword v19, off, s[24:27], s101 offset:128 sc1
LG_x9:
    s_mov_b64 exec, -1
    s_branch LG_r9
LG_s10:
    v_mov_b32 v20, 163832
    s_mov_b32 s100, 0x10000
    s_mov_b64 exec, 1
    s_waitcnt vmcnt(3)
    ds_add_rtn_u32 v21, v20, v19
    s_waitcnt lgkmcnt(0)
    v_readfirstlane_b32 s101, v21
    s_nop 1
    s_cmp_lg_u32 s101, 7
    s_cbranch_scc1 LG_x10
    s_add_u32 s101, s63, 0
    buffer_store_dword v19, off, s[24:27], s101 offset:128 sc1
LG_x10:
    s_mov_b64 exec, -1
    s_branch LG_r10
LG_s11:
    v_mov_b32 v20, 163832
    s_mov_b32 s100, 0x10000
    s_mov_b64 exec, 1
    s_waitcnt vmcnt(4)
    ds_add_rtn_u32 v21, v20, v19
    s_waitcnt lgkmcnt(0)
    v_readfirstlane_b32 s101, v21
    s_nop 1
    s_cmp_lg_u32 s101, 7
    s_cbranch_scc1 LG_x11
    s_add_u32 s101, s63, 0
    buffer_store_dword v19, off, s[24:27], s101 offset:128 sc1
LG_x11:
    s_mov_b64 exec, -1
    s_branch LG_r11
LG_s12:
    v_mov_b32 v20, 163832
    s_mov_b32 s100, 0x10000
    s_mov_b64 exec, 1
    s_waitcnt vmcnt(4)
    ds_add_rtn_u32 v21, v20, v19
    s_waitcnt lgkmcnt(0)
    v_readfirstlane_b32 s101, v21
    s_nop 1
    s_cmp_lg_u32 s101, 7
    s_cbranch_scc1 LG_x12
    s_add_u32 s101, s63, 0
    buffer_store_dword v19, off, s[24:27], s101 offset:128 sc1
LG_x12:
    s_mov_b64 exec, -1
    s_branch LG_r12
LG_s13:
    v_mov_b32 v20, 163832
    s_mov_b32 s100, 0x10000
    s_mov_b64 exec, 1
    s_waitcnt vmcnt(4)
    ds_add_rtn_u32 v21, v20, v19
    s_waitcnt lgkmcnt(0)
    v_readfirstlane_b32 s101, v21
    s_nop 1
    s_cmp_lg_u32 s101, 7
    s_cbranch_scc1 LG_x13
    s_add_u32 s101, s63, 0
    buffer_store_dword v19, off, s[24:27], s101 offset:128 sc1
LG_x13:
    s_mov_b64 exec, -1
    s_branch LG_r13
LG_s14:
    v_mov_b32 v20, 163832
    s_mov_b32 s100, 0x10000
    s_mov_b64 exec, 1
    s_waitcnt vmcnt(4)
    ds_add_rtn_u32 v21, v20, v19
    s_waitcnt lgkmcnt(0)
    v_readfirstlane_b32 s101, v21
    s_nop 1
    s_cmp_lg_u32 s101, 7
    s_cbranch_scc1 LG_x14
    s_add_u32 s101, s63, 0
    buffer_store_dword v19, off, s[24:27], s101 offset:128 sc1
LG_x14:
    s_mov_b64 exec, -1
    s_branch LG_r14
LB_m0:
    v_mfma_f32_32x32x16_bf16 v[136:151], v[216:219], v[32:35], v[240:255]
    s_branch LB_n0
LG_s15:
    v_mov_b32 v20, 96256
    s_mov_b32 s100, 0x10000
    s_mov_b64 exec, 1
    s_waitcnt vmcnt(0)
    ds_add_rtn_u32 v21, v20, v19
    s_waitcnt lgkmcnt(0)
    v_readfirstlane_b32 s101, v21
    s_nop 1
    s_cmp_lg_u32 s101, 7
    s_cbranch_scc1 LG_x15
    s_add_u32 s101, s63, 0
    buffer_store_dword v19, off, s[24:27], s101 offset:256 sc1
LG_x15:
    s_mov_b64 exec, -1
    s_branch LG_r15
LB_m1:
    v_mfma_f32_32x32x16_bf16 v[168:183], v[232:235], v[32:35], v[240:255]
    s_branch LB_n1
LG_s16:
    v_mov_b32 v20, 96256
    s_mov_b32 s100, 0x10000
    s_mov_b64 exec, 1
    s_waitcnt vmcnt(0)
    ds_add_rtn_u32 v21, v20, v19
    s_waitcnt lgkmcnt(0)
    v_readfirstlane_b32 s101, v21
    s_nop 1
    s_cmp_lg_u32 s101, 7
    s_cbranch_scc1 LG_x16
    s_add_u32 s101, s63, 0
    buffer_store_dword v19, off, s[24:27], s101 offset:256 sc1
LG_x16:
    s_mov_b64 exec, -1
    s_branch LG_r16
LB_m2:
    v_mfma_f32_32x32x16_bf16 v[184:199], v[112:115], v[32:35], v[240:255]
    s_branch LB_n2
LG_s17:
    v_mov_b32 v20, 96256
    s_mov_b32 s100, 0x10000
    s_mov_b64 exec, 1
    s_waitcnt vmcnt(0)
    ds_add_rtn_u32 v21, v20, v19
    s_waitcnt lgkmcnt(0)
    v_readfirstlane_b32 s101, v21
    s_nop 1
    s_cmp_lg_u32 s101, 7
    s_cbranch_scc1 LG_x17
    s_add_u32 s101, s63, 0
    buffer_store_dword v19, off, s[24:27], s101 offset:256 sc1
LG_x17:
    s_mov_b64 exec, -1
    s_branch LG_r17
LB_m3:
    v_mfma_f32_32x32x16_bf16 v[136:151], v[216:219], v[32:35], v[240:255]
    s_branch LB_n3
LG_s18:
    v_mov_b32 v20, 96256
    s_mov_b32 s100, 0x10000
    s_mov_b64 exec, 1
    s_waitcnt vmcnt(0)
    ds_add_rtn_u32 v21, v20, v19
    s_waitcnt lgkmcnt(0)
    v_readfirstlane_b32 s101, v21
    s_nop 1
    s_cmp_lg_u32 s101, 7
    s_cbranch_scc1 LG_x18
    s_add_u32 s101, s63, 0
    buffer_store_dword v19, off, s[24:27], s101 offset:256 sc1
LG_x18:
    s_mov_b64 exec, -1
    s_branch LG_r18
LB_m4:
    v_mfma_f32_32x32x16_bf16 v[152:167], v[224:227], v[32:35], v[240:255]
    s_branch LB_n4
LG_s19:
    v_mov_b32 v20, 96256
    s_mov_b32 s100, 0x10000
    s_mov_b64 exec, 1
    s_waitcnt vmcnt(2)
    ds_add_rtn_u32 v21, v20, v19
    s_waitcnt lgkmcnt(0)
    v_readfirstlane_b32 s101, v21
    s_nop 1
    s_cmp_lg_u32 s101, 7
    s_cbranch_scc1 LG_x19
    s_add_u32 s101, s63, 0
    buffer_store_dword v19, off, s[24:27], s101 offset:256 sc1
LG_x19:
    s_mov_b64 exec, -1
    s_branch LG_r19
LB_m5:
    v_mfma_f32_32x32x16_bf16 v[168:183], v[232:235], v[32:35], v[240:255]
    s_branch LB_n5
LG_s20:
    v_mov_b32 v20, 96256
    s_mov_b32 s100, 0x10000
    s_mov_b64 exec, 1
    s_waitcnt vmcnt(4)
    ds_add_rtn_u32 v21, v20, v19
    s_waitcnt lgkmcnt(0)
    v_readfirstlane_b32 s101, v21
    s_nop 1
    s_cmp_lg_u32 s101, 7
    s_cbranch_scc1 LG_x20
    s_add_u32 s101, s63, 0
    buffer_store_dword v19, off, s[24:27], s101 offset:256 sc1
LG_x20:
    s_mov_b64 exec, -1
    s_branch LG_r20
LB_m6:
    v_mfma_f32_32x32x16_bf16 v[184:199], v[112:115], v[32:35], v[240:255]
    s_branch LB_n6
LG_s21:
    v_mov_b32 v20, 96256
    s_mov_b32 s100, 0x10000
    s_mov_b64 exec, 1
    s_waitcnt vmcnt(6)
    ds_add_rtn_u32 v21, v20, v19
    s_waitcnt lgkmcnt(0)
    v_readfirstlane_b32 s101, v21
    s_nop 1
    s_cmp_lg_u32 s101, 7
    s_cbranch_scc1 LG_x21
    s_add_u32 s101, s63, 0
    buffer_store_dword v19, off, s[24:27], s101 offset:256 sc1
LG_x21:
    s_mov_b64 exec, -1
    s_branch LG_r21
LB_m7:
    v_mfma_f32_32x32x16_bf16 v[136:151], v[216:219], v[32:35], v[240:255]
    s_branch LB_n7
LG_s22:
    v_mov_b32 v20, 96256
    s_mov_b32 s100, 0x10000
    s_mov_b64 exec, 1
    s_waitcnt vmcnt(7)
    ds_add_rtn_u32 v21, v20, v19
    s_waitcnt lgkmcnt(0)
    v_readfirstlane_b32 s101, v21
    s_nop 1
    s_cmp_lg_u32 s101, 7
    s_cbranch_scc1 LG_x22
    s_add_u32 s101, s63, 0
    buffer_store_dword v19, off, s[24:27], s101 offset:256 sc1
LG_x22:
    s_mov_b64 exec, -1
    s_branch LG_r22
LG_s23:
    v_mov_b32 v20, 96256
    s_mov_b32 s100, 0x10000
    s_mov_b64 exec, 1
    s_waitcnt vmcnt(7)
    ds_add_rtn_u32 v21, v20, v19
    s_waitcnt lgkmcnt(0)
    v_readfirstlane_b32 s101, v21
    s_nop 1
    s_cmp_lg_u32 s101, 7
    s_cbranch_scc1 LG_x23
    s_add_u32 s101, s63, 0
    buffer_store_dword v19, off, s[24:27], s101 offset:256 sc1
LG_x23:
    s_mov_b64 exec, -1
    s_branch LG_r23
LG_s24:
    v_mov_b32 v20, 0
    s_mov_b32 s100, 0x10000
    s_mov_b64 exec, 1
    s_waitcnt vmcnt(0)
    ds_add_rtn_u32 v21, v20, v19
    s_waitcnt lgkmcnt(0)
    v_readfirstlane_b32 s101, v21
    s_nop 1
    s_cmp_lg_u32 s101, 7
    s_cbranch_scc1 LG_x24
    s_add_u32 s101, s63, 0
    buffer_store_dword v19, off, s[24:27], s101 offset:384 sc1
LG_x24:
    s_mov_b64 exec, -1
    s_branch LG_r24
LG_s25:
    v_mov_b32 v20, 0
    s_mov_b32 s100, 0x10000
    s_mov_b64 exec, 1
    s_waitcnt vmcnt(0)
    ds_add_rtn_u32 v21, v20, v19
    s_waitcnt lgkmcnt(0)
    v_readfirstlane_b32 s101, v21
    s_nop 1
    s_cmp_lg_u32 s101, 7
    s_cbranch_scc1 LG_x25
    s_add_u32 s101, s63, 0
    buffer_store_dword v19, off, s[24:27], s101 offset:384 sc1
LG_x25:
    s_mov_b64 exec, -1
    s_branch LG_r25
LG_s26:
    v_mov_b32 v20, 0
    s_mov_b32 s100, 0x10000
    s_mov_b64 exec, 1
    s_waitcnt vmcnt(1)
    ds_add_rtn_u32 v21, v20, v19
    s_waitcnt lgkmcnt(0)
    v_readfirstlane_b32 s101, v21
    s_nop 1
    s_cmp_lg_u32 s101, 7
    s_cbranch_scc1 LG_x26
    s_add_u32 s101, s63, 0
    buffer_store_dword v19, off, s[24:27], s101 offset:384 sc1
LG_x26:
    s_mov_b64 exec, -1
    s_branch LG_r26
LG_s27:
    v_mov_b32 v20, 0
    s_mov_b32 s100, 0x10000
    s_mov_b64 exec, 1
    s_waitcnt vmcnt(2)
    ds_add_rtn_u32 v21, v20, v19
    s_waitcnt lgkmcnt(0)
    v_readfirstlane_b32 s101, v21
    s_nop 1
    s_cmp_lg_u32 s101, 7
    s_cbranch_scc1 LG_x27
    s_add_u32 s101, s63, 0
    buffer_store_dword v19, off, s[24:27], s101 offset:384 sc1
LG_x27:
    s_mov_b64 exec, -1
    s_branch LG_r27
LG_s28:
    v_mov_b32 v20, 4
    s_mov_b32 s55, 0x10000
    s_mov_b64 exec, 1
    s_waitcnt vmcnt(0)
    ds_add_rtn_u32 v21, v20, v19
    s_waitcnt lgkmcnt(0)
    v_readfirstlane_b32 s101, v21
    s_nop 1
    s_cmp_lg_u32 s101, 7
    s_cbranch_scc1 LG_x28
    s_add_u32 s101, s63, 0
    buffer_store_dword v19, off, s[24:27], s101 offset:388 sc1
LG_x28:
    s_mov_b64 exec, -1
    s_branch LG_r28
LG_s29:
    v_mov_b32 v20, 0
    s_mov_b32 s100, 0x10000
    s_mov_b64 exec, 1
    s_waitcnt vmcnt(3)
    ds_add_rtn_u32 v21, v20, v19
    s_waitcnt lgkmcnt(0)
    v_readfirstlane_b32 s101, v21
    s_nop 1
    s_cmp_lg_u32 s101, 7
    s_cbranch_scc1 LG_x29
    s_add_u32 s101, s63, 0
    buffer_store_dword v19, off, s[24:27], s101 offset:384 sc1
LG_x29:
    s_mov_b64 exec, -1
    s_branch LG_r29
LG_s30:
    v_mov_b32 v20, 4
    s_mov_b32 s55, 0x10000
    s_mov_b64 exec, 1
    s_waitcnt vmcnt(1)
    ds_add_rtn_u32 v21, v20, v19
    s_waitcnt lgkmcnt(0)
    v_readfirstlane_b32 s101, v21
    s_nop 1
    s_cmp_lg_u32 s101, 7
    s_cbranch_scc1 LG_x30
    s_add_u32 s101, s63, 0
    buffer_store_dword v19, off, s[24:27], s101 offset:388 sc1
LG_x30:
    s_mov_b64 exec, -1
    s_branch LG_r30
LG_s31:
    v_mov_b32 v20, 0
    s_mov_b32 s100, 0x10000
    s_mov_b64 exec, 1
    s_waitcnt vmcnt(3)
    ds_add_rtn_u32 v21, v20, v19
    s_waitcnt lgkmcnt(0)
    v_readfirstlane_b32 s101, v21
    s_nop 1
    s_cmp_lg_u32 s101, 7
    s_cbranch_scc1 LG_x31
    s_add_u32 s101, s63, 0
    buffer_store_dword v19, off, s[24:27], s101 offset:384 sc1
LG_x31:
    s_mov_b64 exec, -1
    s_branch LG_r31
LG_s32:
    v_mov_b32 v20, 0
    s_mov_b32 s100, 0x10000
    s_mov_b64 exec, 1
    s_waitcnt vmcnt(15)
    ds_add_rtn_u32 v21, v20, v19
    s_waitcnt lgkmcnt(0)
    v_readfirstlane_b32 s101, v21
    s_nop 1
    s_cmp_lg_u32 s101, 7
    s_cbranch_scc1 LG_x32
    s_add_u32 s101, s63, 0
    buffer_store_dword v19, off, s[24:27], s101 offset:384 sc1
LG_x32:
    s_mov_b64 exec, -1
    s_branch LG_r32
LG_s33:
    v_mov_b32 v20, 4
    s_mov_b32 s55, 0x10000
    s_mov_b64 exec, 1
    s_waitcnt vmcnt(15)
    ds_add_rtn_u32 v21, v20, v19
    s_waitcnt lgkmcnt(0)
    v_readfirstlane_b32 s101, v21
    s_nop 1
    s_cmp_lg_u32 s101, 7
    s_cbranch_scc1 LG_x33
    s_add_u32 s101, s63, 0
    buffer_store_dword v19, off, s[24:27], s101 offset:388 sc1
LG_x33:
    s_mov_b64 exec, -1
    s_branch LG_r33
LZ_end:
.section .rodata,"a"
.p2align 6
.amdhsa_kernel gated_mix__sliding_block__swiglu_ffn__prompt_kernel
  .amdhsa_next_free_vgpr 256
  .amdhsa_next_free_sgpr 102
  .amdhsa_accum_offset 256
  .amdhsa_group_segment_fixed_size 0
  .amdhsa_kernarg_size 88
  .amdhsa_user_sgpr_count 2
  .amdhsa_user_sgpr_kernarg_segment_ptr 1
  .amdhsa_system_sgpr_workgroup_id_x 1
.end_amdhsa_kernel
```
